```python
import torch

def _softmax(x, axis=-1):
    return torch.softmax(x, dim=axis)
def _gelu(x):
    return torch.nn.functional.gelu(x, approximate="tanh")
def _silu(x):
    return torch.nn.functional.silu(x)
def _sigmoid(x):
    return torch.sigmoid(x)
def _layernorm(x, axis=-1, eps=1e-5):
    m = x.mean(dim=axis, keepdim=True)
    v = x.var(dim=axis, keepdim=True, unbiased=False)
    return (x - m) / torch.sqrt(v + eps)
def _scatter_add(tgt, idx, src, axis=0):
    return tgt.clone().index_add_(axis, idx, src)
def _segment_sum(src, seg, n):
    out = torch.zeros((n,) + src.shape[1:], dtype=src.dtype)
    return out.index_add_(0, seg, src)
def _pad(x, pw):
    flat = tuple(v for pair in reversed(pw) for v in pair)
    return torch.nn.functional.pad(x, flat)

kernel_name = 'sequential_preLN__grouped_kv_mqa__dense_activation_squared_relu__prompt'

def setup_inputs():

    _w = (lambda a: (lambda t: t.to(torch.bfloat16) if t.is_floating_point() else t)(torch.as_tensor(a)))
    def _A_setup():
        B, S, D, H = 1, 2048, 640, 32
        Dh = D // H
        return {
            "x": _w((lambda *s: torch.randn(*s, dtype=torch.bfloat16) * 0.05)(B, S, D)),
            "wq": _w((lambda *s: torch.randn(*s, dtype=torch.bfloat16) * 0.05)(D, H * Dh)),
            "wk": _w((lambda *s: torch.randn(*s, dtype=torch.bfloat16) * 0.05)(D, Dh)),
            "wv": _w((lambda *s: torch.randn(*s, dtype=torch.bfloat16) * 0.05)(D, Dh)),
            "wo": _w((lambda *s: torch.randn(*s, dtype=torch.bfloat16) * 0.05)(H * Dh, D)),
        }
    _A_in = _A_setup()

    def _B_setup():
        B, S, D, F = 1, 2048, 640, 1536
        return {
            "x": _w((lambda *s: torch.randn(*s, dtype=torch.bfloat16) * 0.05)(B, S, D)),
            "w1": _w((lambda *s: torch.randn(*s, dtype=torch.bfloat16) * 0.05)(D, F)),
            "b1": _w((lambda *s: torch.randn(*s, dtype=torch.bfloat16) * 0.8)(F)),
            "w2": _w((lambda *s: torch.randn(*s, dtype=torch.bfloat16) * 0.05)(F, D)),
            "b2": _w((lambda *s: torch.randn(*s, dtype=torch.bfloat16) * 3.2)(D)),
        }
    _B_in = _B_setup()

    return {
        "A_x": _A_in["x"],
        "A_wq": _A_in["wq"],
        "A_wk": _A_in["wk"],
        "A_wv": _A_in["wv"],
        "A_wo": _A_in["wo"],
        "B_x": _B_in["x"],
        "B_w1": _B_in["w1"],
        "B_b1": _B_in["b1"],
        "B_w2": _B_in["w2"],
        "B_b2": _B_in["b2"],
    }

def reference(A_x, A_wq, A_wk, A_wv, A_wo, B_x, B_w1, B_b1, B_w2, B_b2):
    def _A_ref(x, wq, wk, wv, wo):
        B, S, D = x.shape
        H = 32
        Dh = D // H
        q = (lambda x, *d: x.permute(*d))((x @ wq).reshape(B, S, H, Dh), 0, 2, 1, 3)
        k = x @ wk
        v = x @ wv
        scores = torch.einsum("bhqd,bkd->bhqk", q, k) * (Dh ** -0.5)
        p = _softmax(scores, axis=-1)
        o = torch.einsum("bhqk,bkd->bhqd", p, v)
        return (lambda x, *d: x.permute(*d))(o, 0, 2, 1, 3).reshape(B, S, H * Dh) @ wo

    def _B_ref(x, w1, b1, w2, b2):
        h = torch.einsum("bsd,df->bsf", x, w1) + b1
        zero = torch.zeros_like(h)
        r = torch.where(h > zero, h, zero)
        h = r * r
        out = torch.einsum("bsf,fd->bsd", h, w2) + b2
        return out

    x = A_x
    h = x + _A_ref(_layernorm(x, axis=-1), A_wq, A_wk, A_wv, A_wo)
    h2 = h + _B_ref(_layernorm(h, axis=-1), B_w1, B_b1, B_w2, B_b2)
    return h2
```

```asm
; @launch kernel=k1_kernel grid=(256,1,1) block=(256,1,1) lds=157184
; @launch kernel=k2_kernel grid=(256,1,1) block=(576,1,1) lds=163840
; @launch kernel=k3_kernel grid=(256,1,1) block=(256,1,1) lds=155648
.amdgcn_target "amdgcn-amd-amdhsa--gfx950"
.text
.globl k1_kernel
.p2align 8
.type k1_kernel,@function
k1_kernel:
    s_getpc_b64 s[48:49]
k1_pc:
    s_cmp_ge_u32 s2, 256
    s_cbranch_scc1 k1_end
    s_load_dwordx4 s[4:7], s[0:1], 0
    s_load_dwordx4 s[8:11], s[0:1], 16
    s_load_dwordx2 s[12:13], s[0:1], 96
    s_sub_u32 s48, s48, k1_pc-k1_kernel
    s_subb_u32 s49, s49, 0
    s_mov_b32 s50, text_end-k1_kernel
    s_mov_b32 s51, 0x00020000
    s_lshr_b32 s35, s2, 3
    s_lshl_b32 s35, s35, 15
    v_lshlrev_b32 v12, 7, v0
    buffer_load_dword v216, v12, s[48:51], s35 offen
    v_lshrrev_b32 v1, 6, v0
    s_nop 0
    v_readfirstlane_b32 s34, v1
    v_and_b32 v1, 63, v0
    v_and_b32 v2, 15, v1
    v_lshrrev_b32 v3, 4, v1
    s_and_b32 s35, s2, 7
    s_lshr_b32 s36, s2, 3
    s_lshl_b32 s32, s35, 2
    s_and_b32 s35, s36, 3
    s_add_u32 s32, s32, s35
    s_lshr_b32 s33, s36, 2
    s_lshl_b32 s35, s32, 6
    s_lshl_b32 s36, s34, 4
    s_add_u32 s35, s35, s36
    v_add_u32 v12, 0, v3
    v_xor_b32 v13, v2, v12
    v_add_u32 v12, s35, v12
    v_mul_u32_u24 v12, 1280, v12
    v_lshl_add_u32 v145, v13, 4, v12
    v_add_u32 v12, 4, v3
    v_xor_b32 v13, v2, v12
    v_add_u32 v12, s35, v12
    v_mul_u32_u24 v12, 1280, v12
    v_lshl_add_u32 v146, v13, 4, v12
    v_add_u32 v12, 8, v3
    v_xor_b32 v13, v2, v12
    v_add_u32 v12, s35, v12
    v_mul_u32_u24 v12, 1280, v12
    v_lshl_add_u32 v147, v13, 4, v12
    v_add_u32 v12, 12, v3
    v_xor_b32 v13, v2, v12
    v_add_u32 v12, s35, v12
    v_mul_u32_u24 v12, 1280, v12
    v_lshl_add_u32 v148, v13, 4, v12
    s_lshl_b32 s43, s34, 12
    s_add_u32 s43, s43, 81920
    s_mul_i32 s37, s33, 160
    s_mul_i32 s35, s34, 40960
    s_add_u32 s37, s37, s35
    s_mul_i32 s41, s34, 5120
    v_add_u32 v12, 0, v1
    v_mul_u32_u24 v13, 6554, v12
    v_lshrrev_b32 v13, 16, v13
    v_mul_u32_u24 v14, 10, v13
    v_sub_u32 v12, v12, v14
    v_lshlrev_b32 v12, 4, v12
    v_bfe_u32 v14, v13, 2, 2
    v_lshlrev_b32 v14, 3, v14
    v_and_b32 v5, 3, v13
    v_add_u32 v14, v14, v5
    v_lshrrev_b32 v13, 4, v13
    v_lshl_add_u32 v14, v13, 2, v14
    v_mul_u32_u24 v14, 1280, v14
    v_add_u32 v5, v14, v12
    v_add_u32 v12, 64, v1
    v_mul_u32_u24 v13, 6554, v12
    v_lshrrev_b32 v13, 16, v13
    v_mul_u32_u24 v14, 10, v13
    v_sub_u32 v12, v12, v14
    v_lshlrev_b32 v12, 4, v12
    v_bfe_u32 v14, v13, 2, 2
    v_lshlrev_b32 v14, 3, v14
    v_and_b32 v6, 3, v13
    v_add_u32 v14, v14, v6
    v_lshrrev_b32 v13, 4, v13
    v_lshl_add_u32 v14, v13, 2, v14
    v_mul_u32_u24 v14, 1280, v14
    v_add_u32 v6, v14, v12
    v_add_u32 v12, 128, v1
    v_mul_u32_u24 v13, 6554, v12
    v_lshrrev_b32 v13, 16, v13
    v_mul_u32_u24 v14, 10, v13
    v_sub_u32 v12, v12, v14
    v_lshlrev_b32 v12, 4, v12
    v_bfe_u32 v14, v13, 2, 2
    v_lshlrev_b32 v14, 3, v14
    v_and_b32 v7, 3, v13
    v_add_u32 v14, v14, v7
    v_lshrrev_b32 v13, 4, v13
    v_lshl_add_u32 v14, v13, 2, v14
    v_mul_u32_u24 v14, 1280, v14
    v_add_u32 v7, v14, v12
    v_add_u32 v12, 192, v1
    v_mul_u32_u24 v13, 6554, v12
    v_lshrrev_b32 v13, 16, v13
    v_mul_u32_u24 v14, 10, v13
    v_sub_u32 v12, v12, v14
    v_lshlrev_b32 v12, 4, v12
    v_bfe_u32 v14, v13, 2, 2
    v_lshlrev_b32 v14, 3, v14
    v_and_b32 v8, 3, v13
    v_add_u32 v14, v14, v8
    v_lshrrev_b32 v13, 4, v13
    v_lshl_add_u32 v14, v13, 2, v14
    v_mul_u32_u24 v14, 1280, v14
    v_add_u32 v8, v14, v12
    v_add_u32 v12, 256, v1
    v_mul_u32_u24 v13, 6554, v12
    v_lshrrev_b32 v13, 16, v13
    v_mul_u32_u24 v14, 10, v13
    v_sub_u32 v12, v12, v14
    v_lshlrev_b32 v12, 4, v12
    v_bfe_u32 v14, v13, 2, 2
    v_lshlrev_b32 v14, 3, v14
    v_and_b32 v9, 3, v13
    v_add_u32 v14, v14, v9
    v_lshrrev_b32 v13, 4, v13
    v_lshl_add_u32 v14, v13, 2, v14
    v_mul_u32_u24 v14, 1280, v14
    v_add_u32 v9, v14, v12
    s_waitcnt lgkmcnt(0)
    s_mov_b32 s16, s4
    s_mov_b32 s17, s5
    s_mov_b32 s18, 0x280000
    s_mov_b32 s19, 0x00020000
    s_mov_b32 s20, s6
    s_mov_b32 s21, s7
    s_mov_b32 s22, 0xc8000
    s_mov_b32 s23, 0x00020000
    s_and_b32 s35, s32, 3
    s_lshl_b32 s36, s33, 1
    s_add_u32 s35, s35, s36
    s_mul_hi_u32 s57, s35, 0x33333334
    s_mul_i32 s36, s57, 5
    s_sub_u32 s56, s35, s36
    s_sub_u32 s57, s56, 5
    s_cselect_b32 s59, 5, 0
    s_add_u32 s57, s57, s59
    s_mul_i32 s58, s57, 163840
    s_add_u32 s58, s58, s37
    s_lshl_b32 s57, s57, 8
    s_add_u32 m0, s43, 0
    s_nop 0
    buffer_load_dwordx4 v145, s[16:19], s57 offen lds
    s_add_u32 m0, s43, 1024
    s_nop 0
    buffer_load_dwordx4 v146, s[16:19], s57 offen lds
    s_add_u32 m0, s43, 2048
    s_nop 0
    buffer_load_dwordx4 v147, s[16:19], s57 offen lds
    s_add_u32 m0, s43, 3072
    s_nop 0
    buffer_load_dwordx4 v148, s[16:19], s57 offen lds
    s_add_u32 m0, s41, 0
    s_nop 0
    buffer_load_dwordx4 v5, s[20:23], s58 offen lds
    s_add_u32 m0, s41, 1024
    s_nop 0
    buffer_load_dwordx4 v6, s[20:23], s58 offen lds
    s_add_u32 m0, s41, 2048
    s_nop 0
    buffer_load_dwordx4 v7, s[20:23], s58 offen lds
    s_add_u32 m0, s41, 3072
    s_nop 0
    buffer_load_dwordx4 v8, s[20:23], s58 offen lds
    s_add_u32 m0, s41, 4096
    s_nop 0
    buffer_load_dwordx4 v9, s[20:23], s58 offen lds
    s_mov_b32 s28, s12
    s_mov_b32 s29, s13
    s_mov_b32 s30, 0x1a00000
    s_mov_b32 s31, 0x00020000
    s_add_u32 s52, s12, 0x1900000
    s_addc_u32 s53, s13, 0
    s_mov_b32 s54, 0x1000
    s_mov_b32 s55, 0x00020000
    s_lshl_b32 s35, s2, 7
    v_mov_b32 v12, 0
    buffer_store_dword v12, v12, s[52:55], s35 offen
    s_cmp_eq_u32 s33, 0
    s_cselect_b32 s24, s8, s10
    s_cselect_b32 s25, s9, s11
    s_mov_b32 s26, 25600
    s_mov_b32 s27, 0x00020000
    s_cmp_ge_u32 s33, 2
    s_cbranch_scc1 k1_nokvload
    v_lshlrev_b32 v12, 4, v1
    s_add_u32 s35, s34, 0
    s_min_u32 s35, s35, 24
    s_lshl_b32 s35, s35, 10
    s_add_u32 m0, s35, 131072
    s_mul_i32 s36, s56, 5120
    s_add_u32 s35, s35, s36
    s_sub_u32 s36, s35, 25600
    s_cselect_b32 s35, s35, s36
    buffer_load_dwordx4 v12, s[24:27], s35 offen lds
    s_add_u32 s35, s34, 4
    s_min_u32 s35, s35, 24
    s_lshl_b32 s35, s35, 10
    s_add_u32 m0, s35, 131072
    s_mul_i32 s36, s56, 5120
    s_add_u32 s35, s35, s36
    s_sub_u32 s36, s35, 25600
    s_cselect_b32 s35, s35, s36
    buffer_load_dwordx4 v12, s[24:27], s35 offen lds
    s_add_u32 s35, s34, 8
    s_min_u32 s35, s35, 24
    s_lshl_b32 s35, s35, 10
    s_add_u32 m0, s35, 131072
    s_mul_i32 s36, s56, 5120
    s_add_u32 s35, s35, s36
    s_sub_u32 s36, s35, 25600
    s_cselect_b32 s35, s35, s36
    buffer_load_dwordx4 v12, s[24:27], s35 offen lds
    s_add_u32 s35, s34, 12
    s_min_u32 s35, s35, 24
    s_lshl_b32 s35, s35, 10
    s_add_u32 m0, s35, 131072
    s_mul_i32 s36, s56, 5120
    s_add_u32 s35, s35, s36
    s_sub_u32 s36, s35, 25600
    s_cselect_b32 s35, s35, s36
    buffer_load_dwordx4 v12, s[24:27], s35 offen lds
    s_add_u32 s35, s34, 16
    s_min_u32 s35, s35, 24
    s_lshl_b32 s35, s35, 10
    s_add_u32 m0, s35, 131072
    s_mul_i32 s36, s56, 5120
    s_add_u32 s35, s35, s36
    s_sub_u32 s36, s35, 25600
    s_cselect_b32 s35, s35, s36
    buffer_load_dwordx4 v12, s[24:27], s35 offen lds
    s_add_u32 s35, s34, 20
    s_min_u32 s35, s35, 24
    s_lshl_b32 s35, s35, 10
    s_add_u32 m0, s35, 131072
    s_mul_i32 s36, s56, 5120
    s_add_u32 s35, s35, s36
    s_sub_u32 s36, s35, 25600
    s_cselect_b32 s35, s35, s36
    buffer_load_dwordx4 v12, s[24:27], s35 offen lds
    s_add_u32 s35, s34, 24
    s_min_u32 s35, s35, 24
    s_lshl_b32 s35, s35, 10
    s_add_u32 m0, s35, 131072
    s_mul_i32 s36, s56, 5120
    s_add_u32 s35, s35, s36
    s_sub_u32 s36, s35, 25600
    s_cselect_b32 s35, s35, s36
    buffer_load_dwordx4 v12, s[24:27], s35 offen lds
k1_nokvload:
    s_sub_u32 s57, s56, 4
    s_cselect_b32 s59, 5, 0
    s_add_u32 s57, s57, s59
    s_mul_i32 s58, s57, 163840
    s_add_u32 s58, s58, s37
    s_lshl_b32 s57, s57, 8
    s_add_u32 m0, s43, 16384
    s_nop 0
    buffer_load_dwordx4 v145, s[16:19], s57 offen lds
    s_add_u32 m0, s43, 17408
    s_nop 0
    buffer_load_dwordx4 v146, s[16:19], s57 offen lds
    s_add_u32 m0, s43, 18432
    s_nop 0
    buffer_load_dwordx4 v147, s[16:19], s57 offen lds
    s_add_u32 m0, s43, 19456
    s_nop 0
    buffer_load_dwordx4 v148, s[16:19], s57 offen lds
    s_add_u32 m0, s41, 20480
    s_nop 0
    buffer_load_dwordx4 v5, s[20:23], s58 offen lds
    s_add_u32 m0, s41, 21504
    s_nop 0
    buffer_load_dwordx4 v6, s[20:23], s58 offen lds
    s_add_u32 m0, s41, 22528
    s_nop 0
    buffer_load_dwordx4 v7, s[20:23], s58 offen lds
    s_add_u32 m0, s41, 23552
    s_nop 0
    buffer_load_dwordx4 v8, s[20:23], s58 offen lds
    s_add_u32 m0, s41, 24576
    s_nop 0
    buffer_load_dwordx4 v9, s[20:23], s58 offen lds
    v_lshrrev_b32 v12, 2, v2
    v_lshl_add_u32 v13, v3, 2, v12
    v_mul_u32_u24 v10, 160, v13
    v_and_b32 v14, 3, v2
    v_lshl_add_u32 v10, v14, 3, v10
    v_lshl_add_u32 v13, v3, 3, v12
    v_mul_u32_u24 v11, 40, v13
    v_lshl_add_u32 v11, v14, 3, v11
    v_add_u32 v11, 131072, v11
    v_lshlrev_b32 v15, 8, v2
    v_add_u32 v15, s43, v15
    s_add_u32 s35, s34, 0
    s_and_b32 s44, s35, 3
    s_mul_i32 s35, s44, 5120
    v_add_u32 v132, s35, v10
    s_mul_i32 s35, s44, 1280
    v_add_u32 v136, s35, v11
    s_lshl_b32 s35, s44, 2
    v_add_u32 v12, s35, v3
    v_xor_b32 v12, v12, v2
    v_lshl_add_u32 v149, v12, 4, v15
    s_add_u32 s35, s34, 1
    s_and_b32 s44, s35, 3
    s_mul_i32 s35, s44, 5120
    v_add_u32 v133, s35, v10
    s_mul_i32 s35, s44, 1280
    v_add_u32 v137, s35, v11
    s_lshl_b32 s35, s44, 2
    v_add_u32 v12, s35, v3
    v_xor_b32 v12, v12, v2
    v_lshl_add_u32 v150, v12, 4, v15
    s_add_u32 s35, s34, 2
    s_and_b32 s44, s35, 3
    s_mul_i32 s35, s44, 5120
    v_add_u32 v134, s35, v10
    s_mul_i32 s35, s44, 1280
    v_add_u32 v138, s35, v11
    s_lshl_b32 s35, s44, 2
    v_add_u32 v12, s35, v3
    v_xor_b32 v12, v12, v2
    v_lshl_add_u32 v151, v12, 4, v15
    s_add_u32 s35, s34, 3
    s_and_b32 s44, s35, 3
    s_mul_i32 s35, s44, 5120
    v_add_u32 v135, s35, v10
    s_mul_i32 s35, s44, 1280
    v_add_u32 v139, s35, v11
    s_lshl_b32 s35, s44, 2
    v_add_u32 v12, s35, v3
    v_xor_b32 v12, v12, v2
    v_lshl_add_u32 v152, v12, 4, v15
    s_and_b32 s35, s34, 1
    s_lshl_b32 s35, s35, 4
    v_add_u32 v15, s35, v2
    v_add_u32 v12, 0, v3
    v_mul_u32_u24 v13, 52, v12
    v_lshrrev_b32 v13, 8, v13
    v_mul_u32_u24 v14, 5, v13
    v_sub_u32 v12, v12, v14
    v_lshrrev_b32 v14, 1, v12
    v_lshl_add_u32 v14, v14, 5, v15
    v_lshlrev_b32 v14, 4, v14
    v_and_b32 v140, 1, v12
    v_lshl_add_u32 v14, v140, 3, v14
    v_cmp_eq_u32 vcc, 4, v12
    v_lshlrev_b32 v140, 3, v15
    v_add_u32 v140, 1024, v140
    v_cndmask_b32 v14, v14, v140, vcc
    v_mul_u32_u24 v13, 81920, v13
    v_add_u32 v140, v13, v14
    v_add_u32 v12, 4, v3
    v_mul_u32_u24 v13, 52, v12
    v_lshrrev_b32 v13, 8, v13
    v_mul_u32_u24 v14, 5, v13
    v_sub_u32 v12, v12, v14
    v_lshrrev_b32 v14, 1, v12
    v_lshl_add_u32 v14, v14, 5, v15
    v_lshlrev_b32 v14, 4, v14
    v_and_b32 v141, 1, v12
    v_lshl_add_u32 v14, v141, 3, v14
    v_cmp_eq_u32 vcc, 4, v12
    v_lshlrev_b32 v141, 3, v15
    v_add_u32 v141, 1024, v141
    v_cndmask_b32 v14, v14, v141, vcc
    v_mul_u32_u24 v13, 81920, v13
    v_add_u32 v141, v13, v14
    v_add_u32 v12, 8, v3
    v_mul_u32_u24 v13, 52, v12
    v_lshrrev_b32 v13, 8, v13
    v_mul_u32_u24 v14, 5, v13
    v_sub_u32 v12, v12, v14
    v_lshrrev_b32 v14, 1, v12
    v_lshl_add_u32 v14, v14, 5, v15
    v_lshlrev_b32 v14, 4, v14
    v_and_b32 v142, 1, v12
    v_lshl_add_u32 v14, v142, 3, v14
    v_cmp_eq_u32 vcc, 4, v12
    v_lshlrev_b32 v142, 3, v15
    v_add_u32 v142, 1024, v142
    v_cndmask_b32 v14, v14, v142, vcc
    v_mul_u32_u24 v13, 81920, v13
    v_add_u32 v142, v13, v14
    v_add_u32 v12, 12, v3
    v_mul_u32_u24 v13, 52, v12
    v_lshrrev_b32 v13, 8, v13
    v_mul_u32_u24 v14, 5, v13
    v_sub_u32 v12, v12, v14
    v_lshrrev_b32 v14, 1, v12
    v_lshl_add_u32 v14, v14, 5, v15
    v_lshlrev_b32 v14, 4, v14
    v_and_b32 v143, 1, v12
    v_lshl_add_u32 v14, v143, 3, v14
    v_cmp_eq_u32 vcc, 4, v12
    v_lshlrev_b32 v143, 3, v15
    v_add_u32 v143, 1024, v143
    v_cndmask_b32 v14, v14, v143, vcc
    v_mul_u32_u24 v13, 81920, v13
    v_add_u32 v143, v13, v14
    v_add_u32 v12, 16, v3
    v_mul_u32_u24 v13, 52, v12
    v_lshrrev_b32 v13, 8, v13
    v_mul_u32_u24 v14, 5, v13
    v_sub_u32 v12, v12, v14
    v_lshrrev_b32 v14, 1, v12
    v_lshl_add_u32 v14, v14, 5, v15
    v_lshlrev_b32 v14, 4, v14
    v_and_b32 v144, 1, v12
    v_lshl_add_u32 v14, v144, 3, v14
    v_cmp_eq_u32 vcc, 4, v12
    v_lshlrev_b32 v144, 3, v15
    v_add_u32 v144, 1024, v144
    v_cndmask_b32 v14, v14, v144, vcc
    v_mul_u32_u24 v13, 81920, v13
    v_add_u32 v144, v13, v14
    s_lshl_b32 s42, s33, 8
    s_lshl_b32 s35, s32, 1
    s_add_u32 s42, s42, s35
    s_lshr_b32 s35, s34, 1
    s_add_u32 s42, s42, s35
    s_mul_i32 s42, s42, 1280
    s_add_u32 s42, s42, 0
    s_mov_b32 s38, 0x3f803f80
    v_mov_b32 v20, s38
    v_mov_b32 v21, s38
    v_mov_b32 v22, s38
    v_mov_b32 v23, s38
    v_mov_b32 v16, 0
    v_mov_b32 v17, 0
    v_mov_b32 v18, 0
    v_mov_b32 v19, 0
    v_mov_b32 v160, 0
    v_mov_b32 v161, 0
    v_mov_b32 v162, 0
    v_mov_b32 v163, 0
    v_mov_b32 v164, 0
    v_mov_b32 v165, 0
    v_mov_b32 v166, 0
    v_mov_b32 v167, 0
    v_mov_b32 v168, 0
    v_mov_b32 v169, 0
    v_mov_b32 v170, 0
    v_mov_b32 v171, 0
    v_mov_b32 v172, 0
    v_mov_b32 v173, 0
    v_mov_b32 v174, 0
    v_mov_b32 v175, 0
    v_mov_b32 v176, 0
    v_mov_b32 v177, 0
    v_mov_b32 v178, 0
    v_mov_b32 v179, 0
    v_mov_b32 v180, 0
    v_mov_b32 v181, 0
    v_mov_b32 v182, 0
    v_mov_b32 v183, 0
    v_mov_b32 v184, 0
    v_mov_b32 v185, 0
    v_mov_b32 v186, 0
    v_mov_b32 v187, 0
    v_mov_b32 v188, 0
    v_mov_b32 v189, 0
    v_mov_b32 v190, 0
    v_mov_b32 v191, 0
    v_mov_b32 v192, 0
    v_mov_b32 v193, 0
    v_mov_b32 v194, 0
    v_mov_b32 v195, 0
    v_mov_b32 v196, 0
    v_mov_b32 v197, 0
    v_mov_b32 v198, 0
    v_mov_b32 v199, 0
    v_mov_b32 v200, 0
    v_mov_b32 v201, 0
    v_mov_b32 v202, 0
    v_mov_b32 v203, 0
    v_mov_b32 v204, 0
    v_mov_b32 v205, 0
    v_mov_b32 v206, 0
    v_mov_b32 v207, 0
    v_mov_b32 v208, 0
    v_mov_b32 v209, 0
    v_mov_b32 v210, 0
    v_mov_b32 v211, 0
    v_mov_b32 v212, 0
    v_mov_b32 v213, 0
    v_mov_b32 v214, 0
    v_mov_b32 v215, 0
    s_cmp_eq_u32 s33, 0
    s_cbranch_scc1 k1_loop_k
    s_cmp_eq_u32 s33, 1
    s_cbranch_scc1 k1_loop_v
    s_waitcnt vmcnt(10)
    ds_read_b128 v[24:27], v149 offset:0
    ds_read_b128 v[28:31], v150 offset:0
    ds_read_b128 v[32:35], v151 offset:0
    ds_read_b128 v[36:39], v152 offset:0
    s_barrier
    ds_read_b64_tr_b16 v[104:105], v132 offset:0
    ds_read_b64_tr_b16 v[106:107], v132 offset:2560
    ds_read_b64_tr_b16 v[108:109], v132 offset:32
    ds_read_b64_tr_b16 v[110:111], v132 offset:2592
    ds_read_b64_tr_b16 v[112:113], v132 offset:64
    ds_read_b64_tr_b16 v[114:115], v132 offset:2624
    ds_read_b64_tr_b16 v[116:117], v132 offset:96
    ds_read_b64_tr_b16 v[118:119], v132 offset:2656
    ds_read_b64_tr_b16 v[120:121], v132 offset:128
    ds_read_b64_tr_b16 v[122:123], v132 offset:2688
    s_waitcnt lgkmcnt(8)
    v_dot2_f32_bf16 v16, v24, v20, v16
    v_dot2_f32_bf16 v18, v24, v24, v18
    v_dot2_f32_bf16 v17, v25, v20, v17
    v_dot2_f32_bf16 v19, v25, v25, v19
    v_dot2_f32_bf16 v16, v26, v20, v16
    v_dot2_f32_bf16 v18, v26, v26, v18
    v_dot2_f32_bf16 v17, v27, v20, v17
    v_dot2_f32_bf16 v19, v27, v27, v19
    v_dot2_f32_bf16 v16, v28, v20, v16
    v_dot2_f32_bf16 v18, v28, v28, v18
    v_dot2_f32_bf16 v17, v29, v20, v17
    v_dot2_f32_bf16 v19, v29, v29, v19
    v_dot2_f32_bf16 v16, v30, v20, v16
    v_dot2_f32_bf16 v18, v30, v30, v18
    v_dot2_f32_bf16 v17, v31, v20, v17
    v_dot2_f32_bf16 v19, v31, v31, v19
    v_dot2_f32_bf16 v16, v32, v20, v16
    v_dot2_f32_bf16 v18, v32, v32, v18
    v_dot2_f32_bf16 v17, v33, v20, v17
    v_dot2_f32_bf16 v19, v33, v33, v19
    v_dot2_f32_bf16 v16, v34, v20, v16
    v_dot2_f32_bf16 v18, v34, v34, v18
    v_dot2_f32_bf16 v17, v35, v20, v17
    v_dot2_f32_bf16 v19, v35, v35, v19
    v_dot2_f32_bf16 v16, v36, v20, v16
    v_dot2_f32_bf16 v18, v36, v36, v18
    v_dot2_f32_bf16 v17, v37, v20, v17
    v_dot2_f32_bf16 v19, v37, v37, v19
    v_dot2_f32_bf16 v16, v38, v20, v16
    v_dot2_f32_bf16 v18, v38, v38, v18
    v_dot2_f32_bf16 v17, v39, v20, v17
    v_dot2_f32_bf16 v19, v39, v39, v19
    v_mfma_f32_16x16x32_bf16 v[160:163], v[104:107], v[24:27], v[160:163]
    v_mfma_f32_16x16x32_bf16 v[188:191], v[20:23], v[104:107], v[188:191]
    ds_read_b64_tr_b16 v[124:125], v133 offset:0
    ds_read_b64_tr_b16 v[126:127], v133 offset:2560
    s_sub_u32 s57, s56, 3
    s_cselect_b32 s59, 5, 0
    s_add_u32 s57, s57, s59
    s_mul_i32 s58, s57, 163840
    s_add_u32 s58, s58, s37
    s_lshl_b32 s57, s57, 8
    s_add_u32 m0, s43, 32768
    s_nop 0
    buffer_load_dwordx4 v145, s[16:19], s57 offen lds
    s_waitcnt lgkmcnt(8)
    v_mfma_f32_16x16x32_bf16 v[164:167], v[108:111], v[24:27], v[164:167]
    v_mfma_f32_16x16x32_bf16 v[192:195], v[20:23], v[108:111], v[192:195]
    ds_read_b64_tr_b16 v[104:105], v133 offset:32
    ds_read_b64_tr_b16 v[106:107], v133 offset:2592
    s_add_u32 m0, s43, 33792
    s_nop 0
    buffer_load_dwordx4 v146, s[16:19], s57 offen lds
    s_waitcnt lgkmcnt(8)
    v_mfma_f32_16x16x32_bf16 v[168:171], v[112:115], v[24:27], v[168:171]
    v_mfma_f32_16x16x32_bf16 v[196:199], v[20:23], v[112:115], v[196:199]
    ds_read_b64_tr_b16 v[108:109], v133 offset:64
    ds_read_b64_tr_b16 v[110:111], v133 offset:2624
    s_add_u32 m0, s43, 34816
    s_nop 0
    buffer_load_dwordx4 v147, s[16:19], s57 offen lds
    s_waitcnt lgkmcnt(8)
    v_mfma_f32_16x16x32_bf16 v[172:175], v[116:119], v[24:27], v[172:175]
    v_mfma_f32_16x16x32_bf16 v[200:203], v[20:23], v[116:119], v[200:203]
    ds_read_b64_tr_b16 v[112:113], v133 offset:96
    ds_read_b64_tr_b16 v[114:115], v133 offset:2656
    s_add_u32 m0, s43, 35840
    s_nop 0
    buffer_load_dwordx4 v148, s[16:19], s57 offen lds
    s_waitcnt lgkmcnt(8)
    v_mfma_f32_16x16x32_bf16 v[176:179], v[120:123], v[24:27], v[176:179]
    v_mfma_f32_16x16x32_bf16 v[204:207], v[20:23], v[120:123], v[204:207]
    ds_read_b64_tr_b16 v[116:117], v133 offset:128
    ds_read_b64_tr_b16 v[118:119], v133 offset:2688
    s_add_u32 m0, s41, 40960
    s_nop 0
    buffer_load_dwordx4 v5, s[20:23], s58 offen lds
    s_waitcnt lgkmcnt(8)
    v_mfma_f32_16x16x32_bf16 v[160:163], v[124:127], v[28:31], v[160:163]
    ds_read_b64_tr_b16 v[120:121], v134 offset:0
    ds_read_b64_tr_b16 v[122:123], v134 offset:2560
    s_add_u32 m0, s41, 41984
    s_nop 0
    buffer_load_dwordx4 v6, s[20:23], s58 offen lds
    s_waitcnt lgkmcnt(8)
    v_mfma_f32_16x16x32_bf16 v[164:167], v[104:107], v[28:31], v[164:167]
    ds_read_b64_tr_b16 v[124:125], v134 offset:32
    ds_read_b64_tr_b16 v[126:127], v134 offset:2592
    s_add_u32 m0, s41, 43008
    s_nop 0
    buffer_load_dwordx4 v7, s[20:23], s58 offen lds
    s_waitcnt lgkmcnt(8)
    v_mfma_f32_16x16x32_bf16 v[168:171], v[108:111], v[28:31], v[168:171]
    ds_read_b64_tr_b16 v[104:105], v134 offset:64
    ds_read_b64_tr_b16 v[106:107], v134 offset:2624
    s_add_u32 m0, s41, 44032
    s_nop 0
    buffer_load_dwordx4 v8, s[20:23], s58 offen lds
    s_waitcnt lgkmcnt(8)
    v_mfma_f32_16x16x32_bf16 v[172:175], v[112:115], v[28:31], v[172:175]
    ds_read_b64_tr_b16 v[108:109], v134 offset:96
    ds_read_b64_tr_b16 v[110:111], v134 offset:2656
    s_add_u32 m0, s41, 45056
    s_nop 0
    buffer_load_dwordx4 v9, s[20:23], s58 offen lds
    s_waitcnt lgkmcnt(8)
    v_mfma_f32_16x16x32_bf16 v[176:179], v[116:119], v[28:31], v[176:179]
    ds_read_b64_tr_b16 v[112:113], v134 offset:128
    ds_read_b64_tr_b16 v[114:115], v134 offset:2688
    s_waitcnt lgkmcnt(8)
    v_mfma_f32_16x16x32_bf16 v[160:163], v[120:123], v[32:35], v[160:163]
    ds_read_b64_tr_b16 v[116:117], v135 offset:0
    ds_read_b64_tr_b16 v[118:119], v135 offset:2560
    s_waitcnt lgkmcnt(8)
    v_mfma_f32_16x16x32_bf16 v[164:167], v[124:127], v[32:35], v[164:167]
    ds_read_b64_tr_b16 v[120:121], v135 offset:32
    ds_read_b64_tr_b16 v[122:123], v135 offset:2592
    s_waitcnt lgkmcnt(8)
    v_mfma_f32_16x16x32_bf16 v[168:171], v[104:107], v[32:35], v[168:171]
    ds_read_b64_tr_b16 v[124:125], v135 offset:64
    ds_read_b64_tr_b16 v[126:127], v135 offset:2624
    s_waitcnt lgkmcnt(8)
    v_mfma_f32_16x16x32_bf16 v[172:175], v[108:111], v[32:35], v[172:175]
    ds_read_b64_tr_b16 v[104:105], v135 offset:96
    ds_read_b64_tr_b16 v[106:107], v135 offset:2656
    s_waitcnt lgkmcnt(8)
    v_mfma_f32_16x16x32_bf16 v[176:179], v[112:115], v[32:35], v[176:179]
    ds_read_b64_tr_b16 v[108:109], v135 offset:128
    ds_read_b64_tr_b16 v[110:111], v135 offset:2688
    s_waitcnt lgkmcnt(8)
    v_mfma_f32_16x16x32_bf16 v[160:163], v[116:119], v[36:39], v[160:163]
    s_waitcnt vmcnt(9)
    ds_read_b128 v[40:43], v149 offset:16384
    ds_read_b128 v[44:47], v150 offset:16384
    ds_read_b128 v[48:51], v151 offset:16384
    ds_read_b128 v[52:55], v152 offset:16384
    s_barrier
    ds_read_b64_tr_b16 v[112:113], v132 offset:20480
    ds_read_b64_tr_b16 v[114:115], v132 offset:23040
    s_waitcnt lgkmcnt(8)
    v_mfma_f32_16x16x32_bf16 v[164:167], v[120:123], v[36:39], v[164:167]
    ds_read_b64_tr_b16 v[116:117], v132 offset:20512
    ds_read_b64_tr_b16 v[118:119], v132 offset:23072
    s_waitcnt lgkmcnt(8)
    v_mfma_f32_16x16x32_bf16 v[168:171], v[124:127], v[36:39], v[168:171]
    ds_read_b64_tr_b16 v[120:121], v132 offset:20544
    ds_read_b64_tr_b16 v[122:123], v132 offset:23104
    s_waitcnt lgkmcnt(8)
    v_mfma_f32_16x16x32_bf16 v[172:175], v[104:107], v[36:39], v[172:175]
    ds_read_b64_tr_b16 v[124:125], v132 offset:20576
    ds_read_b64_tr_b16 v[126:127], v132 offset:23136
    s_waitcnt lgkmcnt(8)
    v_mfma_f32_16x16x32_bf16 v[176:179], v[108:111], v[36:39], v[176:179]
    ds_read_b64_tr_b16 v[104:105], v132 offset:20608
    ds_read_b64_tr_b16 v[106:107], v132 offset:23168
    s_waitcnt lgkmcnt(8)
    v_dot2_f32_bf16 v16, v40, v20, v16
    v_dot2_f32_bf16 v18, v40, v40, v18
    v_dot2_f32_bf16 v17, v41, v20, v17
    v_dot2_f32_bf16 v19, v41, v41, v19
    v_dot2_f32_bf16 v16, v42, v20, v16
    v_dot2_f32_bf16 v18, v42, v42, v18
    v_dot2_f32_bf16 v17, v43, v20, v17
    v_dot2_f32_bf16 v19, v43, v43, v19
    v_dot2_f32_bf16 v16, v44, v20, v16
    v_dot2_f32_bf16 v18, v44, v44, v18
    v_dot2_f32_bf16 v17, v45, v20, v17
    v_dot2_f32_bf16 v19, v45, v45, v19
    v_dot2_f32_bf16 v16, v46, v20, v16
    v_dot2_f32_bf16 v18, v46, v46, v18
    v_dot2_f32_bf16 v17, v47, v20, v17
    v_dot2_f32_bf16 v19, v47, v47, v19
    v_dot2_f32_bf16 v16, v48, v20, v16
    v_dot2_f32_bf16 v18, v48, v48, v18
    v_dot2_f32_bf16 v17, v49, v20, v17
    v_dot2_f32_bf16 v19, v49, v49, v19
    v_dot2_f32_bf16 v16, v50, v20, v16
    v_dot2_f32_bf16 v18, v50, v50, v18
    v_dot2_f32_bf16 v17, v51, v20, v17
    v_dot2_f32_bf16 v19, v51, v51, v19
    v_dot2_f32_bf16 v16, v52, v20, v16
    v_dot2_f32_bf16 v18, v52, v52, v18
    v_dot2_f32_bf16 v17, v53, v20, v17
    v_dot2_f32_bf16 v19, v53, v53, v19
    v_dot2_f32_bf16 v16, v54, v20, v16
    v_dot2_f32_bf16 v18, v54, v54, v18
    v_dot2_f32_bf16 v17, v55, v20, v17
    v_dot2_f32_bf16 v19, v55, v55, v19
    v_mfma_f32_16x16x32_bf16 v[160:163], v[112:115], v[40:43], v[160:163]
    v_mfma_f32_16x16x32_bf16 v[188:191], v[20:23], v[112:115], v[188:191]
    ds_read_b64_tr_b16 v[108:109], v133 offset:20480
    ds_read_b64_tr_b16 v[110:111], v133 offset:23040
    s_sub_u32 s57, s56, 2
    s_cselect_b32 s59, 5, 0
    s_add_u32 s57, s57, s59
    s_mul_i32 s58, s57, 163840
    s_add_u32 s58, s58, s37
    s_lshl_b32 s57, s57, 8
    s_add_u32 m0, s43, 0
    s_nop 0
    buffer_load_dwordx4 v145, s[16:19], s57 offen lds
    s_waitcnt lgkmcnt(8)
    v_mfma_f32_16x16x32_bf16 v[164:167], v[116:119], v[40:43], v[164:167]
    v_mfma_f32_16x16x32_bf16 v[192:195], v[20:23], v[116:119], v[192:195]
    ds_read_b64_tr_b16 v[112:113], v133 offset:20512
    ds_read_b64_tr_b16 v[114:115], v133 offset:23072
    s_add_u32 m0, s43, 1024
    s_nop 0
    buffer_load_dwordx4 v146, s[16:19], s57 offen lds
    s_waitcnt lgkmcnt(8)
    v_mfma_f32_16x16x32_bf16 v[168:171], v[120:123], v[40:43], v[168:171]
    v_mfma_f32_16x16x32_bf16 v[196:199], v[20:23], v[120:123], v[196:199]
    ds_read_b64_tr_b16 v[116:117], v133 offset:20544
    ds_read_b64_tr_b16 v[118:119], v133 offset:23104
    s_add_u32 m0, s43, 2048
    s_nop 0
    buffer_load_dwordx4 v147, s[16:19], s57 offen lds
    s_waitcnt lgkmcnt(8)
    v_mfma_f32_16x16x32_bf16 v[172:175], v[124:127], v[40:43], v[172:175]
    v_mfma_f32_16x16x32_bf16 v[200:203], v[20:23], v[124:127], v[200:203]
    ds_read_b64_tr_b16 v[120:121], v133 offset:20576
    ds_read_b64_tr_b16 v[122:123], v133 offset:23136
    s_add_u32 m0, s43, 3072
    s_nop 0
    buffer_load_dwordx4 v148, s[16:19], s57 offen lds
    s_waitcnt lgkmcnt(8)
    v_mfma_f32_16x16x32_bf16 v[176:179], v[104:107], v[40:43], v[176:179]
    v_mfma_f32_16x16x32_bf16 v[204:207], v[20:23], v[104:107], v[204:207]
    ds_read_b64_tr_b16 v[124:125], v133 offset:20608
    ds_read_b64_tr_b16 v[126:127], v133 offset:23168
    s_add_u32 m0, s41, 61440
    s_nop 0
    buffer_load_dwordx4 v5, s[20:23], s58 offen lds
    s_waitcnt lgkmcnt(8)
    v_mfma_f32_16x16x32_bf16 v[160:163], v[108:111], v[44:47], v[160:163]
    ds_read_b64_tr_b16 v[104:105], v134 offset:20480
    ds_read_b64_tr_b16 v[106:107], v134 offset:23040
    s_add_u32 m0, s41, 62464
    s_nop 0
    buffer_load_dwordx4 v6, s[20:23], s58 offen lds
    s_waitcnt lgkmcnt(8)
    v_mfma_f32_16x16x32_bf16 v[164:167], v[112:115], v[44:47], v[164:167]
    ds_read_b64_tr_b16 v[108:109], v134 offset:20512
    ds_read_b64_tr_b16 v[110:111], v134 offset:23072
    s_add_u32 m0, s41, 63488
    s_nop 0
    buffer_load_dwordx4 v7, s[20:23], s58 offen lds
    s_waitcnt lgkmcnt(8)
    v_mfma_f32_16x16x32_bf16 v[168:171], v[116:119], v[44:47], v[168:171]
    ds_read_b64_tr_b16 v[112:113], v134 offset:20544
    ds_read_b64_tr_b16 v[114:115], v134 offset:23104
    s_add_u32 m0, s41, 64512
    s_nop 0
    buffer_load_dwordx4 v8, s[20:23], s58 offen lds
    s_waitcnt lgkmcnt(8)
    v_mfma_f32_16x16x32_bf16 v[172:175], v[120:123], v[44:47], v[172:175]
    ds_read_b64_tr_b16 v[116:117], v134 offset:20576
    ds_read_b64_tr_b16 v[118:119], v134 offset:23136
    s_add_u32 m0, s41, 65536
    s_nop 0
    buffer_load_dwordx4 v9, s[20:23], s58 offen lds
    s_waitcnt lgkmcnt(8)
    v_mfma_f32_16x16x32_bf16 v[176:179], v[124:127], v[44:47], v[176:179]
    ds_read_b64_tr_b16 v[120:121], v134 offset:20608
    ds_read_b64_tr_b16 v[122:123], v134 offset:23168
    s_waitcnt lgkmcnt(8)
    v_mfma_f32_16x16x32_bf16 v[160:163], v[104:107], v[48:51], v[160:163]
    ds_read_b64_tr_b16 v[124:125], v135 offset:20480
    ds_read_b64_tr_b16 v[126:127], v135 offset:23040
    s_waitcnt lgkmcnt(8)
    v_mfma_f32_16x16x32_bf16 v[164:167], v[108:111], v[48:51], v[164:167]
    ds_read_b64_tr_b16 v[104:105], v135 offset:20512
    ds_read_b64_tr_b16 v[106:107], v135 offset:23072
    s_waitcnt lgkmcnt(8)
    v_mfma_f32_16x16x32_bf16 v[168:171], v[112:115], v[48:51], v[168:171]
    ds_read_b64_tr_b16 v[108:109], v135 offset:20544
    ds_read_b64_tr_b16 v[110:111], v135 offset:23104
    s_waitcnt lgkmcnt(8)
    v_mfma_f32_16x16x32_bf16 v[172:175], v[116:119], v[48:51], v[172:175]
    ds_read_b64_tr_b16 v[112:113], v135 offset:20576
    ds_read_b64_tr_b16 v[114:115], v135 offset:23136
    s_waitcnt lgkmcnt(8)
    v_mfma_f32_16x16x32_bf16 v[176:179], v[120:123], v[48:51], v[176:179]
    ds_read_b64_tr_b16 v[116:117], v135 offset:20608
    ds_read_b64_tr_b16 v[118:119], v135 offset:23168
    s_waitcnt lgkmcnt(8)
    v_mfma_f32_16x16x32_bf16 v[160:163], v[124:127], v[52:55], v[160:163]
    s_waitcnt vmcnt(9)
    ds_read_b128 v[24:27], v149 offset:32768
    ds_read_b128 v[28:31], v150 offset:32768
    ds_read_b128 v[32:35], v151 offset:32768
    ds_read_b128 v[36:39], v152 offset:32768
    s_barrier
    ds_read_b64_tr_b16 v[120:121], v132 offset:40960
    ds_read_b64_tr_b16 v[122:123], v132 offset:43520
    s_waitcnt lgkmcnt(8)
    v_mfma_f32_16x16x32_bf16 v[164:167], v[104:107], v[52:55], v[164:167]
    ds_read_b64_tr_b16 v[124:125], v132 offset:40992
    ds_read_b64_tr_b16 v[126:127], v132 offset:43552
    s_waitcnt lgkmcnt(8)
    v_mfma_f32_16x16x32_bf16 v[168:171], v[108:111], v[52:55], v[168:171]
    ds_read_b64_tr_b16 v[104:105], v132 offset:41024
    ds_read_b64_tr_b16 v[106:107], v132 offset:43584
    s_waitcnt lgkmcnt(8)
    v_mfma_f32_16x16x32_bf16 v[172:175], v[112:115], v[52:55], v[172:175]
    ds_read_b64_tr_b16 v[108:109], v132 offset:41056
    ds_read_b64_tr_b16 v[110:111], v132 offset:43616
    s_waitcnt lgkmcnt(8)
    v_mfma_f32_16x16x32_bf16 v[176:179], v[116:119], v[52:55], v[176:179]
    ds_read_b64_tr_b16 v[112:113], v132 offset:41088
    ds_read_b64_tr_b16 v[114:115], v132 offset:43648
    s_waitcnt lgkmcnt(8)
    v_dot2_f32_bf16 v16, v24, v20, v16
    v_dot2_f32_bf16 v18, v24, v24, v18
    v_dot2_f32_bf16 v17, v25, v20, v17
    v_dot2_f32_bf16 v19, v25, v25, v19
    v_dot2_f32_bf16 v16, v26, v20, v16
    v_dot2_f32_bf16 v18, v26, v26, v18
    v_dot2_f32_bf16 v17, v27, v20, v17
    v_dot2_f32_bf16 v19, v27, v27, v19
    v_dot2_f32_bf16 v16, v28, v20, v16
    v_dot2_f32_bf16 v18, v28, v28, v18
    v_dot2_f32_bf16 v17, v29, v20, v17
    v_dot2_f32_bf16 v19, v29, v29, v19
    v_dot2_f32_bf16 v16, v30, v20, v16
    v_dot2_f32_bf16 v18, v30, v30, v18
    v_dot2_f32_bf16 v17, v31, v20, v17
    v_dot2_f32_bf16 v19, v31, v31, v19
    v_dot2_f32_bf16 v16, v32, v20, v16
    v_dot2_f32_bf16 v18, v32, v32, v18
    v_dot2_f32_bf16 v17, v33, v20, v17
    v_dot2_f32_bf16 v19, v33, v33, v19
    v_dot2_f32_bf16 v16, v34, v20, v16
    v_dot2_f32_bf16 v18, v34, v34, v18
    v_dot2_f32_bf16 v17, v35, v20, v17
    v_dot2_f32_bf16 v19, v35, v35, v19
    v_dot2_f32_bf16 v16, v36, v20, v16
    v_dot2_f32_bf16 v18, v36, v36, v18
    v_dot2_f32_bf16 v17, v37, v20, v17
    v_dot2_f32_bf16 v19, v37, v37, v19
    v_dot2_f32_bf16 v16, v38, v20, v16
    v_dot2_f32_bf16 v18, v38, v38, v18
    v_dot2_f32_bf16 v17, v39, v20, v17
    v_dot2_f32_bf16 v19, v39, v39, v19
    v_mfma_f32_16x16x32_bf16 v[160:163], v[120:123], v[24:27], v[160:163]
    v_mfma_f32_16x16x32_bf16 v[188:191], v[20:23], v[120:123], v[188:191]
    ds_read_b64_tr_b16 v[116:117], v133 offset:40960
    ds_read_b64_tr_b16 v[118:119], v133 offset:43520
    s_sub_u32 s57, s56, 1
    s_cselect_b32 s59, 5, 0
    s_add_u32 s57, s57, s59
    s_mul_i32 s58, s57, 163840
    s_add_u32 s58, s58, s37
    s_lshl_b32 s57, s57, 8
    s_add_u32 m0, s43, 16384
    s_nop 0
    buffer_load_dwordx4 v145, s[16:19], s57 offen lds
    s_waitcnt lgkmcnt(8)
    v_mfma_f32_16x16x32_bf16 v[164:167], v[124:127], v[24:27], v[164:167]
    v_mfma_f32_16x16x32_bf16 v[192:195], v[20:23], v[124:127], v[192:195]
    ds_read_b64_tr_b16 v[120:121], v133 offset:40992
    ds_read_b64_tr_b16 v[122:123], v133 offset:43552
    s_add_u32 m0, s43, 17408
    s_nop 0
    buffer_load_dwordx4 v146, s[16:19], s57 offen lds
    s_waitcnt lgkmcnt(8)
    v_mfma_f32_16x16x32_bf16 v[168:171], v[104:107], v[24:27], v[168:171]
    v_mfma_f32_16x16x32_bf16 v[196:199], v[20:23], v[104:107], v[196:199]
    ds_read_b64_tr_b16 v[124:125], v133 offset:41024
    ds_read_b64_tr_b16 v[126:127], v133 offset:43584
    s_add_u32 m0, s43, 18432
    s_nop 0
    buffer_load_dwordx4 v147, s[16:19], s57 offen lds
    s_waitcnt lgkmcnt(8)
    v_mfma_f32_16x16x32_bf16 v[172:175], v[108:111], v[24:27], v[172:175]
    v_mfma_f32_16x16x32_bf16 v[200:203], v[20:23], v[108:111], v[200:203]
    ds_read_b64_tr_b16 v[104:105], v133 offset:41056
    ds_read_b64_tr_b16 v[106:107], v133 offset:43616
    s_add_u32 m0, s43, 19456
    s_nop 0
    buffer_load_dwordx4 v148, s[16:19], s57 offen lds
    s_waitcnt lgkmcnt(8)
    v_mfma_f32_16x16x32_bf16 v[176:179], v[112:115], v[24:27], v[176:179]
    v_mfma_f32_16x16x32_bf16 v[204:207], v[20:23], v[112:115], v[204:207]
    ds_read_b64_tr_b16 v[108:109], v133 offset:41088
    ds_read_b64_tr_b16 v[110:111], v133 offset:43648
    s_add_u32 m0, s41, 0
    s_nop 0
    buffer_load_dwordx4 v5, s[20:23], s58 offen lds
    s_waitcnt lgkmcnt(8)
    v_mfma_f32_16x16x32_bf16 v[160:163], v[116:119], v[28:31], v[160:163]
    ds_read_b64_tr_b16 v[112:113], v134 offset:40960
    ds_read_b64_tr_b16 v[114:115], v134 offset:43520
    s_add_u32 m0, s41, 1024
    s_nop 0
    buffer_load_dwordx4 v6, s[20:23], s58 offen lds
    s_waitcnt lgkmcnt(8)
    v_mfma_f32_16x16x32_bf16 v[164:167], v[120:123], v[28:31], v[164:167]
    ds_read_b64_tr_b16 v[116:117], v134 offset:40992
    ds_read_b64_tr_b16 v[118:119], v134 offset:43552
    s_add_u32 m0, s41, 2048
    s_nop 0
    buffer_load_dwordx4 v7, s[20:23], s58 offen lds
    s_waitcnt lgkmcnt(8)
    v_mfma_f32_16x16x32_bf16 v[168:171], v[124:127], v[28:31], v[168:171]
    ds_read_b64_tr_b16 v[120:121], v134 offset:41024
    ds_read_b64_tr_b16 v[122:123], v134 offset:43584
    s_add_u32 m0, s41, 3072
    s_nop 0
    buffer_load_dwordx4 v8, s[20:23], s58 offen lds
    s_waitcnt lgkmcnt(8)
    v_mfma_f32_16x16x32_bf16 v[172:175], v[104:107], v[28:31], v[172:175]
    ds_read_b64_tr_b16 v[124:125], v134 offset:41056
    ds_read_b64_tr_b16 v[126:127], v134 offset:43616
    s_add_u32 m0, s41, 4096
    s_nop 0
    buffer_load_dwordx4 v9, s[20:23], s58 offen lds
    s_waitcnt lgkmcnt(8)
    v_mfma_f32_16x16x32_bf16 v[176:179], v[108:111], v[28:31], v[176:179]
    ds_read_b64_tr_b16 v[104:105], v134 offset:41088
    ds_read_b64_tr_b16 v[106:107], v134 offset:43648
    s_waitcnt lgkmcnt(8)
    v_mfma_f32_16x16x32_bf16 v[160:163], v[112:115], v[32:35], v[160:163]
    ds_read_b64_tr_b16 v[108:109], v135 offset:40960
    ds_read_b64_tr_b16 v[110:111], v135 offset:43520
    s_waitcnt lgkmcnt(8)
    v_mfma_f32_16x16x32_bf16 v[164:167], v[116:119], v[32:35], v[164:167]
    ds_read_b64_tr_b16 v[112:113], v135 offset:40992
    ds_read_b64_tr_b16 v[114:115], v135 offset:43552
    s_waitcnt lgkmcnt(8)
    v_mfma_f32_16x16x32_bf16 v[168:171], v[120:123], v[32:35], v[168:171]
    ds_read_b64_tr_b16 v[116:117], v135 offset:41024
    ds_read_b64_tr_b16 v[118:119], v135 offset:43584
    s_waitcnt lgkmcnt(8)
    v_mfma_f32_16x16x32_bf16 v[172:175], v[124:127], v[32:35], v[172:175]
    ds_read_b64_tr_b16 v[120:121], v135 offset:41056
    ds_read_b64_tr_b16 v[122:123], v135 offset:43616
    s_waitcnt lgkmcnt(8)
    v_mfma_f32_16x16x32_bf16 v[176:179], v[104:107], v[32:35], v[176:179]
    ds_read_b64_tr_b16 v[124:125], v135 offset:41088
    ds_read_b64_tr_b16 v[126:127], v135 offset:43648
    s_waitcnt lgkmcnt(8)
    v_mfma_f32_16x16x32_bf16 v[160:163], v[108:111], v[36:39], v[160:163]
    s_waitcnt vmcnt(9)
    ds_read_b128 v[40:43], v149 offset:0
    ds_read_b128 v[44:47], v150 offset:0
    ds_read_b128 v[48:51], v151 offset:0
    ds_read_b128 v[52:55], v152 offset:0
    s_barrier
    ds_read_b64_tr_b16 v[104:105], v132 offset:61440
    ds_read_b64_tr_b16 v[106:107], v132 offset:64000
    s_waitcnt lgkmcnt(8)
    v_mfma_f32_16x16x32_bf16 v[164:167], v[112:115], v[36:39], v[164:167]
    ds_read_b64_tr_b16 v[108:109], v132 offset:61472
    ds_read_b64_tr_b16 v[110:111], v132 offset:64032
    s_waitcnt lgkmcnt(8)
    v_mfma_f32_16x16x32_bf16 v[168:171], v[116:119], v[36:39], v[168:171]
    ds_read_b64_tr_b16 v[112:113], v132 offset:61504
    ds_read_b64_tr_b16 v[114:115], v132 offset:64064
    s_waitcnt lgkmcnt(8)
    v_mfma_f32_16x16x32_bf16 v[172:175], v[120:123], v[36:39], v[172:175]
    ds_read_b64_tr_b16 v[116:117], v132 offset:61536
    ds_read_b64_tr_b16 v[118:119], v132 offset:64096
    s_waitcnt lgkmcnt(8)
    v_mfma_f32_16x16x32_bf16 v[176:179], v[124:127], v[36:39], v[176:179]
    ds_read_b64_tr_b16 v[120:121], v132 offset:61568
    ds_read_b64_tr_b16 v[122:123], v132 offset:64128
    s_waitcnt lgkmcnt(8)
    v_dot2_f32_bf16 v16, v40, v20, v16
    v_dot2_f32_bf16 v18, v40, v40, v18
    v_dot2_f32_bf16 v17, v41, v20, v17
    v_dot2_f32_bf16 v19, v41, v41, v19
    v_dot2_f32_bf16 v16, v42, v20, v16
    v_dot2_f32_bf16 v18, v42, v42, v18
    v_dot2_f32_bf16 v17, v43, v20, v17
    v_dot2_f32_bf16 v19, v43, v43, v19
    v_dot2_f32_bf16 v16, v44, v20, v16
    v_dot2_f32_bf16 v18, v44, v44, v18
    v_dot2_f32_bf16 v17, v45, v20, v17
    v_dot2_f32_bf16 v19, v45, v45, v19
    v_dot2_f32_bf16 v16, v46, v20, v16
    v_dot2_f32_bf16 v18, v46, v46, v18
    v_dot2_f32_bf16 v17, v47, v20, v17
    v_dot2_f32_bf16 v19, v47, v47, v19
    v_dot2_f32_bf16 v16, v48, v20, v16
    v_dot2_f32_bf16 v18, v48, v48, v18
    v_dot2_f32_bf16 v17, v49, v20, v17
    v_dot2_f32_bf16 v19, v49, v49, v19
    v_dot2_f32_bf16 v16, v50, v20, v16
    v_dot2_f32_bf16 v18, v50, v50, v18
    v_dot2_f32_bf16 v17, v51, v20, v17
    v_dot2_f32_bf16 v19, v51, v51, v19
    v_dot2_f32_bf16 v16, v52, v20, v16
    v_dot2_f32_bf16 v18, v52, v52, v18
    v_dot2_f32_bf16 v17, v53, v20, v17
    v_dot2_f32_bf16 v19, v53, v53, v19
    v_dot2_f32_bf16 v16, v54, v20, v16
    v_dot2_f32_bf16 v18, v54, v54, v18
    v_dot2_f32_bf16 v17, v55, v20, v17
    v_dot2_f32_bf16 v19, v55, v55, v19
    v_mfma_f32_16x16x32_bf16 v[160:163], v[104:107], v[40:43], v[160:163]
    v_mfma_f32_16x16x32_bf16 v[188:191], v[20:23], v[104:107], v[188:191]
    ds_read_b64_tr_b16 v[124:125], v133 offset:61440
    ds_read_b64_tr_b16 v[126:127], v133 offset:64000
    s_waitcnt lgkmcnt(8)
    v_mfma_f32_16x16x32_bf16 v[164:167], v[108:111], v[40:43], v[164:167]
    v_mfma_f32_16x16x32_bf16 v[192:195], v[20:23], v[108:111], v[192:195]
    ds_read_b64_tr_b16 v[104:105], v133 offset:61472
    ds_read_b64_tr_b16 v[106:107], v133 offset:64032
    s_waitcnt lgkmcnt(8)
    v_mfma_f32_16x16x32_bf16 v[168:171], v[112:115], v[40:43], v[168:171]
    v_mfma_f32_16x16x32_bf16 v[196:199], v[20:23], v[112:115], v[196:199]
    ds_read_b64_tr_b16 v[108:109], v133 offset:61504
    ds_read_b64_tr_b16 v[110:111], v133 offset:64064
    s_waitcnt lgkmcnt(8)
    v_mfma_f32_16x16x32_bf16 v[172:175], v[116:119], v[40:43], v[172:175]
    v_mfma_f32_16x16x32_bf16 v[200:203], v[20:23], v[116:119], v[200:203]
    ds_read_b64_tr_b16 v[112:113], v133 offset:61536
    ds_read_b64_tr_b16 v[114:115], v133 offset:64096
    s_waitcnt lgkmcnt(8)
    v_mfma_f32_16x16x32_bf16 v[176:179], v[120:123], v[40:43], v[176:179]
    v_mfma_f32_16x16x32_bf16 v[204:207], v[20:23], v[120:123], v[204:207]
    ds_read_b64_tr_b16 v[116:117], v133 offset:61568
    ds_read_b64_tr_b16 v[118:119], v133 offset:64128
    s_waitcnt lgkmcnt(8)
    v_mfma_f32_16x16x32_bf16 v[160:163], v[124:127], v[44:47], v[160:163]
    ds_read_b64_tr_b16 v[120:121], v134 offset:61440
    ds_read_b64_tr_b16 v[122:123], v134 offset:64000
    s_waitcnt lgkmcnt(8)
    v_mfma_f32_16x16x32_bf16 v[164:167], v[104:107], v[44:47], v[164:167]
    ds_read_b64_tr_b16 v[124:125], v134 offset:61472
    ds_read_b64_tr_b16 v[126:127], v134 offset:64032
    s_waitcnt lgkmcnt(8)
    v_mfma_f32_16x16x32_bf16 v[168:171], v[108:111], v[44:47], v[168:171]
    ds_read_b64_tr_b16 v[104:105], v134 offset:61504
    ds_read_b64_tr_b16 v[106:107], v134 offset:64064
    s_waitcnt lgkmcnt(8)
    v_mfma_f32_16x16x32_bf16 v[172:175], v[112:115], v[44:47], v[172:175]
    ds_read_b64_tr_b16 v[108:109], v134 offset:61536
    ds_read_b64_tr_b16 v[110:111], v134 offset:64096
    s_waitcnt lgkmcnt(8)
    v_mfma_f32_16x16x32_bf16 v[176:179], v[116:119], v[44:47], v[176:179]
    ds_read_b64_tr_b16 v[112:113], v134 offset:61568
    ds_read_b64_tr_b16 v[114:115], v134 offset:64128
    s_waitcnt lgkmcnt(8)
    v_mfma_f32_16x16x32_bf16 v[160:163], v[120:123], v[48:51], v[160:163]
    ds_read_b64_tr_b16 v[116:117], v135 offset:61440
    ds_read_b64_tr_b16 v[118:119], v135 offset:64000
    s_waitcnt lgkmcnt(8)
    v_mfma_f32_16x16x32_bf16 v[164:167], v[124:127], v[48:51], v[164:167]
    ds_read_b64_tr_b16 v[120:121], v135 offset:61472
    ds_read_b64_tr_b16 v[122:123], v135 offset:64032
    s_waitcnt lgkmcnt(8)
    v_mfma_f32_16x16x32_bf16 v[168:171], v[104:107], v[48:51], v[168:171]
    ds_read_b64_tr_b16 v[124:125], v135 offset:61504
    ds_read_b64_tr_b16 v[126:127], v135 offset:64064
    s_waitcnt lgkmcnt(8)
    v_mfma_f32_16x16x32_bf16 v[172:175], v[108:111], v[48:51], v[172:175]
    ds_read_b64_tr_b16 v[104:105], v135 offset:61536
    ds_read_b64_tr_b16 v[106:107], v135 offset:64096
    s_waitcnt lgkmcnt(8)
    v_mfma_f32_16x16x32_bf16 v[176:179], v[112:115], v[48:51], v[176:179]
    ds_read_b64_tr_b16 v[108:109], v135 offset:61568
    ds_read_b64_tr_b16 v[110:111], v135 offset:64128
    s_waitcnt lgkmcnt(8)
    v_mfma_f32_16x16x32_bf16 v[160:163], v[116:119], v[52:55], v[160:163]
    s_waitcnt vmcnt(0)
    ds_read_b128 v[24:27], v149 offset:16384
    ds_read_b128 v[28:31], v150 offset:16384
    ds_read_b128 v[32:35], v151 offset:16384
    ds_read_b128 v[36:39], v152 offset:16384
    s_barrier
    ds_read_b64_tr_b16 v[112:113], v132 offset:0
    ds_read_b64_tr_b16 v[114:115], v132 offset:2560
    s_waitcnt lgkmcnt(8)
    v_mfma_f32_16x16x32_bf16 v[164:167], v[120:123], v[52:55], v[164:167]
    ds_read_b64_tr_b16 v[116:117], v132 offset:32
    ds_read_b64_tr_b16 v[118:119], v132 offset:2592
    s_waitcnt lgkmcnt(8)
    v_mfma_f32_16x16x32_bf16 v[168:171], v[124:127], v[52:55], v[168:171]
    ds_read_b64_tr_b16 v[120:121], v132 offset:64
    ds_read_b64_tr_b16 v[122:123], v132 offset:2624
    s_waitcnt lgkmcnt(8)
    v_mfma_f32_16x16x32_bf16 v[172:175], v[104:107], v[52:55], v[172:175]
    ds_read_b64_tr_b16 v[124:125], v132 offset:96
    ds_read_b64_tr_b16 v[126:127], v132 offset:2656
    s_waitcnt lgkmcnt(8)
    v_mfma_f32_16x16x32_bf16 v[176:179], v[108:111], v[52:55], v[176:179]
    ds_read_b64_tr_b16 v[104:105], v132 offset:128
    ds_read_b64_tr_b16 v[106:107], v132 offset:2688
    s_waitcnt lgkmcnt(8)
    v_dot2_f32_bf16 v16, v24, v20, v16
    v_dot2_f32_bf16 v18, v24, v24, v18
    v_dot2_f32_bf16 v17, v25, v20, v17
    v_dot2_f32_bf16 v19, v25, v25, v19
    v_dot2_f32_bf16 v16, v26, v20, v16
    v_dot2_f32_bf16 v18, v26, v26, v18
    v_dot2_f32_bf16 v17, v27, v20, v17
    v_dot2_f32_bf16 v19, v27, v27, v19
    v_dot2_f32_bf16 v16, v28, v20, v16
    v_dot2_f32_bf16 v18, v28, v28, v18
    v_dot2_f32_bf16 v17, v29, v20, v17
    v_dot2_f32_bf16 v19, v29, v29, v19
    v_dot2_f32_bf16 v16, v30, v20, v16
    v_dot2_f32_bf16 v18, v30, v30, v18
    v_dot2_f32_bf16 v17, v31, v20, v17
    v_dot2_f32_bf16 v19, v31, v31, v19
    v_dot2_f32_bf16 v16, v32, v20, v16
    v_dot2_f32_bf16 v18, v32, v32, v18
    v_dot2_f32_bf16 v17, v33, v20, v17
    v_dot2_f32_bf16 v19, v33, v33, v19
    v_dot2_f32_bf16 v16, v34, v20, v16
    v_dot2_f32_bf16 v18, v34, v34, v18
    v_dot2_f32_bf16 v17, v35, v20, v17
    v_dot2_f32_bf16 v19, v35, v35, v19
    v_dot2_f32_bf16 v16, v36, v20, v16
    v_dot2_f32_bf16 v18, v36, v36, v18
    v_dot2_f32_bf16 v17, v37, v20, v17
    v_dot2_f32_bf16 v19, v37, v37, v19
    v_dot2_f32_bf16 v16, v38, v20, v16
    v_dot2_f32_bf16 v18, v38, v38, v18
    v_dot2_f32_bf16 v17, v39, v20, v17
    v_dot2_f32_bf16 v19, v39, v39, v19
    v_mfma_f32_16x16x32_bf16 v[160:163], v[112:115], v[24:27], v[160:163]
    v_mfma_f32_16x16x32_bf16 v[188:191], v[20:23], v[112:115], v[188:191]
    ds_read_b64_tr_b16 v[108:109], v133 offset:0
    ds_read_b64_tr_b16 v[110:111], v133 offset:2560
    s_waitcnt lgkmcnt(8)
    v_mfma_f32_16x16x32_bf16 v[164:167], v[116:119], v[24:27], v[164:167]
    v_mfma_f32_16x16x32_bf16 v[192:195], v[20:23], v[116:119], v[192:195]
    ds_read_b64_tr_b16 v[112:113], v133 offset:32
    ds_read_b64_tr_b16 v[114:115], v133 offset:2592
    s_waitcnt lgkmcnt(8)
    v_mfma_f32_16x16x32_bf16 v[168:171], v[120:123], v[24:27], v[168:171]
    v_mfma_f32_16x16x32_bf16 v[196:199], v[20:23], v[120:123], v[196:199]
    ds_read_b64_tr_b16 v[116:117], v133 offset:64
    ds_read_b64_tr_b16 v[118:119], v133 offset:2624
    s_waitcnt lgkmcnt(8)
    v_mfma_f32_16x16x32_bf16 v[172:175], v[124:127], v[24:27], v[172:175]
    v_mfma_f32_16x16x32_bf16 v[200:203], v[20:23], v[124:127], v[200:203]
    ds_read_b64_tr_b16 v[120:121], v133 offset:96
    ds_read_b64_tr_b16 v[122:123], v133 offset:2656
    s_waitcnt lgkmcnt(8)
    v_mfma_f32_16x16x32_bf16 v[176:179], v[104:107], v[24:27], v[176:179]
    v_mfma_f32_16x16x32_bf16 v[204:207], v[20:23], v[104:107], v[204:207]
    ds_read_b64_tr_b16 v[124:125], v133 offset:128
    ds_read_b64_tr_b16 v[126:127], v133 offset:2688
    s_waitcnt lgkmcnt(8)
    v_mfma_f32_16x16x32_bf16 v[160:163], v[108:111], v[28:31], v[160:163]
    ds_read_b64_tr_b16 v[104:105], v134 offset:0
    ds_read_b64_tr_b16 v[106:107], v134 offset:2560
    s_waitcnt lgkmcnt(8)
    v_mfma_f32_16x16x32_bf16 v[164:167], v[112:115], v[28:31], v[164:167]
    ds_read_b64_tr_b16 v[108:109], v134 offset:32
    ds_read_b64_tr_b16 v[110:111], v134 offset:2592
    s_waitcnt lgkmcnt(8)
    v_mfma_f32_16x16x32_bf16 v[168:171], v[116:119], v[28:31], v[168:171]
    ds_read_b64_tr_b16 v[112:113], v134 offset:64
    ds_read_b64_tr_b16 v[114:115], v134 offset:2624
    s_waitcnt lgkmcnt(8)
    v_mfma_f32_16x16x32_bf16 v[172:175], v[120:123], v[28:31], v[172:175]
    ds_read_b64_tr_b16 v[116:117], v134 offset:96
    ds_read_b64_tr_b16 v[118:119], v134 offset:2656
    s_waitcnt lgkmcnt(8)
    v_mfma_f32_16x16x32_bf16 v[176:179], v[124:127], v[28:31], v[176:179]
    ds_read_b64_tr_b16 v[120:121], v134 offset:128
    ds_read_b64_tr_b16 v[122:123], v134 offset:2688
    s_waitcnt lgkmcnt(8)
    v_mfma_f32_16x16x32_bf16 v[160:163], v[104:107], v[32:35], v[160:163]
    ds_read_b64_tr_b16 v[124:125], v135 offset:0
    ds_read_b64_tr_b16 v[126:127], v135 offset:2560
    s_waitcnt lgkmcnt(8)
    v_mfma_f32_16x16x32_bf16 v[164:167], v[108:111], v[32:35], v[164:167]
    ds_read_b64_tr_b16 v[104:105], v135 offset:32
    ds_read_b64_tr_b16 v[106:107], v135 offset:2592
    s_waitcnt lgkmcnt(8)
    v_mfma_f32_16x16x32_bf16 v[168:171], v[112:115], v[32:35], v[168:171]
    ds_read_b64_tr_b16 v[108:109], v135 offset:64
    ds_read_b64_tr_b16 v[110:111], v135 offset:2624
    s_waitcnt lgkmcnt(8)
    v_mfma_f32_16x16x32_bf16 v[172:175], v[116:119], v[32:35], v[172:175]
    ds_read_b64_tr_b16 v[112:113], v135 offset:96
    ds_read_b64_tr_b16 v[114:115], v135 offset:2656
    s_waitcnt lgkmcnt(8)
    v_mfma_f32_16x16x32_bf16 v[176:179], v[120:123], v[32:35], v[176:179]
    ds_read_b64_tr_b16 v[116:117], v135 offset:128
    ds_read_b64_tr_b16 v[118:119], v135 offset:2688
    s_waitcnt lgkmcnt(8)
    v_mfma_f32_16x16x32_bf16 v[160:163], v[124:127], v[36:39], v[160:163]
    s_waitcnt lgkmcnt(6)
    v_mfma_f32_16x16x32_bf16 v[164:167], v[104:107], v[36:39], v[164:167]
    s_waitcnt lgkmcnt(4)
    v_mfma_f32_16x16x32_bf16 v[168:171], v[108:111], v[36:39], v[168:171]
    s_waitcnt lgkmcnt(2)
    v_mfma_f32_16x16x32_bf16 v[172:175], v[112:115], v[36:39], v[172:175]
    s_waitcnt lgkmcnt(0)
    v_mfma_f32_16x16x32_bf16 v[176:179], v[116:119], v[36:39], v[176:179]
k1_epi:
    s_lshl_b32 s35, s34, 8
    s_add_u32 s35, s35, 81920
    v_lshlrev_b32 v15, 4, v2
    v_add_u32 v15, s35, v15
    v_lshlrev_b32 v14, 4, v1
    v_add_u32 v14, 81920, v14
    v_and_b32 v189, 0xffff0000, v188
    v_sub_f32 v188, v188, v189
    v_and_b32 v190, 0xffff0000, v188
    v_sub_f32 v191, v188, v190
    v_lshrrev_b32 v188, 16, v189
    v_or_b32 v188, v188, v190
    v_lshrrev_b32 v189, 16, v191
    v_mov_b32 v190, 0
    v_mov_b32 v191, 0
    ds_write_b128 v15, v[188:191] offset:0
    v_and_b32 v193, 0xffff0000, v192
    v_sub_f32 v192, v192, v193
    v_and_b32 v194, 0xffff0000, v192
    v_sub_f32 v195, v192, v194
    v_lshrrev_b32 v192, 16, v193
    v_or_b32 v192, v192, v194
    v_lshrrev_b32 v193, 16, v195
    v_mov_b32 v194, 0
    v_mov_b32 v195, 0
    ds_write_b128 v15, v[192:195] offset:1024
    v_and_b32 v197, 0xffff0000, v196
    v_sub_f32 v196, v196, v197
    v_and_b32 v198, 0xffff0000, v196
    v_sub_f32 v199, v196, v198
    v_lshrrev_b32 v196, 16, v197
    v_or_b32 v196, v196, v198
    v_lshrrev_b32 v197, 16, v199
    v_mov_b32 v198, 0
    v_mov_b32 v199, 0
    ds_write_b128 v15, v[196:199] offset:2048
    v_and_b32 v201, 0xffff0000, v200
    v_sub_f32 v200, v200, v201
    v_and_b32 v202, 0xffff0000, v200
    v_sub_f32 v203, v200, v202
    v_lshrrev_b32 v200, 16, v201
    v_or_b32 v200, v200, v202
    v_lshrrev_b32 v201, 16, v203
    v_mov_b32 v202, 0
    v_mov_b32 v203, 0
    ds_write_b128 v15, v[200:203] offset:3072
    v_and_b32 v205, 0xffff0000, v204
    v_sub_f32 v204, v204, v205
    v_and_b32 v206, 0xffff0000, v204
    v_sub_f32 v207, v204, v206
    v_lshrrev_b32 v204, 16, v205
    v_or_b32 v204, v204, v206
    v_lshrrev_b32 v205, 16, v207
    v_mov_b32 v206, 0
    v_mov_b32 v207, 0
    ds_write_b128 v15, v[204:207] offset:4096
    v_and_b32 v209, 0xffff0000, v208
    v_sub_f32 v208, v208, v209
    v_and_b32 v210, 0xffff0000, v208
    v_sub_f32 v211, v208, v210
    v_lshrrev_b32 v208, 16, v209
    v_or_b32 v208, v208, v210
    v_lshrrev_b32 v209, 16, v211
    v_mov_b32 v210, 0
    v_mov_b32 v211, 0
    ds_write_b128 v15, v[208:211] offset:5120
    v_and_b32 v213, 0xffff0000, v212
    v_sub_f32 v212, v212, v213
    v_and_b32 v214, 0xffff0000, v212
    v_sub_f32 v215, v212, v214
    v_lshrrev_b32 v212, 16, v213
    v_or_b32 v212, v212, v214
    v_lshrrev_b32 v213, 16, v215
    v_mov_b32 v214, 0
    v_mov_b32 v215, 0
    ds_write_b128 v15, v[212:215] offset:6144
    v_add_f32 v16, v16, v17
    v_add_f32 v18, v18, v19
    s_waitcnt lgkmcnt(0)
    s_barrier
    ds_read_b128 v[24:27], v14 offset:0
    ds_read_b128 v[28:31], v14 offset:1024
    ds_read_b128 v[32:35], v14 offset:2048
    ds_read_b128 v[36:39], v14 offset:3072
    ds_read_b128 v[40:43], v14 offset:4096
    ds_read_b128 v[44:47], v14 offset:5120
    ds_read_b128 v[48:51], v14 offset:6144
    v_mov_b32 v12, v16
    v_mov_b32 v13, v18
    s_nop 0
    v_permlane16_swap_b32 v16, v12
    v_permlane16_swap_b32 v18, v13
    v_add_f32 v16, v16, v12
    v_add_f32 v18, v18, v13
    v_mov_b32 v12, v16
    v_mov_b32 v13, v18
    s_nop 0
    v_permlane32_swap_b32 v16, v12
    v_permlane32_swap_b32 v18, v13
    v_add_f32 v16, v16, v12
    v_add_f32 v18, v18, v13
    v_mul_f32 v12, 0x3acccccd, v16
    v_mul_f32 v13, 0x3acccccd, v18
    v_fma_f32 v13, -v12, v12, v13
    v_max_f32 v13, 0, v13
    v_cvt_pk_bf16_f32 v216, v12, v12
    v_lshlrev_b32 v216, 16, v216
    v_cvt_pk_bf16_f32 v13, v13, v13
    v_lshlrev_b32 v13, 16, v13
    v_add_f32 v13, 0x3727c5ac, v13
    v_cvt_pk_bf16_f32 v13, v13, v13
    v_lshlrev_b32 v13, 16, v13
    v_sqrt_f32 v13, v13
    s_nop 0
    v_cvt_pk_bf16_f32 v13, v13, v13
    v_lshlrev_b32 v13, 16, v13
    v_rcp_f32 v217, v13
    s_nop 0
    v_xor_b32 v12, 0x80000000, v216
    v_lshrrev_b32 v220, 16, v12
    v_or_b32 v220, v220, v12
    v_mov_b32 v221, v220
    v_mov_b32 v222, 0
    v_mov_b32 v223, 0
    v_mul_f32 v218, 0x3ea52b5c, v217
    v_mov_b32 v219, v218
    s_waitcnt lgkmcnt(0)
    v_mfma_f32_16x16x32_bf16 v[160:163], v[24:27], v[220:223], v[160:163]
    v_mfma_f32_16x16x32_bf16 v[164:167], v[28:31], v[220:223], v[164:167]
    v_mfma_f32_16x16x32_bf16 v[168:171], v[32:35], v[220:223], v[168:171]
    v_mfma_f32_16x16x32_bf16 v[172:175], v[36:39], v[220:223], v[172:175]
    v_mfma_f32_16x16x32_bf16 v[176:179], v[40:43], v[220:223], v[176:179]
    s_nop 3
    v_pk_mul_f32 v[160:161], v[160:161], v[218:219]
    v_pk_mul_f32 v[162:163], v[162:163], v[218:219]
    v_cvt_pk_bf16_f32 v224, v160, v161
    v_cvt_pk_bf16_f32 v225, v162, v163
    buffer_store_dwordx2 v[224:225], v140, s[28:31], s42 offen
    v_pk_mul_f32 v[164:165], v[164:165], v[218:219]
    v_pk_mul_f32 v[166:167], v[166:167], v[218:219]
    v_cvt_pk_bf16_f32 v226, v164, v165
    v_cvt_pk_bf16_f32 v227, v166, v167
    buffer_store_dwordx2 v[226:227], v141, s[28:31], s42 offen
    v_pk_mul_f32 v[168:169], v[168:169], v[218:219]
    v_pk_mul_f32 v[170:171], v[170:171], v[218:219]
    v_cvt_pk_bf16_f32 v228, v168, v169
    v_cvt_pk_bf16_f32 v229, v170, v171
    buffer_store_dwordx2 v[228:229], v142, s[28:31], s42 offen
    v_pk_mul_f32 v[172:173], v[172:173], v[218:219]
    v_pk_mul_f32 v[174:175], v[174:175], v[218:219]
    v_cvt_pk_bf16_f32 v230, v172, v173
    v_cvt_pk_bf16_f32 v231, v174, v175
    buffer_store_dwordx2 v[230:231], v143, s[28:31], s42 offen
    v_pk_mul_f32 v[176:177], v[176:177], v[218:219]
    v_pk_mul_f32 v[178:179], v[178:179], v[218:219]
    v_cvt_pk_bf16_f32 v232, v176, v177
    v_cvt_pk_bf16_f32 v233, v178, v179
    buffer_store_dwordx2 v[232:233], v144, s[28:31], s42 offen
    s_cmp_lt_u32 s33, 2
    s_cbranch_scc1 k1_kv_epi
k1_end:
    s_endpgm
k1_kv_epi:
    s_lshl_b32 s35, s32, 1
    s_lshr_b32 s36, s34, 1
    s_add_u32 s35, s35, s36
    s_mul_i32 s39, s35, 2560
    s_add_u32 s39, s39, 3145728
    s_and_b32 s40, s34, 1
    s_cmp_eq_u32 s33, 1
    s_cbranch_scc1 k1_epi_v
    v_mfma_f32_16x16x32_bf16 v[180:183], v[44:47], v[220:223], v[180:183]
    v_mfma_f32_16x16x32_bf16 v[184:187], v[48:51], v[220:223], v[184:187]
    v_cmp_eq_u32 vcc, 0, v3
    s_lshl_b32 s35, s40, 4
    v_add_u32 v13, s35, v2
    v_lshrrev_b32 v14, 1, v3
    v_lshl_add_u32 v14, v14, 5, v13
    v_lshlrev_b32 v14, 4, v14
    v_and_b32 v15, 1, v3
    v_lshl_add_u32 v14, v15, 3, v14
    v_lshlrev_b32 v12, 3, v13
    v_add_u32 v12, 2304, v12
    v_mov_b32 v13, 0x7ffffff8
    v_cndmask_b32 v13, v13, v12, vcc
    v_mul_f32 v180, v180, v217
    v_mul_f32 v181, v181, v217
    v_mul_f32 v182, v182, v217
    v_mul_f32 v183, v183, v217
    v_mul_f32 v184, v184, v217
    v_mul_f32 v185, v185, v217
    v_mul_f32 v186, v186, v217
    v_mul_f32 v187, v187, v217
    v_cvt_pk_bf16_f32 v236, v180, v181
    v_cvt_pk_bf16_f32 v237, v182, v183
    v_cvt_pk_bf16_f32 v238, v184, v185
    v_cvt_pk_bf16_f32 v239, v186, v187
    v_cndmask_b32 v238, 0, v238, vcc
    v_cndmask_b32 v239, 0, v239, vcc
    buffer_store_dwordx2 v[236:237], v14, s[28:31], s39 offen
    buffer_store_dwordx2 v[238:239], v13, s[28:31], s39 offen
    v_mov_b32 v15, 0
    v_dot2_f32_bf16 v15, v236, v236, v15
    v_dot2_f32_bf16 v15, v237, v237, v15
    v_dot2_f32_bf16 v15, v238, v238, v15
    v_dot2_f32_bf16 v15, v239, v239, v15
    s_nop 2
    v_mov_b32 v12, v15
    s_nop 1
    v_permlane16_swap_b32 v15, v12
    s_nop 1
    v_add_f32 v15, v15, v12
    v_mov_b32 v12, v15
    s_nop 1
    v_permlane32_swap_b32 v15, v12
    s_nop 1
    v_add_f32 v15, v15, v12
    s_nop 1
    v_max_f32_dpp v15, v15, v15 row_ror:8 row_mask:0xf bank_mask:0xf
    s_nop 1
    v_max_f32_dpp v15, v15, v15 row_ror:4 row_mask:0xf bank_mask:0xf
    s_nop 1
    v_max_f32_dpp v15, v15, v15 row_ror:2 row_mask:0xf bank_mask:0xf
    s_nop 1
    v_max_f32_dpp v15, v15, v15 row_ror:1 row_mask:0xf bank_mask:0xf
    s_lshl_b32 s35, s32, 2
    s_add_u32 s35, s35, s34
    s_lshl_b32 s35, s35, 2
    s_add_u32 s35, s35, 3407872
    v_mov_b32 v14, 0
    buffer_store_dword v15, v14, s[28:31], s35 offen
    s_endpgm
k1_epi_v:
    v_mfma_f32_16x16x32_bf16 v[180:183], v[220:223], v[44:47], v[180:183]
    v_mfma_f32_16x16x32_bf16 v[184:187], v[220:223], v[48:51], v[184:187]
    s_lshl_b32 s35, s34, 6
    s_add_u32 s35, s35, 156672
    v_lshlrev_b32 v14, 2, v2
    v_add_u32 v14, s35, v14
    ds_write_b32 v14, v217
    v_lshlrev_b32 v14, 4, v3
    v_add_u32 v14, s35, v14
    s_waitcnt lgkmcnt(0)
    ds_read_b128 v[56:59], v14
    v_and_b32 v13, 1, v3
    s_lshl_b32 s35, s40, 1
    v_add_u32 v13, s35, v13
    v_mul_u32_u24 v13, 20, v13
    v_add_u32 v13, v13, v2
    v_lshlrev_b32 v13, 4, v13
    v_lshrrev_b32 v14, 1, v3
    v_lshl_add_u32 v13, v14, 3, v13
    v_cmp_gt_u32 vcc, 4, v2
    v_mov_b32 v14, 0x7ffffff8
    s_nop 0
    v_cndmask_b32 v12, v14, v13, vcc
    s_waitcnt lgkmcnt(0)
    v_mul_f32 v180, v180, v56
    v_mul_f32 v181, v181, v57
    v_mul_f32 v182, v182, v58
    v_mul_f32 v183, v183, v59
    v_cvt_pk_bf16_f32 v236, v180, v181
    v_cvt_pk_bf16_f32 v237, v182, v183
    v_mul_f32 v184, v184, v56
    v_mul_f32 v185, v185, v57
    v_mul_f32 v186, v186, v58
    v_mul_f32 v187, v187, v59
    v_cvt_pk_bf16_f32 v238, v184, v185
    v_cvt_pk_bf16_f32 v239, v186, v187
    buffer_store_dwordx2 v[236:237], v13, s[28:31], s39 offen offset:1024
    buffer_store_dwordx2 v[238:239], v12, s[28:31], s39 offen offset:1280
    s_endpgm
k1_loop_k:
    s_waitcnt vmcnt(10)
    ds_read_b128 v[24:27], v149 offset:0
    ds_read_b128 v[28:31], v150 offset:0
    ds_read_b128 v[32:35], v151 offset:0
    ds_read_b128 v[36:39], v152 offset:0
    s_barrier
    ds_read_b64_tr_b16 v[104:105], v132 offset:0
    ds_read_b64_tr_b16 v[106:107], v132 offset:2560
    ds_read_b64_tr_b16 v[108:109], v132 offset:32
    ds_read_b64_tr_b16 v[110:111], v132 offset:2592
    ds_read_b64_tr_b16 v[112:113], v132 offset:64
    ds_read_b64_tr_b16 v[114:115], v132 offset:2624
    ds_read_b64_tr_b16 v[116:117], v132 offset:96
    ds_read_b64_tr_b16 v[118:119], v132 offset:2656
    ds_read_b64_tr_b16 v[120:121], v132 offset:128
    ds_read_b64_tr_b16 v[122:123], v132 offset:2688
    s_waitcnt lgkmcnt(8)
    v_dot2_f32_bf16 v16, v24, v20, v16
    v_dot2_f32_bf16 v18, v24, v24, v18
    v_dot2_f32_bf16 v17, v25, v20, v17
    v_dot2_f32_bf16 v19, v25, v25, v19
    v_dot2_f32_bf16 v16, v26, v20, v16
    v_dot2_f32_bf16 v18, v26, v26, v18
    v_dot2_f32_bf16 v17, v27, v20, v17
    v_dot2_f32_bf16 v19, v27, v27, v19
    v_dot2_f32_bf16 v16, v28, v20, v16
    v_dot2_f32_bf16 v18, v28, v28, v18
    v_dot2_f32_bf16 v17, v29, v20, v17
    v_dot2_f32_bf16 v19, v29, v29, v19
    v_dot2_f32_bf16 v16, v30, v20, v16
    v_dot2_f32_bf16 v18, v30, v30, v18
    v_dot2_f32_bf16 v17, v31, v20, v17
    v_dot2_f32_bf16 v19, v31, v31, v19
    v_dot2_f32_bf16 v16, v32, v20, v16
    v_dot2_f32_bf16 v18, v32, v32, v18
    v_dot2_f32_bf16 v17, v33, v20, v17
    v_dot2_f32_bf16 v19, v33, v33, v19
    v_dot2_f32_bf16 v16, v34, v20, v16
    v_dot2_f32_bf16 v18, v34, v34, v18
    v_dot2_f32_bf16 v17, v35, v20, v17
    v_dot2_f32_bf16 v19, v35, v35, v19
    v_dot2_f32_bf16 v16, v36, v20, v16
    v_dot2_f32_bf16 v18, v36, v36, v18
    v_dot2_f32_bf16 v17, v37, v20, v17
    v_dot2_f32_bf16 v19, v37, v37, v19
    v_dot2_f32_bf16 v16, v38, v20, v16
    v_dot2_f32_bf16 v18, v38, v38, v18
    v_dot2_f32_bf16 v17, v39, v20, v17
    v_dot2_f32_bf16 v19, v39, v39, v19
    v_mfma_f32_16x16x32_bf16 v[160:163], v[104:107], v[24:27], v[160:163]
    v_mfma_f32_16x16x32_bf16 v[188:191], v[20:23], v[104:107], v[188:191]
    ds_read_b64_tr_b16 v[124:125], v136 offset:0
    ds_read_b64_tr_b16 v[126:127], v136 offset:160
    s_sub_u32 s57, s56, 3
    s_cselect_b32 s59, 5, 0
    s_add_u32 s57, s57, s59
    s_mul_i32 s58, s57, 163840
    s_add_u32 s58, s58, s37
    s_lshl_b32 s57, s57, 8
    s_add_u32 m0, s43, 32768
    s_nop 0
    buffer_load_dwordx4 v145, s[16:19], s57 offen lds
    s_waitcnt lgkmcnt(8)
    v_mfma_f32_16x16x32_bf16 v[164:167], v[108:111], v[24:27], v[164:167]
    v_mfma_f32_16x16x32_bf16 v[192:195], v[20:23], v[108:111], v[192:195]
    ds_read_b64_tr_b16 v[104:105], v136 offset:32
    ds_read_b64_tr_b16 v[106:107], v136 offset:192
    s_add_u32 m0, s43, 33792
    s_nop 0
    buffer_load_dwordx4 v146, s[16:19], s57 offen lds
    s_waitcnt lgkmcnt(8)
    v_mfma_f32_16x16x32_bf16 v[168:171], v[112:115], v[24:27], v[168:171]
    v_mfma_f32_16x16x32_bf16 v[196:199], v[20:23], v[112:115], v[196:199]
    ds_read_b64_tr_b16 v[108:109], v133 offset:0
    ds_read_b64_tr_b16 v[110:111], v133 offset:2560
    s_add_u32 m0, s43, 34816
    s_nop 0
    buffer_load_dwordx4 v147, s[16:19], s57 offen lds
    s_waitcnt lgkmcnt(8)
    v_mfma_f32_16x16x32_bf16 v[172:175], v[116:119], v[24:27], v[172:175]
    v_mfma_f32_16x16x32_bf16 v[200:203], v[20:23], v[116:119], v[200:203]
    ds_read_b64_tr_b16 v[112:113], v133 offset:32
    ds_read_b64_tr_b16 v[114:115], v133 offset:2592
    s_add_u32 m0, s43, 35840
    s_nop 0
    buffer_load_dwordx4 v148, s[16:19], s57 offen lds
    s_waitcnt lgkmcnt(8)
    v_mfma_f32_16x16x32_bf16 v[176:179], v[120:123], v[24:27], v[176:179]
    v_mfma_f32_16x16x32_bf16 v[204:207], v[20:23], v[120:123], v[204:207]
    ds_read_b64_tr_b16 v[116:117], v133 offset:64
    ds_read_b64_tr_b16 v[118:119], v133 offset:2624
    s_add_u32 m0, s41, 40960
    s_nop 0
    buffer_load_dwordx4 v5, s[20:23], s58 offen lds
    s_waitcnt lgkmcnt(8)
    v_mfma_f32_16x16x32_bf16 v[180:183], v[124:127], v[24:27], v[180:183]
    v_mfma_f32_16x16x32_bf16 v[208:211], v[20:23], v[124:127], v[208:211]
    ds_read_b64_tr_b16 v[120:121], v133 offset:96
    ds_read_b64_tr_b16 v[122:123], v133 offset:2656
    s_add_u32 m0, s41, 41984
    s_nop 0
    buffer_load_dwordx4 v6, s[20:23], s58 offen lds
    s_waitcnt lgkmcnt(8)
    v_mfma_f32_16x16x32_bf16 v[184:187], v[104:107], v[24:27], v[184:187]
    v_mfma_f32_16x16x32_bf16 v[212:215], v[20:23], v[104:107], v[212:215]
    ds_read_b64_tr_b16 v[124:125], v133 offset:128
    ds_read_b64_tr_b16 v[126:127], v133 offset:2688
    s_add_u32 m0, s41, 43008
    s_nop 0
    buffer_load_dwordx4 v7, s[20:23], s58 offen lds
    s_waitcnt lgkmcnt(8)
    v_mfma_f32_16x16x32_bf16 v[160:163], v[108:111], v[28:31], v[160:163]
    ds_read_b64_tr_b16 v[104:105], v137 offset:0
    ds_read_b64_tr_b16 v[106:107], v137 offset:160
    s_add_u32 m0, s41, 44032
    s_nop 0
    buffer_load_dwordx4 v8, s[20:23], s58 offen lds
    s_waitcnt lgkmcnt(8)
    v_mfma_f32_16x16x32_bf16 v[164:167], v[112:115], v[28:31], v[164:167]
    ds_read_b64_tr_b16 v[108:109], v137 offset:32
    ds_read_b64_tr_b16 v[110:111], v137 offset:192
    s_add_u32 m0, s41, 45056
    s_nop 0
    buffer_load_dwordx4 v9, s[20:23], s58 offen lds
    s_waitcnt lgkmcnt(8)
    v_mfma_f32_16x16x32_bf16 v[168:171], v[116:119], v[28:31], v[168:171]
    ds_read_b64_tr_b16 v[112:113], v134 offset:0
    ds_read_b64_tr_b16 v[114:115], v134 offset:2560
    s_waitcnt lgkmcnt(8)
    v_mfma_f32_16x16x32_bf16 v[172:175], v[120:123], v[28:31], v[172:175]
    ds_read_b64_tr_b16 v[116:117], v134 offset:32
    ds_read_b64_tr_b16 v[118:119], v134 offset:2592
    s_waitcnt lgkmcnt(8)
    v_mfma_f32_16x16x32_bf16 v[176:179], v[124:127], v[28:31], v[176:179]
    ds_read_b64_tr_b16 v[120:121], v134 offset:64
    ds_read_b64_tr_b16 v[122:123], v134 offset:2624
    s_waitcnt lgkmcnt(8)
    v_mfma_f32_16x16x32_bf16 v[180:183], v[104:107], v[28:31], v[180:183]
    ds_read_b64_tr_b16 v[124:125], v134 offset:96
    ds_read_b64_tr_b16 v[126:127], v134 offset:2656
    s_waitcnt lgkmcnt(8)
    v_mfma_f32_16x16x32_bf16 v[184:187], v[108:111], v[28:31], v[184:187]
    ds_read_b64_tr_b16 v[104:105], v134 offset:128
    ds_read_b64_tr_b16 v[106:107], v134 offset:2688
    s_waitcnt lgkmcnt(8)
    v_mfma_f32_16x16x32_bf16 v[160:163], v[112:115], v[32:35], v[160:163]
    ds_read_b64_tr_b16 v[108:109], v138 offset:0
    ds_read_b64_tr_b16 v[110:111], v138 offset:160
    s_waitcnt lgkmcnt(8)
    v_mfma_f32_16x16x32_bf16 v[164:167], v[116:119], v[32:35], v[164:167]
    ds_read_b64_tr_b16 v[112:113], v138 offset:32
    ds_read_b64_tr_b16 v[114:115], v138 offset:192
    s_waitcnt lgkmcnt(8)
    v_mfma_f32_16x16x32_bf16 v[168:171], v[120:123], v[32:35], v[168:171]
    ds_read_b64_tr_b16 v[116:117], v135 offset:0
    ds_read_b64_tr_b16 v[118:119], v135 offset:2560
    s_waitcnt lgkmcnt(8)
    v_mfma_f32_16x16x32_bf16 v[172:175], v[124:127], v[32:35], v[172:175]
    ds_read_b64_tr_b16 v[120:121], v135 offset:32
    ds_read_b64_tr_b16 v[122:123], v135 offset:2592
    s_waitcnt lgkmcnt(8)
    v_mfma_f32_16x16x32_bf16 v[176:179], v[104:107], v[32:35], v[176:179]
    ds_read_b64_tr_b16 v[124:125], v135 offset:64
    ds_read_b64_tr_b16 v[126:127], v135 offset:2624
    s_waitcnt lgkmcnt(8)
    v_mfma_f32_16x16x32_bf16 v[180:183], v[108:111], v[32:35], v[180:183]
    ds_read_b64_tr_b16 v[104:105], v135 offset:96
    ds_read_b64_tr_b16 v[106:107], v135 offset:2656
    s_waitcnt lgkmcnt(8)
    v_mfma_f32_16x16x32_bf16 v[184:187], v[112:115], v[32:35], v[184:187]
    ds_read_b64_tr_b16 v[108:109], v135 offset:128
    ds_read_b64_tr_b16 v[110:111], v135 offset:2688
    s_waitcnt lgkmcnt(8)
    v_mfma_f32_16x16x32_bf16 v[160:163], v[116:119], v[36:39], v[160:163]
    ds_read_b64_tr_b16 v[112:113], v139 offset:0
    ds_read_b64_tr_b16 v[114:115], v139 offset:160
    s_waitcnt lgkmcnt(8)
    v_mfma_f32_16x16x32_bf16 v[164:167], v[120:123], v[36:39], v[164:167]
    ds_read_b64_tr_b16 v[116:117], v139 offset:32
    ds_read_b64_tr_b16 v[118:119], v139 offset:192
    s_waitcnt lgkmcnt(8)
    v_mfma_f32_16x16x32_bf16 v[168:171], v[124:127], v[36:39], v[168:171]
    s_waitcnt vmcnt(9)
    ds_read_b128 v[40:43], v149 offset:16384
    ds_read_b128 v[44:47], v150 offset:16384
    ds_read_b128 v[48:51], v151 offset:16384
    ds_read_b128 v[52:55], v152 offset:16384
    s_barrier
    ds_read_b64_tr_b16 v[120:121], v132 offset:20480
    ds_read_b64_tr_b16 v[122:123], v132 offset:23040
    s_waitcnt lgkmcnt(8)
    v_mfma_f32_16x16x32_bf16 v[172:175], v[104:107], v[36:39], v[172:175]
    ds_read_b64_tr_b16 v[124:125], v132 offset:20512
    ds_read_b64_tr_b16 v[126:127], v132 offset:23072
    s_waitcnt lgkmcnt(8)
    v_mfma_f32_16x16x32_bf16 v[176:179], v[108:111], v[36:39], v[176:179]
    ds_read_b64_tr_b16 v[104:105], v132 offset:20544
    ds_read_b64_tr_b16 v[106:107], v132 offset:23104
    s_waitcnt lgkmcnt(8)
    v_mfma_f32_16x16x32_bf16 v[180:183], v[112:115], v[36:39], v[180:183]
    ds_read_b64_tr_b16 v[108:109], v132 offset:20576
    ds_read_b64_tr_b16 v[110:111], v132 offset:23136
    s_waitcnt lgkmcnt(8)
    v_mfma_f32_16x16x32_bf16 v[184:187], v[116:119], v[36:39], v[184:187]
    ds_read_b64_tr_b16 v[112:113], v132 offset:20608
    ds_read_b64_tr_b16 v[114:115], v132 offset:23168
    s_waitcnt lgkmcnt(8)
    v_dot2_f32_bf16 v16, v40, v20, v16
    v_dot2_f32_bf16 v18, v40, v40, v18
    v_dot2_f32_bf16 v17, v41, v20, v17
    v_dot2_f32_bf16 v19, v41, v41, v19
    v_dot2_f32_bf16 v16, v42, v20, v16
    v_dot2_f32_bf16 v18, v42, v42, v18
    v_dot2_f32_bf16 v17, v43, v20, v17
    v_dot2_f32_bf16 v19, v43, v43, v19
    v_dot2_f32_bf16 v16, v44, v20, v16
    v_dot2_f32_bf16 v18, v44, v44, v18
    v_dot2_f32_bf16 v17, v45, v20, v17
    v_dot2_f32_bf16 v19, v45, v45, v19
    v_dot2_f32_bf16 v16, v46, v20, v16
    v_dot2_f32_bf16 v18, v46, v46, v18
    v_dot2_f32_bf16 v17, v47, v20, v17
    v_dot2_f32_bf16 v19, v47, v47, v19
    v_dot2_f32_bf16 v16, v48, v20, v16
    v_dot2_f32_bf16 v18, v48, v48, v18
    v_dot2_f32_bf16 v17, v49, v20, v17
    v_dot2_f32_bf16 v19, v49, v49, v19
    v_dot2_f32_bf16 v16, v50, v20, v16
    v_dot2_f32_bf16 v18, v50, v50, v18
    v_dot2_f32_bf16 v17, v51, v20, v17
    v_dot2_f32_bf16 v19, v51, v51, v19
    v_dot2_f32_bf16 v16, v52, v20, v16
    v_dot2_f32_bf16 v18, v52, v52, v18
    v_dot2_f32_bf16 v17, v53, v20, v17
    v_dot2_f32_bf16 v19, v53, v53, v19
    v_dot2_f32_bf16 v16, v54, v20, v16
    v_dot2_f32_bf16 v18, v54, v54, v18
    v_dot2_f32_bf16 v17, v55, v20, v17
    v_dot2_f32_bf16 v19, v55, v55, v19
    v_mfma_f32_16x16x32_bf16 v[160:163], v[120:123], v[40:43], v[160:163]
    v_mfma_f32_16x16x32_bf16 v[188:191], v[20:23], v[120:123], v[188:191]
    ds_read_b64_tr_b16 v[116:117], v136 offset:5120
    ds_read_b64_tr_b16 v[118:119], v136 offset:5280
    s_sub_u32 s57, s56, 2
    s_cselect_b32 s59, 5, 0
    s_add_u32 s57, s57, s59
    s_mul_i32 s58, s57, 163840
    s_add_u32 s58, s58, s37
    s_lshl_b32 s57, s57, 8
    s_add_u32 m0, s43, 0
    s_nop 0
    buffer_load_dwordx4 v145, s[16:19], s57 offen lds
    s_waitcnt lgkmcnt(8)
    v_mfma_f32_16x16x32_bf16 v[164:167], v[124:127], v[40:43], v[164:167]
    v_mfma_f32_16x16x32_bf16 v[192:195], v[20:23], v[124:127], v[192:195]
    ds_read_b64_tr_b16 v[120:121], v136 offset:5152
    ds_read_b64_tr_b16 v[122:123], v136 offset:5312
    s_add_u32 m0, s43, 1024
    s_nop 0
    buffer_load_dwordx4 v146, s[16:19], s57 offen lds
    s_waitcnt lgkmcnt(8)
    v_mfma_f32_16x16x32_bf16 v[168:171], v[104:107], v[40:43], v[168:171]
    v_mfma_f32_16x16x32_bf16 v[196:199], v[20:23], v[104:107], v[196:199]
    ds_read_b64_tr_b16 v[124:125], v133 offset:20480
    ds_read_b64_tr_b16 v[126:127], v133 offset:23040
    s_add_u32 m0, s43, 2048
    s_nop 0
    buffer_load_dwordx4 v147, s[16:19], s57 offen lds
    s_waitcnt lgkmcnt(8)
    v_mfma_f32_16x16x32_bf16 v[172:175], v[108:111], v[40:43], v[172:175]
    v_mfma_f32_16x16x32_bf16 v[200:203], v[20:23], v[108:111], v[200:203]
    ds_read_b64_tr_b16 v[104:105], v133 offset:20512
    ds_read_b64_tr_b16 v[106:107], v133 offset:23072
    s_add_u32 m0, s43, 3072
    s_nop 0
    buffer_load_dwordx4 v148, s[16:19], s57 offen lds
    s_waitcnt lgkmcnt(8)
    v_mfma_f32_16x16x32_bf16 v[176:179], v[112:115], v[40:43], v[176:179]
    v_mfma_f32_16x16x32_bf16 v[204:207], v[20:23], v[112:115], v[204:207]
    ds_read_b64_tr_b16 v[108:109], v133 offset:20544
    ds_read_b64_tr_b16 v[110:111], v133 offset:23104
    s_add_u32 m0, s41, 61440
    s_nop 0
    buffer_load_dwordx4 v5, s[20:23], s58 offen lds
    s_waitcnt lgkmcnt(8)
    v_mfma_f32_16x16x32_bf16 v[180:183], v[116:119], v[40:43], v[180:183]
    v_mfma_f32_16x16x32_bf16 v[208:211], v[20:23], v[116:119], v[208:211]
    ds_read_b64_tr_b16 v[112:113], v133 offset:20576
    ds_read_b64_tr_b16 v[114:115], v133 offset:23136
    s_add_u32 m0, s41, 62464
    s_nop 0
    buffer_load_dwordx4 v6, s[20:23], s58 offen lds
    s_waitcnt lgkmcnt(8)
    v_mfma_f32_16x16x32_bf16 v[184:187], v[120:123], v[40:43], v[184:187]
    v_mfma_f32_16x16x32_bf16 v[212:215], v[20:23], v[120:123], v[212:215]
    ds_read_b64_tr_b16 v[116:117], v133 offset:20608
    ds_read_b64_tr_b16 v[118:119], v133 offset:23168
    s_add_u32 m0, s41, 63488
    s_nop 0
    buffer_load_dwordx4 v7, s[20:23], s58 offen lds
    s_waitcnt lgkmcnt(8)
    v_mfma_f32_16x16x32_bf16 v[160:163], v[124:127], v[44:47], v[160:163]
    ds_read_b64_tr_b16 v[120:121], v137 offset:5120
    ds_read_b64_tr_b16 v[122:123], v137 offset:5280
    s_add_u32 m0, s41, 64512
    s_nop 0
    buffer_load_dwordx4 v8, s[20:23], s58 offen lds
    s_waitcnt lgkmcnt(8)
    v_mfma_f32_16x16x32_bf16 v[164:167], v[104:107], v[44:47], v[164:167]
    ds_read_b64_tr_b16 v[124:125], v137 offset:5152
    ds_read_b64_tr_b16 v[126:127], v137 offset:5312
    s_add_u32 m0, s41, 65536
    s_nop 0
    buffer_load_dwordx4 v9, s[20:23], s58 offen lds
    s_waitcnt lgkmcnt(8)
    v_mfma_f32_16x16x32_bf16 v[168:171], v[108:111], v[44:47], v[168:171]
    ds_read_b64_tr_b16 v[104:105], v134 offset:20480
    ds_read_b64_tr_b16 v[106:107], v134 offset:23040
    s_waitcnt lgkmcnt(8)
    v_mfma_f32_16x16x32_bf16 v[172:175], v[112:115], v[44:47], v[172:175]
    ds_read_b64_tr_b16 v[108:109], v134 offset:20512
    ds_read_b64_tr_b16 v[110:111], v134 offset:23072
    s_waitcnt lgkmcnt(8)
    v_mfma_f32_16x16x32_bf16 v[176:179], v[116:119], v[44:47], v[176:179]
    ds_read_b64_tr_b16 v[112:113], v134 offset:20544
    ds_read_b64_tr_b16 v[114:115], v134 offset:23104
    s_waitcnt lgkmcnt(8)
    v_mfma_f32_16x16x32_bf16 v[180:183], v[120:123], v[44:47], v[180:183]
    ds_read_b64_tr_b16 v[116:117], v134 offset:20576
    ds_read_b64_tr_b16 v[118:119], v134 offset:23136
    s_waitcnt lgkmcnt(8)
    v_mfma_f32_16x16x32_bf16 v[184:187], v[124:127], v[44:47], v[184:187]
    ds_read_b64_tr_b16 v[120:121], v134 offset:20608
    ds_read_b64_tr_b16 v[122:123], v134 offset:23168
    s_waitcnt lgkmcnt(8)
    v_mfma_f32_16x16x32_bf16 v[160:163], v[104:107], v[48:51], v[160:163]
    ds_read_b64_tr_b16 v[124:125], v138 offset:5120
    ds_read_b64_tr_b16 v[126:127], v138 offset:5280
    s_waitcnt lgkmcnt(8)
    v_mfma_f32_16x16x32_bf16 v[164:167], v[108:111], v[48:51], v[164:167]
    ds_read_b64_tr_b16 v[104:105], v138 offset:5152
    ds_read_b64_tr_b16 v[106:107], v138 offset:5312
    s_waitcnt lgkmcnt(8)
    v_mfma_f32_16x16x32_bf16 v[168:171], v[112:115], v[48:51], v[168:171]
    ds_read_b64_tr_b16 v[108:109], v135 offset:20480
    ds_read_b64_tr_b16 v[110:111], v135 offset:23040
    s_waitcnt lgkmcnt(8)
    v_mfma_f32_16x16x32_bf16 v[172:175], v[116:119], v[48:51], v[172:175]
    ds_read_b64_tr_b16 v[112:113], v135 offset:20512
    ds_read_b64_tr_b16 v[114:115], v135 offset:23072
    s_waitcnt lgkmcnt(8)
    v_mfma_f32_16x16x32_bf16 v[176:179], v[120:123], v[48:51], v[176:179]
    ds_read_b64_tr_b16 v[116:117], v135 offset:20544
    ds_read_b64_tr_b16 v[118:119], v135 offset:23104
    s_waitcnt lgkmcnt(8)
    v_mfma_f32_16x16x32_bf16 v[180:183], v[124:127], v[48:51], v[180:183]
    ds_read_b64_tr_b16 v[120:121], v135 offset:20576
    ds_read_b64_tr_b16 v[122:123], v135 offset:23136
    s_waitcnt lgkmcnt(8)
    v_mfma_f32_16x16x32_bf16 v[184:187], v[104:107], v[48:51], v[184:187]
    ds_read_b64_tr_b16 v[124:125], v135 offset:20608
    ds_read_b64_tr_b16 v[126:127], v135 offset:23168
    s_waitcnt lgkmcnt(8)
    v_mfma_f32_16x16x32_bf16 v[160:163], v[108:111], v[52:55], v[160:163]
    ds_read_b64_tr_b16 v[104:105], v139 offset:5120
    ds_read_b64_tr_b16 v[106:107], v139 offset:5280
    s_waitcnt lgkmcnt(8)
    v_mfma_f32_16x16x32_bf16 v[164:167], v[112:115], v[52:55], v[164:167]
    ds_read_b64_tr_b16 v[108:109], v139 offset:5152
    ds_read_b64_tr_b16 v[110:111], v139 offset:5312
    s_waitcnt lgkmcnt(8)
    v_mfma_f32_16x16x32_bf16 v[168:171], v[116:119], v[52:55], v[168:171]
    s_waitcnt vmcnt(9)
    ds_read_b128 v[24:27], v149 offset:32768
    ds_read_b128 v[28:31], v150 offset:32768
    ds_read_b128 v[32:35], v151 offset:32768
    ds_read_b128 v[36:39], v152 offset:32768
    s_barrier
    ds_read_b64_tr_b16 v[112:113], v132 offset:40960
    ds_read_b64_tr_b16 v[114:115], v132 offset:43520
    s_waitcnt lgkmcnt(8)
    v_mfma_f32_16x16x32_bf16 v[172:175], v[120:123], v[52:55], v[172:175]
    ds_read_b64_tr_b16 v[116:117], v132 offset:40992
    ds_read_b64_tr_b16 v[118:119], v132 offset:43552
    s_waitcnt lgkmcnt(8)
    v_mfma_f32_16x16x32_bf16 v[176:179], v[124:127], v[52:55], v[176:179]
    ds_read_b64_tr_b16 v[120:121], v132 offset:41024
    ds_read_b64_tr_b16 v[122:123], v132 offset:43584
    s_waitcnt lgkmcnt(8)
    v_mfma_f32_16x16x32_bf16 v[180:183], v[104:107], v[52:55], v[180:183]
    ds_read_b64_tr_b16 v[124:125], v132 offset:41056
    ds_read_b64_tr_b16 v[126:127], v132 offset:43616
    s_waitcnt lgkmcnt(8)
    v_mfma_f32_16x16x32_bf16 v[184:187], v[108:111], v[52:55], v[184:187]
    ds_read_b64_tr_b16 v[104:105], v132 offset:41088
    ds_read_b64_tr_b16 v[106:107], v132 offset:43648
    s_waitcnt lgkmcnt(8)
    v_dot2_f32_bf16 v16, v24, v20, v16
    v_dot2_f32_bf16 v18, v24, v24, v18
    v_dot2_f32_bf16 v17, v25, v20, v17
    v_dot2_f32_bf16 v19, v25, v25, v19
    v_dot2_f32_bf16 v16, v26, v20, v16
    v_dot2_f32_bf16 v18, v26, v26, v18
    v_dot2_f32_bf16 v17, v27, v20, v17
    v_dot2_f32_bf16 v19, v27, v27, v19
    v_dot2_f32_bf16 v16, v28, v20, v16
    v_dot2_f32_bf16 v18, v28, v28, v18
    v_dot2_f32_bf16 v17, v29, v20, v17
    v_dot2_f32_bf16 v19, v29, v29, v19
    v_dot2_f32_bf16 v16, v30, v20, v16
    v_dot2_f32_bf16 v18, v30, v30, v18
    v_dot2_f32_bf16 v17, v31, v20, v17
    v_dot2_f32_bf16 v19, v31, v31, v19
    v_dot2_f32_bf16 v16, v32, v20, v16
    v_dot2_f32_bf16 v18, v32, v32, v18
    v_dot2_f32_bf16 v17, v33, v20, v17
    v_dot2_f32_bf16 v19, v33, v33, v19
    v_dot2_f32_bf16 v16, v34, v20, v16
    v_dot2_f32_bf16 v18, v34, v34, v18
    v_dot2_f32_bf16 v17, v35, v20, v17
    v_dot2_f32_bf16 v19, v35, v35, v19
    v_dot2_f32_bf16 v16, v36, v20, v16
    v_dot2_f32_bf16 v18, v36, v36, v18
    v_dot2_f32_bf16 v17, v37, v20, v17
    v_dot2_f32_bf16 v19, v37, v37, v19
    v_dot2_f32_bf16 v16, v38, v20, v16
    v_dot2_f32_bf16 v18, v38, v38, v18
    v_dot2_f32_bf16 v17, v39, v20, v17
    v_dot2_f32_bf16 v19, v39, v39, v19
    v_mfma_f32_16x16x32_bf16 v[160:163], v[112:115], v[24:27], v[160:163]
    v_mfma_f32_16x16x32_bf16 v[188:191], v[20:23], v[112:115], v[188:191]
    ds_read_b64_tr_b16 v[108:109], v136 offset:10240
    ds_read_b64_tr_b16 v[110:111], v136 offset:10400
    s_sub_u32 s57, s56, 1
    s_cselect_b32 s59, 5, 0
    s_add_u32 s57, s57, s59
    s_mul_i32 s58, s57, 163840
    s_add_u32 s58, s58, s37
    s_lshl_b32 s57, s57, 8
    s_add_u32 m0, s43, 16384
    s_nop 0
    buffer_load_dwordx4 v145, s[16:19], s57 offen lds
    s_waitcnt lgkmcnt(8)
    v_mfma_f32_16x16x32_bf16 v[164:167], v[116:119], v[24:27], v[164:167]
    v_mfma_f32_16x16x32_bf16 v[192:195], v[20:23], v[116:119], v[192:195]
    ds_read_b64_tr_b16 v[112:113], v136 offset:10272
    ds_read_b64_tr_b16 v[114:115], v136 offset:10432
    s_add_u32 m0, s43, 17408
    s_nop 0
    buffer_load_dwordx4 v146, s[16:19], s57 offen lds
    s_waitcnt lgkmcnt(8)
    v_mfma_f32_16x16x32_bf16 v[168:171], v[120:123], v[24:27], v[168:171]
    v_mfma_f32_16x16x32_bf16 v[196:199], v[20:23], v[120:123], v[196:199]
    ds_read_b64_tr_b16 v[116:117], v133 offset:40960
    ds_read_b64_tr_b16 v[118:119], v133 offset:43520
    s_add_u32 m0, s43, 18432
    s_nop 0
    buffer_load_dwordx4 v147, s[16:19], s57 offen lds
    s_waitcnt lgkmcnt(8)
    v_mfma_f32_16x16x32_bf16 v[172:175], v[124:127], v[24:27], v[172:175]
    v_mfma_f32_16x16x32_bf16 v[200:203], v[20:23], v[124:127], v[200:203]
    ds_read_b64_tr_b16 v[120:121], v133 offset:40992
    ds_read_b64_tr_b16 v[122:123], v133 offset:43552
    s_add_u32 m0, s43, 19456
    s_nop 0
    buffer_load_dwordx4 v148, s[16:19], s57 offen lds
    s_waitcnt lgkmcnt(8)
    v_mfma_f32_16x16x32_bf16 v[176:179], v[104:107], v[24:27], v[176:179]
    v_mfma_f32_16x16x32_bf16 v[204:207], v[20:23], v[104:107], v[204:207]
    ds_read_b64_tr_b16 v[124:125], v133 offset:41024
    ds_read_b64_tr_b16 v[126:127], v133 offset:43584
    s_add_u32 m0, s41, 0
    s_nop 0
    buffer_load_dwordx4 v5, s[20:23], s58 offen lds
    s_waitcnt lgkmcnt(8)
    v_mfma_f32_16x16x32_bf16 v[180:183], v[108:111], v[24:27], v[180:183]
    v_mfma_f32_16x16x32_bf16 v[208:211], v[20:23], v[108:111], v[208:211]
    ds_read_b64_tr_b16 v[104:105], v133 offset:41056
    ds_read_b64_tr_b16 v[106:107], v133 offset:43616
    s_add_u32 m0, s41, 1024
    s_nop 0
    buffer_load_dwordx4 v6, s[20:23], s58 offen lds
    s_waitcnt lgkmcnt(8)
    v_mfma_f32_16x16x32_bf16 v[184:187], v[112:115], v[24:27], v[184:187]
    v_mfma_f32_16x16x32_bf16 v[212:215], v[20:23], v[112:115], v[212:215]
    ds_read_b64_tr_b16 v[108:109], v133 offset:41088
    ds_read_b64_tr_b16 v[110:111], v133 offset:43648
    s_add_u32 m0, s41, 2048
    s_nop 0
    buffer_load_dwordx4 v7, s[20:23], s58 offen lds
    s_waitcnt lgkmcnt(8)
    v_mfma_f32_16x16x32_bf16 v[160:163], v[116:119], v[28:31], v[160:163]
    ds_read_b64_tr_b16 v[112:113], v137 offset:10240
    ds_read_b64_tr_b16 v[114:115], v137 offset:10400
    s_add_u32 m0, s41, 3072
    s_nop 0
    buffer_load_dwordx4 v8, s[20:23], s58 offen lds
    s_waitcnt lgkmcnt(8)
    v_mfma_f32_16x16x32_bf16 v[164:167], v[120:123], v[28:31], v[164:167]
    ds_read_b64_tr_b16 v[116:117], v137 offset:10272
    ds_read_b64_tr_b16 v[118:119], v137 offset:10432
    s_add_u32 m0, s41, 4096
    s_nop 0
    buffer_load_dwordx4 v9, s[20:23], s58 offen lds
    s_waitcnt lgkmcnt(8)
    v_mfma_f32_16x16x32_bf16 v[168:171], v[124:127], v[28:31], v[168:171]
    ds_read_b64_tr_b16 v[120:121], v134 offset:40960
    ds_read_b64_tr_b16 v[122:123], v134 offset:43520
    s_waitcnt lgkmcnt(8)
    v_mfma_f32_16x16x32_bf16 v[172:175], v[104:107], v[28:31], v[172:175]
    ds_read_b64_tr_b16 v[124:125], v134 offset:40992
    ds_read_b64_tr_b16 v[126:127], v134 offset:43552
    s_waitcnt lgkmcnt(8)
    v_mfma_f32_16x16x32_bf16 v[176:179], v[108:111], v[28:31], v[176:179]
    ds_read_b64_tr_b16 v[104:105], v134 offset:41024
    ds_read_b64_tr_b16 v[106:107], v134 offset:43584
    s_waitcnt lgkmcnt(8)
    v_mfma_f32_16x16x32_bf16 v[180:183], v[112:115], v[28:31], v[180:183]
    ds_read_b64_tr_b16 v[108:109], v134 offset:41056
    ds_read_b64_tr_b16 v[110:111], v134 offset:43616
    s_waitcnt lgkmcnt(8)
    v_mfma_f32_16x16x32_bf16 v[184:187], v[116:119], v[28:31], v[184:187]
    ds_read_b64_tr_b16 v[112:113], v134 offset:41088
    ds_read_b64_tr_b16 v[114:115], v134 offset:43648
    s_waitcnt lgkmcnt(8)
    v_mfma_f32_16x16x32_bf16 v[160:163], v[120:123], v[32:35], v[160:163]
    ds_read_b64_tr_b16 v[116:117], v138 offset:10240
    ds_read_b64_tr_b16 v[118:119], v138 offset:10400
    s_waitcnt lgkmcnt(8)
    v_mfma_f32_16x16x32_bf16 v[164:167], v[124:127], v[32:35], v[164:167]
    ds_read_b64_tr_b16 v[120:121], v138 offset:10272
    ds_read_b64_tr_b16 v[122:123], v138 offset:10432
    s_waitcnt lgkmcnt(8)
    v_mfma_f32_16x16x32_bf16 v[168:171], v[104:107], v[32:35], v[168:171]
    ds_read_b64_tr_b16 v[124:125], v135 offset:40960
    ds_read_b64_tr_b16 v[126:127], v135 offset:43520
    s_waitcnt lgkmcnt(8)
    v_mfma_f32_16x16x32_bf16 v[172:175], v[108:111], v[32:35], v[172:175]
    ds_read_b64_tr_b16 v[104:105], v135 offset:40992
    ds_read_b64_tr_b16 v[106:107], v135 offset:43552
    s_waitcnt lgkmcnt(8)
    v_mfma_f32_16x16x32_bf16 v[176:179], v[112:115], v[32:35], v[176:179]
    ds_read_b64_tr_b16 v[108:109], v135 offset:41024
    ds_read_b64_tr_b16 v[110:111], v135 offset:43584
    s_waitcnt lgkmcnt(8)
    v_mfma_f32_16x16x32_bf16 v[180:183], v[116:119], v[32:35], v[180:183]
    ds_read_b64_tr_b16 v[112:113], v135 offset:41056
    ds_read_b64_tr_b16 v[114:115], v135 offset:43616
    s_waitcnt lgkmcnt(8)
    v_mfma_f32_16x16x32_bf16 v[184:187], v[120:123], v[32:35], v[184:187]
    ds_read_b64_tr_b16 v[116:117], v135 offset:41088
    ds_read_b64_tr_b16 v[118:119], v135 offset:43648
    s_waitcnt lgkmcnt(8)
    v_mfma_f32_16x16x32_bf16 v[160:163], v[124:127], v[36:39], v[160:163]
    ds_read_b64_tr_b16 v[120:121], v139 offset:10240
    ds_read_b64_tr_b16 v[122:123], v139 offset:10400
    s_waitcnt lgkmcnt(8)
    v_mfma_f32_16x16x32_bf16 v[164:167], v[104:107], v[36:39], v[164:167]
    ds_read_b64_tr_b16 v[124:125], v139 offset:10272
    ds_read_b64_tr_b16 v[126:127], v139 offset:10432
    s_waitcnt lgkmcnt(8)
    v_mfma_f32_16x16x32_bf16 v[168:171], v[108:111], v[36:39], v[168:171]
    s_waitcnt vmcnt(9)
    ds_read_b128 v[40:43], v149 offset:0
    ds_read_b128 v[44:47], v150 offset:0
    ds_read_b128 v[48:51], v151 offset:0
    ds_read_b128 v[52:55], v152 offset:0
    s_barrier
    ds_read_b64_tr_b16 v[104:105], v132 offset:61440
    ds_read_b64_tr_b16 v[106:107], v132 offset:64000
    s_waitcnt lgkmcnt(8)
    v_mfma_f32_16x16x32_bf16 v[172:175], v[112:115], v[36:39], v[172:175]
    ds_read_b64_tr_b16 v[108:109], v132 offset:61472
    ds_read_b64_tr_b16 v[110:111], v132 offset:64032
    s_waitcnt lgkmcnt(8)
    v_mfma_f32_16x16x32_bf16 v[176:179], v[116:119], v[36:39], v[176:179]
    ds_read_b64_tr_b16 v[112:113], v132 offset:61504
    ds_read_b64_tr_b16 v[114:115], v132 offset:64064
    s_waitcnt lgkmcnt(8)
    v_mfma_f32_16x16x32_bf16 v[180:183], v[120:123], v[36:39], v[180:183]
    ds_read_b64_tr_b16 v[116:117], v132 offset:61536
    ds_read_b64_tr_b16 v[118:119], v132 offset:64096
    s_waitcnt lgkmcnt(8)
    v_mfma_f32_16x16x32_bf16 v[184:187], v[124:127], v[36:39], v[184:187]
    ds_read_b64_tr_b16 v[120:121], v132 offset:61568
    ds_read_b64_tr_b16 v[122:123], v132 offset:64128
    s_waitcnt lgkmcnt(8)
    v_dot2_f32_bf16 v16, v40, v20, v16
    v_dot2_f32_bf16 v18, v40, v40, v18
    v_dot2_f32_bf16 v17, v41, v20, v17
    v_dot2_f32_bf16 v19, v41, v41, v19
    v_dot2_f32_bf16 v16, v42, v20, v16
    v_dot2_f32_bf16 v18, v42, v42, v18
    v_dot2_f32_bf16 v17, v43, v20, v17
    v_dot2_f32_bf16 v19, v43, v43, v19
    v_dot2_f32_bf16 v16, v44, v20, v16
    v_dot2_f32_bf16 v18, v44, v44, v18
    v_dot2_f32_bf16 v17, v45, v20, v17
    v_dot2_f32_bf16 v19, v45, v45, v19
    v_dot2_f32_bf16 v16, v46, v20, v16
    v_dot2_f32_bf16 v18, v46, v46, v18
    v_dot2_f32_bf16 v17, v47, v20, v17
    v_dot2_f32_bf16 v19, v47, v47, v19
    v_dot2_f32_bf16 v16, v48, v20, v16
    v_dot2_f32_bf16 v18, v48, v48, v18
    v_dot2_f32_bf16 v17, v49, v20, v17
    v_dot2_f32_bf16 v19, v49, v49, v19
    v_dot2_f32_bf16 v16, v50, v20, v16
    v_dot2_f32_bf16 v18, v50, v50, v18
    v_dot2_f32_bf16 v17, v51, v20, v17
    v_dot2_f32_bf16 v19, v51, v51, v19
    v_dot2_f32_bf16 v16, v52, v20, v16
    v_dot2_f32_bf16 v18, v52, v52, v18
    v_dot2_f32_bf16 v17, v53, v20, v17
    v_dot2_f32_bf16 v19, v53, v53, v19
    v_dot2_f32_bf16 v16, v54, v20, v16
    v_dot2_f32_bf16 v18, v54, v54, v18
    v_dot2_f32_bf16 v17, v55, v20, v17
    v_dot2_f32_bf16 v19, v55, v55, v19
    v_mfma_f32_16x16x32_bf16 v[160:163], v[104:107], v[40:43], v[160:163]
    v_mfma_f32_16x16x32_bf16 v[188:191], v[20:23], v[104:107], v[188:191]
    ds_read_b64_tr_b16 v[124:125], v136 offset:15360
    ds_read_b64_tr_b16 v[126:127], v136 offset:15520
    s_waitcnt lgkmcnt(8)
    v_mfma_f32_16x16x32_bf16 v[164:167], v[108:111], v[40:43], v[164:167]
    v_mfma_f32_16x16x32_bf16 v[192:195], v[20:23], v[108:111], v[192:195]
    ds_read_b64_tr_b16 v[104:105], v136 offset:15392
    ds_read_b64_tr_b16 v[106:107], v136 offset:15552
    s_waitcnt lgkmcnt(8)
    v_mfma_f32_16x16x32_bf16 v[168:171], v[112:115], v[40:43], v[168:171]
    v_mfma_f32_16x16x32_bf16 v[196:199], v[20:23], v[112:115], v[196:199]
    ds_read_b64_tr_b16 v[108:109], v133 offset:61440
    ds_read_b64_tr_b16 v[110:111], v133 offset:64000
    s_waitcnt lgkmcnt(8)
    v_mfma_f32_16x16x32_bf16 v[172:175], v[116:119], v[40:43], v[172:175]
    v_mfma_f32_16x16x32_bf16 v[200:203], v[20:23], v[116:119], v[200:203]
    ds_read_b64_tr_b16 v[112:113], v133 offset:61472
    ds_read_b64_tr_b16 v[114:115], v133 offset:64032
    s_waitcnt lgkmcnt(8)
    v_mfma_f32_16x16x32_bf16 v[176:179], v[120:123], v[40:43], v[176:179]
    v_mfma_f32_16x16x32_bf16 v[204:207], v[20:23], v[120:123], v[204:207]
    ds_read_b64_tr_b16 v[116:117], v133 offset:61504
    ds_read_b64_tr_b16 v[118:119], v133 offset:64064
    s_waitcnt lgkmcnt(8)
    v_mfma_f32_16x16x32_bf16 v[180:183], v[124:127], v[40:43], v[180:183]
    v_mfma_f32_16x16x32_bf16 v[208:211], v[20:23], v[124:127], v[208:211]
    ds_read_b64_tr_b16 v[120:121], v133 offset:61536
    ds_read_b64_tr_b16 v[122:123], v133 offset:64096
    s_waitcnt lgkmcnt(8)
    v_mfma_f32_16x16x32_bf16 v[184:187], v[104:107], v[40:43], v[184:187]
    v_mfma_f32_16x16x32_bf16 v[212:215], v[20:23], v[104:107], v[212:215]
    ds_read_b64_tr_b16 v[124:125], v133 offset:61568
    ds_read_b64_tr_b16 v[126:127], v133 offset:64128
    s_waitcnt lgkmcnt(8)
    v_mfma_f32_16x16x32_bf16 v[160:163], v[108:111], v[44:47], v[160:163]
    ds_read_b64_tr_b16 v[104:105], v137 offset:15360
    ds_read_b64_tr_b16 v[106:107], v137 offset:15520
    s_waitcnt lgkmcnt(8)
    v_mfma_f32_16x16x32_bf16 v[164:167], v[112:115], v[44:47], v[164:167]
    ds_read_b64_tr_b16 v[108:109], v137 offset:15392
    ds_read_b64_tr_b16 v[110:111], v137 offset:15552
    s_waitcnt lgkmcnt(8)
    v_mfma_f32_16x16x32_bf16 v[168:171], v[116:119], v[44:47], v[168:171]
    ds_read_b64_tr_b16 v[112:113], v134 offset:61440
    ds_read_b64_tr_b16 v[114:115], v134 offset:64000
    s_waitcnt lgkmcnt(8)
    v_mfma_f32_16x16x32_bf16 v[172:175], v[120:123], v[44:47], v[172:175]
    ds_read_b64_tr_b16 v[116:117], v134 offset:61472
    ds_read_b64_tr_b16 v[118:119], v134 offset:64032
    s_waitcnt lgkmcnt(8)
    v_mfma_f32_16x16x32_bf16 v[176:179], v[124:127], v[44:47], v[176:179]
    ds_read_b64_tr_b16 v[120:121], v134 offset:61504
    ds_read_b64_tr_b16 v[122:123], v134 offset:64064
    s_waitcnt lgkmcnt(8)
    v_mfma_f32_16x16x32_bf16 v[180:183], v[104:107], v[44:47], v[180:183]
    ds_read_b64_tr_b16 v[124:125], v134 offset:61536
    ds_read_b64_tr_b16 v[126:127], v134 offset:64096
    s_waitcnt lgkmcnt(8)
    v_mfma_f32_16x16x32_bf16 v[184:187], v[108:111], v[44:47], v[184:187]
    ds_read_b64_tr_b16 v[104:105], v134 offset:61568
    ds_read_b64_tr_b16 v[106:107], v134 offset:64128
    s_waitcnt lgkmcnt(8)
    v_mfma_f32_16x16x32_bf16 v[160:163], v[112:115], v[48:51], v[160:163]
    ds_read_b64_tr_b16 v[108:109], v138 offset:15360
    ds_read_b64_tr_b16 v[110:111], v138 offset:15520
    s_waitcnt lgkmcnt(8)
    v_mfma_f32_16x16x32_bf16 v[164:167], v[116:119], v[48:51], v[164:167]
    ds_read_b64_tr_b16 v[112:113], v138 offset:15392
    ds_read_b64_tr_b16 v[114:115], v138 offset:15552
    s_waitcnt lgkmcnt(8)
    v_mfma_f32_16x16x32_bf16 v[168:171], v[120:123], v[48:51], v[168:171]
    ds_read_b64_tr_b16 v[116:117], v135 offset:61440
    ds_read_b64_tr_b16 v[118:119], v135 offset:64000
    s_waitcnt lgkmcnt(8)
    v_mfma_f32_16x16x32_bf16 v[172:175], v[124:127], v[48:51], v[172:175]
    ds_read_b64_tr_b16 v[120:121], v135 offset:61472
    ds_read_b64_tr_b16 v[122:123], v135 offset:64032
    s_waitcnt lgkmcnt(8)
    v_mfma_f32_16x16x32_bf16 v[176:179], v[104:107], v[48:51], v[176:179]
    ds_read_b64_tr_b16 v[124:125], v135 offset:61504
    ds_read_b64_tr_b16 v[126:127], v135 offset:64064
    s_waitcnt lgkmcnt(8)
    v_mfma_f32_16x16x32_bf16 v[180:183], v[108:111], v[48:51], v[180:183]
    ds_read_b64_tr_b16 v[104:105], v135 offset:61536
    ds_read_b64_tr_b16 v[106:107], v135 offset:64096
    s_waitcnt lgkmcnt(8)
    v_mfma_f32_16x16x32_bf16 v[184:187], v[112:115], v[48:51], v[184:187]
    ds_read_b64_tr_b16 v[108:109], v135 offset:61568
    ds_read_b64_tr_b16 v[110:111], v135 offset:64128
    s_waitcnt lgkmcnt(8)
    v_mfma_f32_16x16x32_bf16 v[160:163], v[116:119], v[52:55], v[160:163]
    ds_read_b64_tr_b16 v[112:113], v139 offset:15360
    ds_read_b64_tr_b16 v[114:115], v139 offset:15520
    s_waitcnt lgkmcnt(8)
    v_mfma_f32_16x16x32_bf16 v[164:167], v[120:123], v[52:55], v[164:167]
    ds_read_b64_tr_b16 v[116:117], v139 offset:15392
    ds_read_b64_tr_b16 v[118:119], v139 offset:15552
    s_waitcnt lgkmcnt(8)
    v_mfma_f32_16x16x32_bf16 v[168:171], v[124:127], v[52:55], v[168:171]
    s_waitcnt vmcnt(0)
    ds_read_b128 v[24:27], v149 offset:16384
    ds_read_b128 v[28:31], v150 offset:16384
    ds_read_b128 v[32:35], v151 offset:16384
    ds_read_b128 v[36:39], v152 offset:16384
    s_barrier
    ds_read_b64_tr_b16 v[120:121], v132 offset:0
    ds_read_b64_tr_b16 v[122:123], v132 offset:2560
    s_waitcnt lgkmcnt(8)
    v_mfma_f32_16x16x32_bf16 v[172:175], v[104:107], v[52:55], v[172:175]
    ds_read_b64_tr_b16 v[124:125], v132 offset:32
    ds_read_b64_tr_b16 v[126:127], v132 offset:2592
    s_waitcnt lgkmcnt(8)
    v_mfma_f32_16x16x32_bf16 v[176:179], v[108:111], v[52:55], v[176:179]
    ds_read_b64_tr_b16 v[104:105], v132 offset:64
    ds_read_b64_tr_b16 v[106:107], v132 offset:2624
    s_waitcnt lgkmcnt(8)
    v_mfma_f32_16x16x32_bf16 v[180:183], v[112:115], v[52:55], v[180:183]
    ds_read_b64_tr_b16 v[108:109], v132 offset:96
    ds_read_b64_tr_b16 v[110:111], v132 offset:2656
    s_waitcnt lgkmcnt(8)
    v_mfma_f32_16x16x32_bf16 v[184:187], v[116:119], v[52:55], v[184:187]
    ds_read_b64_tr_b16 v[112:113], v132 offset:128
    ds_read_b64_tr_b16 v[114:115], v132 offset:2688
    s_waitcnt lgkmcnt(8)
    v_dot2_f32_bf16 v16, v24, v20, v16
    v_dot2_f32_bf16 v18, v24, v24, v18
    v_dot2_f32_bf16 v17, v25, v20, v17
    v_dot2_f32_bf16 v19, v25, v25, v19
    v_dot2_f32_bf16 v16, v26, v20, v16
    v_dot2_f32_bf16 v18, v26, v26, v18
    v_dot2_f32_bf16 v17, v27, v20, v17
    v_dot2_f32_bf16 v19, v27, v27, v19
    v_dot2_f32_bf16 v16, v28, v20, v16
    v_dot2_f32_bf16 v18, v28, v28, v18
    v_dot2_f32_bf16 v17, v29, v20, v17
    v_dot2_f32_bf16 v19, v29, v29, v19
    v_dot2_f32_bf16 v16, v30, v20, v16
    v_dot2_f32_bf16 v18, v30, v30, v18
    v_dot2_f32_bf16 v17, v31, v20, v17
    v_dot2_f32_bf16 v19, v31, v31, v19
    v_dot2_f32_bf16 v16, v32, v20, v16
    v_dot2_f32_bf16 v18, v32, v32, v18
    v_dot2_f32_bf16 v17, v33, v20, v17
    v_dot2_f32_bf16 v19, v33, v33, v19
    v_dot2_f32_bf16 v16, v34, v20, v16
    v_dot2_f32_bf16 v18, v34, v34, v18
    v_dot2_f32_bf16 v17, v35, v20, v17
    v_dot2_f32_bf16 v19, v35, v35, v19
    v_dot2_f32_bf16 v16, v36, v20, v16
    v_dot2_f32_bf16 v18, v36, v36, v18
    v_dot2_f32_bf16 v17, v37, v20, v17
    v_dot2_f32_bf16 v19, v37, v37, v19
    v_dot2_f32_bf16 v16, v38, v20, v16
    v_dot2_f32_bf16 v18, v38, v38, v18
    v_dot2_f32_bf16 v17, v39, v20, v17
    v_dot2_f32_bf16 v19, v39, v39, v19
    v_mfma_f32_16x16x32_bf16 v[160:163], v[120:123], v[24:27], v[160:163]
    v_mfma_f32_16x16x32_bf16 v[188:191], v[20:23], v[120:123], v[188:191]
    ds_read_b64_tr_b16 v[116:117], v136 offset:20480
    ds_read_b64_tr_b16 v[118:119], v136 offset:20640
    s_waitcnt lgkmcnt(8)
    v_mfma_f32_16x16x32_bf16 v[164:167], v[124:127], v[24:27], v[164:167]
    v_mfma_f32_16x16x32_bf16 v[192:195], v[20:23], v[124:127], v[192:195]
    ds_read_b64_tr_b16 v[120:121], v136 offset:20512
    ds_read_b64_tr_b16 v[122:123], v136 offset:20672
    s_waitcnt lgkmcnt(8)
    v_mfma_f32_16x16x32_bf16 v[168:171], v[104:107], v[24:27], v[168:171]
    v_mfma_f32_16x16x32_bf16 v[196:199], v[20:23], v[104:107], v[196:199]
    ds_read_b64_tr_b16 v[124:125], v133 offset:0
    ds_read_b64_tr_b16 v[126:127], v133 offset:2560
    s_waitcnt lgkmcnt(8)
    v_mfma_f32_16x16x32_bf16 v[172:175], v[108:111], v[24:27], v[172:175]
    v_mfma_f32_16x16x32_bf16 v[200:203], v[20:23], v[108:111], v[200:203]
    ds_read_b64_tr_b16 v[104:105], v133 offset:32
    ds_read_b64_tr_b16 v[106:107], v133 offset:2592
    s_waitcnt lgkmcnt(8)
    v_mfma_f32_16x16x32_bf16 v[176:179], v[112:115], v[24:27], v[176:179]
    v_mfma_f32_16x16x32_bf16 v[204:207], v[20:23], v[112:115], v[204:207]
    ds_read_b64_tr_b16 v[108:109], v133 offset:64
    ds_read_b64_tr_b16 v[110:111], v133 offset:2624
    s_waitcnt lgkmcnt(8)
    v_mfma_f32_16x16x32_bf16 v[180:183], v[116:119], v[24:27], v[180:183]
    v_mfma_f32_16x16x32_bf16 v[208:211], v[20:23], v[116:119], v[208:211]
    ds_read_b64_tr_b16 v[112:113], v133 offset:96
    ds_read_b64_tr_b16 v[114:115], v133 offset:2656
    s_waitcnt lgkmcnt(8)
    v_mfma_f32_16x16x32_bf16 v[184:187], v[120:123], v[24:27], v[184:187]
    v_mfma_f32_16x16x32_bf16 v[212:215], v[20:23], v[120:123], v[212:215]
    ds_read_b64_tr_b16 v[116:117], v133 offset:128
    ds_read_b64_tr_b16 v[118:119], v133 offset:2688
    s_waitcnt lgkmcnt(8)
    v_mfma_f32_16x16x32_bf16 v[160:163], v[124:127], v[28:31], v[160:163]
    ds_read_b64_tr_b16 v[120:121], v137 offset:20480
    ds_read_b64_tr_b16 v[122:123], v137 offset:20640
    s_waitcnt lgkmcnt(8)
    v_mfma_f32_16x16x32_bf16 v[164:167], v[104:107], v[28:31], v[164:167]
    ds_read_b64_tr_b16 v[124:125], v137 offset:20512
    ds_read_b64_tr_b16 v[126:127], v137 offset:20672
    s_waitcnt lgkmcnt(8)
    v_mfma_f32_16x16x32_bf16 v[168:171], v[108:111], v[28:31], v[168:171]
    ds_read_b64_tr_b16 v[104:105], v134 offset:0
    ds_read_b64_tr_b16 v[106:107], v134 offset:2560
    s_waitcnt lgkmcnt(8)
    v_mfma_f32_16x16x32_bf16 v[172:175], v[112:115], v[28:31], v[172:175]
    ds_read_b64_tr_b16 v[108:109], v134 offset:32
    ds_read_b64_tr_b16 v[110:111], v134 offset:2592
    s_waitcnt lgkmcnt(8)
    v_mfma_f32_16x16x32_bf16 v[176:179], v[116:119], v[28:31], v[176:179]
    ds_read_b64_tr_b16 v[112:113], v134 offset:64
    ds_read_b64_tr_b16 v[114:115], v134 offset:2624
    s_waitcnt lgkmcnt(8)
    v_mfma_f32_16x16x32_bf16 v[180:183], v[120:123], v[28:31], v[180:183]
    ds_read_b64_tr_b16 v[116:117], v134 offset:96
    ds_read_b64_tr_b16 v[118:119], v134 offset:2656
    s_waitcnt lgkmcnt(8)
    v_mfma_f32_16x16x32_bf16 v[184:187], v[124:127], v[28:31], v[184:187]
    ds_read_b64_tr_b16 v[120:121], v134 offset:128
    ds_read_b64_tr_b16 v[122:123], v134 offset:2688
    s_waitcnt lgkmcnt(8)
    v_mfma_f32_16x16x32_bf16 v[160:163], v[104:107], v[32:35], v[160:163]
    ds_read_b64_tr_b16 v[124:125], v138 offset:20480
    ds_read_b64_tr_b16 v[126:127], v138 offset:20640
    s_waitcnt lgkmcnt(8)
    v_mfma_f32_16x16x32_bf16 v[164:167], v[108:111], v[32:35], v[164:167]
    ds_read_b64_tr_b16 v[104:105], v138 offset:20512
    ds_read_b64_tr_b16 v[106:107], v138 offset:20672
    s_waitcnt lgkmcnt(8)
    v_mfma_f32_16x16x32_bf16 v[168:171], v[112:115], v[32:35], v[168:171]
    ds_read_b64_tr_b16 v[108:109], v135 offset:0
    ds_read_b64_tr_b16 v[110:111], v135 offset:2560
    s_waitcnt lgkmcnt(8)
    v_mfma_f32_16x16x32_bf16 v[172:175], v[116:119], v[32:35], v[172:175]
    ds_read_b64_tr_b16 v[112:113], v135 offset:32
    ds_read_b64_tr_b16 v[114:115], v135 offset:2592
    s_waitcnt lgkmcnt(8)
    v_mfma_f32_16x16x32_bf16 v[176:179], v[120:123], v[32:35], v[176:179]
    ds_read_b64_tr_b16 v[116:117], v135 offset:64
    ds_read_b64_tr_b16 v[118:119], v135 offset:2624
    s_waitcnt lgkmcnt(8)
    v_mfma_f32_16x16x32_bf16 v[180:183], v[124:127], v[32:35], v[180:183]
    ds_read_b64_tr_b16 v[120:121], v135 offset:96
    ds_read_b64_tr_b16 v[122:123], v135 offset:2656
    s_waitcnt lgkmcnt(8)
    v_mfma_f32_16x16x32_bf16 v[184:187], v[104:107], v[32:35], v[184:187]
    ds_read_b64_tr_b16 v[124:125], v135 offset:128
    ds_read_b64_tr_b16 v[126:127], v135 offset:2688
    s_waitcnt lgkmcnt(8)
    v_mfma_f32_16x16x32_bf16 v[160:163], v[108:111], v[36:39], v[160:163]
    ds_read_b64_tr_b16 v[104:105], v139 offset:20480
    ds_read_b64_tr_b16 v[106:107], v139 offset:20640
    s_waitcnt lgkmcnt(8)
    v_mfma_f32_16x16x32_bf16 v[164:167], v[112:115], v[36:39], v[164:167]
    ds_read_b64_tr_b16 v[108:109], v139 offset:20512
    ds_read_b64_tr_b16 v[110:111], v139 offset:20672
    s_waitcnt lgkmcnt(8)
    v_mfma_f32_16x16x32_bf16 v[168:171], v[116:119], v[36:39], v[168:171]
    s_waitcnt lgkmcnt(6)
    v_mfma_f32_16x16x32_bf16 v[172:175], v[120:123], v[36:39], v[172:175]
    s_waitcnt lgkmcnt(4)
    v_mfma_f32_16x16x32_bf16 v[176:179], v[124:127], v[36:39], v[176:179]
    s_waitcnt lgkmcnt(2)
    v_mfma_f32_16x16x32_bf16 v[180:183], v[104:107], v[36:39], v[180:183]
    s_waitcnt lgkmcnt(0)
    v_mfma_f32_16x16x32_bf16 v[184:187], v[108:111], v[36:39], v[184:187]
    s_branch k1_epi
k1_loop_v:
    s_waitcnt vmcnt(10)
    ds_read_b128 v[24:27], v149 offset:0
    ds_read_b128 v[28:31], v150 offset:0
    ds_read_b128 v[32:35], v151 offset:0
    ds_read_b128 v[36:39], v152 offset:0
    s_barrier
    ds_read_b64_tr_b16 v[104:105], v132 offset:0
    ds_read_b64_tr_b16 v[106:107], v132 offset:2560
    ds_read_b64_tr_b16 v[108:109], v132 offset:32
    ds_read_b64_tr_b16 v[110:111], v132 offset:2592
    ds_read_b64_tr_b16 v[112:113], v132 offset:64
    ds_read_b64_tr_b16 v[114:115], v132 offset:2624
    ds_read_b64_tr_b16 v[116:117], v132 offset:96
    ds_read_b64_tr_b16 v[118:119], v132 offset:2656
    ds_read_b64_tr_b16 v[120:121], v132 offset:128
    ds_read_b64_tr_b16 v[122:123], v132 offset:2688
    s_waitcnt lgkmcnt(8)
    v_dot2_f32_bf16 v16, v24, v20, v16
    v_dot2_f32_bf16 v18, v24, v24, v18
    v_dot2_f32_bf16 v17, v25, v20, v17
    v_dot2_f32_bf16 v19, v25, v25, v19
    v_dot2_f32_bf16 v16, v26, v20, v16
    v_dot2_f32_bf16 v18, v26, v26, v18
    v_dot2_f32_bf16 v17, v27, v20, v17
    v_dot2_f32_bf16 v19, v27, v27, v19
    v_dot2_f32_bf16 v16, v28, v20, v16
    v_dot2_f32_bf16 v18, v28, v28, v18
    v_dot2_f32_bf16 v17, v29, v20, v17
    v_dot2_f32_bf16 v19, v29, v29, v19
    v_dot2_f32_bf16 v16, v30, v20, v16
    v_dot2_f32_bf16 v18, v30, v30, v18
    v_dot2_f32_bf16 v17, v31, v20, v17
    v_dot2_f32_bf16 v19, v31, v31, v19
    v_dot2_f32_bf16 v16, v32, v20, v16
    v_dot2_f32_bf16 v18, v32, v32, v18
    v_dot2_f32_bf16 v17, v33, v20, v17
    v_dot2_f32_bf16 v19, v33, v33, v19
    v_dot2_f32_bf16 v16, v34, v20, v16
    v_dot2_f32_bf16 v18, v34, v34, v18
    v_dot2_f32_bf16 v17, v35, v20, v17
    v_dot2_f32_bf16 v19, v35, v35, v19
    v_dot2_f32_bf16 v16, v36, v20, v16
    v_dot2_f32_bf16 v18, v36, v36, v18
    v_dot2_f32_bf16 v17, v37, v20, v17
    v_dot2_f32_bf16 v19, v37, v37, v19
    v_dot2_f32_bf16 v16, v38, v20, v16
    v_dot2_f32_bf16 v18, v38, v38, v18
    v_dot2_f32_bf16 v17, v39, v20, v17
    v_dot2_f32_bf16 v19, v39, v39, v19
    v_mfma_f32_16x16x32_bf16 v[160:163], v[104:107], v[24:27], v[160:163]
    v_mfma_f32_16x16x32_bf16 v[188:191], v[20:23], v[104:107], v[188:191]
    ds_read_b64_tr_b16 v[124:125], v136 offset:0
    ds_read_b64_tr_b16 v[126:127], v136 offset:160
    s_sub_u32 s57, s56, 3
    s_cselect_b32 s59, 5, 0
    s_add_u32 s57, s57, s59
    s_mul_i32 s58, s57, 163840
    s_add_u32 s58, s58, s37
    s_lshl_b32 s57, s57, 8
    s_add_u32 m0, s43, 32768
    s_nop 0
    buffer_load_dwordx4 v145, s[16:19], s57 offen lds
    s_waitcnt lgkmcnt(8)
    v_mfma_f32_16x16x32_bf16 v[164:167], v[108:111], v[24:27], v[164:167]
    v_mfma_f32_16x16x32_bf16 v[192:195], v[20:23], v[108:111], v[192:195]
    ds_read_b64_tr_b16 v[104:105], v136 offset:32
    ds_read_b64_tr_b16 v[106:107], v136 offset:192
    s_add_u32 m0, s43, 33792
    s_nop 0
    buffer_load_dwordx4 v146, s[16:19], s57 offen lds
    s_waitcnt lgkmcnt(8)
    v_mfma_f32_16x16x32_bf16 v[168:171], v[112:115], v[24:27], v[168:171]
    v_mfma_f32_16x16x32_bf16 v[196:199], v[20:23], v[112:115], v[196:199]
    ds_read_b64_tr_b16 v[108:109], v133 offset:0
    ds_read_b64_tr_b16 v[110:111], v133 offset:2560
    s_add_u32 m0, s43, 34816
    s_nop 0
    buffer_load_dwordx4 v147, s[16:19], s57 offen lds
    s_waitcnt lgkmcnt(8)
    v_mfma_f32_16x16x32_bf16 v[172:175], v[116:119], v[24:27], v[172:175]
    v_mfma_f32_16x16x32_bf16 v[200:203], v[20:23], v[116:119], v[200:203]
    ds_read_b64_tr_b16 v[112:113], v133 offset:32
    ds_read_b64_tr_b16 v[114:115], v133 offset:2592
    s_add_u32 m0, s43, 35840
    s_nop 0
    buffer_load_dwordx4 v148, s[16:19], s57 offen lds
    s_waitcnt lgkmcnt(8)
    v_mfma_f32_16x16x32_bf16 v[176:179], v[120:123], v[24:27], v[176:179]
    v_mfma_f32_16x16x32_bf16 v[204:207], v[20:23], v[120:123], v[204:207]
    ds_read_b64_tr_b16 v[116:117], v133 offset:64
    ds_read_b64_tr_b16 v[118:119], v133 offset:2624
    s_add_u32 m0, s41, 40960
    s_nop 0
    buffer_load_dwordx4 v5, s[20:23], s58 offen lds
    s_waitcnt lgkmcnt(8)
    v_mfma_f32_16x16x32_bf16 v[180:183], v[24:27], v[124:127], v[180:183]
    v_mfma_f32_16x16x32_bf16 v[208:211], v[20:23], v[124:127], v[208:211]
    ds_read_b64_tr_b16 v[120:121], v133 offset:96
    ds_read_b64_tr_b16 v[122:123], v133 offset:2656
    s_add_u32 m0, s41, 41984
    s_nop 0
    buffer_load_dwordx4 v6, s[20:23], s58 offen lds
    s_waitcnt lgkmcnt(8)
    v_mfma_f32_16x16x32_bf16 v[184:187], v[24:27], v[104:107], v[184:187]
    v_mfma_f32_16x16x32_bf16 v[212:215], v[20:23], v[104:107], v[212:215]
    ds_read_b64_tr_b16 v[124:125], v133 offset:128
    ds_read_b64_tr_b16 v[126:127], v133 offset:2688
    s_add_u32 m0, s41, 43008
    s_nop 0
    buffer_load_dwordx4 v7, s[20:23], s58 offen lds
    s_waitcnt lgkmcnt(8)
    v_mfma_f32_16x16x32_bf16 v[160:163], v[108:111], v[28:31], v[160:163]
    ds_read_b64_tr_b16 v[104:105], v137 offset:0
    ds_read_b64_tr_b16 v[106:107], v137 offset:160
    s_add_u32 m0, s41, 44032
    s_nop 0
    buffer_load_dwordx4 v8, s[20:23], s58 offen lds
    s_waitcnt lgkmcnt(8)
    v_mfma_f32_16x16x32_bf16 v[164:167], v[112:115], v[28:31], v[164:167]
    ds_read_b64_tr_b16 v[108:109], v137 offset:32
    ds_read_b64_tr_b16 v[110:111], v137 offset:192
    s_add_u32 m0, s41, 45056
    s_nop 0
    buffer_load_dwordx4 v9, s[20:23], s58 offen lds
    s_waitcnt lgkmcnt(8)
    v_mfma_f32_16x16x32_bf16 v[168:171], v[116:119], v[28:31], v[168:171]
    ds_read_b64_tr_b16 v[112:113], v134 offset:0
    ds_read_b64_tr_b16 v[114:115], v134 offset:2560
    s_waitcnt lgkmcnt(8)
    v_mfma_f32_16x16x32_bf16 v[172:175], v[120:123], v[28:31], v[172:175]
    ds_read_b64_tr_b16 v[116:117], v134 offset:32
    ds_read_b64_tr_b16 v[118:119], v134 offset:2592
    s_waitcnt lgkmcnt(8)
    v_mfma_f32_16x16x32_bf16 v[176:179], v[124:127], v[28:31], v[176:179]
    ds_read_b64_tr_b16 v[120:121], v134 offset:64
    ds_read_b64_tr_b16 v[122:123], v134 offset:2624
    s_waitcnt lgkmcnt(8)
    v_mfma_f32_16x16x32_bf16 v[180:183], v[28:31], v[104:107], v[180:183]
    ds_read_b64_tr_b16 v[124:125], v134 offset:96
    ds_read_b64_tr_b16 v[126:127], v134 offset:2656
    s_waitcnt lgkmcnt(8)
    v_mfma_f32_16x16x32_bf16 v[184:187], v[28:31], v[108:111], v[184:187]
    ds_read_b64_tr_b16 v[104:105], v134 offset:128
    ds_read_b64_tr_b16 v[106:107], v134 offset:2688
    s_waitcnt lgkmcnt(8)
    v_mfma_f32_16x16x32_bf16 v[160:163], v[112:115], v[32:35], v[160:163]
    ds_read_b64_tr_b16 v[108:109], v138 offset:0
    ds_read_b64_tr_b16 v[110:111], v138 offset:160
    s_waitcnt lgkmcnt(8)
    v_mfma_f32_16x16x32_bf16 v[164:167], v[116:119], v[32:35], v[164:167]
    ds_read_b64_tr_b16 v[112:113], v138 offset:32
    ds_read_b64_tr_b16 v[114:115], v138 offset:192
    s_waitcnt lgkmcnt(8)
    v_mfma_f32_16x16x32_bf16 v[168:171], v[120:123], v[32:35], v[168:171]
    ds_read_b64_tr_b16 v[116:117], v135 offset:0
    ds_read_b64_tr_b16 v[118:119], v135 offset:2560
    s_waitcnt lgkmcnt(8)
    v_mfma_f32_16x16x32_bf16 v[172:175], v[124:127], v[32:35], v[172:175]
    ds_read_b64_tr_b16 v[120:121], v135 offset:32
    ds_read_b64_tr_b16 v[122:123], v135 offset:2592
    s_waitcnt lgkmcnt(8)
    v_mfma_f32_16x16x32_bf16 v[176:179], v[104:107], v[32:35], v[176:179]
    ds_read_b64_tr_b16 v[124:125], v135 offset:64
    ds_read_b64_tr_b16 v[126:127], v135 offset:2624
    s_waitcnt lgkmcnt(8)
    v_mfma_f32_16x16x32_bf16 v[180:183], v[32:35], v[108:111], v[180:183]
    ds_read_b64_tr_b16 v[104:105], v135 offset:96
    ds_read_b64_tr_b16 v[106:107], v135 offset:2656
    s_waitcnt lgkmcnt(8)
    v_mfma_f32_16x16x32_bf16 v[184:187], v[32:35], v[112:115], v[184:187]
    ds_read_b64_tr_b16 v[108:109], v135 offset:128
    ds_read_b64_tr_b16 v[110:111], v135 offset:2688
    s_waitcnt lgkmcnt(8)
    v_mfma_f32_16x16x32_bf16 v[160:163], v[116:119], v[36:39], v[160:163]
    ds_read_b64_tr_b16 v[112:113], v139 offset:0
    ds_read_b64_tr_b16 v[114:115], v139 offset:160
    s_waitcnt lgkmcnt(8)
    v_mfma_f32_16x16x32_bf16 v[164:167], v[120:123], v[36:39], v[164:167]
    ds_read_b64_tr_b16 v[116:117], v139 offset:32
    ds_read_b64_tr_b16 v[118:119], v139 offset:192
    s_waitcnt lgkmcnt(8)
    v_mfma_f32_16x16x32_bf16 v[168:171], v[124:127], v[36:39], v[168:171]
    s_waitcnt vmcnt(9)
    ds_read_b128 v[40:43], v149 offset:16384
    ds_read_b128 v[44:47], v150 offset:16384
    ds_read_b128 v[48:51], v151 offset:16384
    ds_read_b128 v[52:55], v152 offset:16384
    s_barrier
    ds_read_b64_tr_b16 v[120:121], v132 offset:20480
    ds_read_b64_tr_b16 v[122:123], v132 offset:23040
    s_waitcnt lgkmcnt(8)
    v_mfma_f32_16x16x32_bf16 v[172:175], v[104:107], v[36:39], v[172:175]
    ds_read_b64_tr_b16 v[124:125], v132 offset:20512
    ds_read_b64_tr_b16 v[126:127], v132 offset:23072
    s_waitcnt lgkmcnt(8)
    v_mfma_f32_16x16x32_bf16 v[176:179], v[108:111], v[36:39], v[176:179]
    ds_read_b64_tr_b16 v[104:105], v132 offset:20544
    ds_read_b64_tr_b16 v[106:107], v132 offset:23104
    s_waitcnt lgkmcnt(8)
    v_mfma_f32_16x16x32_bf16 v[180:183], v[36:39], v[112:115], v[180:183]
    ds_read_b64_tr_b16 v[108:109], v132 offset:20576
    ds_read_b64_tr_b16 v[110:111], v132 offset:23136
    s_waitcnt lgkmcnt(8)
    v_mfma_f32_16x16x32_bf16 v[184:187], v[36:39], v[116:119], v[184:187]
    ds_read_b64_tr_b16 v[112:113], v132 offset:20608
    ds_read_b64_tr_b16 v[114:115], v132 offset:23168
    s_waitcnt lgkmcnt(8)
    v_dot2_f32_bf16 v16, v40, v20, v16
    v_dot2_f32_bf16 v18, v40, v40, v18
    v_dot2_f32_bf16 v17, v41, v20, v17
    v_dot2_f32_bf16 v19, v41, v41, v19
    v_dot2_f32_bf16 v16, v42, v20, v16
    v_dot2_f32_bf16 v18, v42, v42, v18
    v_dot2_f32_bf16 v17, v43, v20, v17
    v_dot2_f32_bf16 v19, v43, v43, v19
    v_dot2_f32_bf16 v16, v44, v20, v16
    v_dot2_f32_bf16 v18, v44, v44, v18
    v_dot2_f32_bf16 v17, v45, v20, v17
    v_dot2_f32_bf16 v19, v45, v45, v19
    v_dot2_f32_bf16 v16, v46, v20, v16
    v_dot2_f32_bf16 v18, v46, v46, v18
    v_dot2_f32_bf16 v17, v47, v20, v17
    v_dot2_f32_bf16 v19, v47, v47, v19
    v_dot2_f32_bf16 v16, v48, v20, v16
    v_dot2_f32_bf16 v18, v48, v48, v18
    v_dot2_f32_bf16 v17, v49, v20, v17
    v_dot2_f32_bf16 v19, v49, v49, v19
    v_dot2_f32_bf16 v16, v50, v20, v16
    v_dot2_f32_bf16 v18, v50, v50, v18
    v_dot2_f32_bf16 v17, v51, v20, v17
    v_dot2_f32_bf16 v19, v51, v51, v19
    v_dot2_f32_bf16 v16, v52, v20, v16
    v_dot2_f32_bf16 v18, v52, v52, v18
    v_dot2_f32_bf16 v17, v53, v20, v17
    v_dot2_f32_bf16 v19, v53, v53, v19
    v_dot2_f32_bf16 v16, v54, v20, v16
    v_dot2_f32_bf16 v18, v54, v54, v18
    v_dot2_f32_bf16 v17, v55, v20, v17
    v_dot2_f32_bf16 v19, v55, v55, v19
    v_mfma_f32_16x16x32_bf16 v[160:163], v[120:123], v[40:43], v[160:163]
    v_mfma_f32_16x16x32_bf16 v[188:191], v[20:23], v[120:123], v[188:191]
    ds_read_b64_tr_b16 v[116:117], v136 offset:5120
    ds_read_b64_tr_b16 v[118:119], v136 offset:5280
    s_sub_u32 s57, s56, 2
    s_cselect_b32 s59, 5, 0
    s_add_u32 s57, s57, s59
    s_mul_i32 s58, s57, 163840
    s_add_u32 s58, s58, s37
    s_lshl_b32 s57, s57, 8
    s_add_u32 m0, s43, 0
    s_nop 0
    buffer_load_dwordx4 v145, s[16:19], s57 offen lds
    s_waitcnt lgkmcnt(8)
    v_mfma_f32_16x16x32_bf16 v[164:167], v[124:127], v[40:43], v[164:167]
    v_mfma_f32_16x16x32_bf16 v[192:195], v[20:23], v[124:127], v[192:195]
    ds_read_b64_tr_b16 v[120:121], v136 offset:5152
    ds_read_b64_tr_b16 v[122:123], v136 offset:5312
    s_add_u32 m0, s43, 1024
    s_nop 0
    buffer_load_dwordx4 v146, s[16:19], s57 offen lds
    s_waitcnt lgkmcnt(8)
    v_mfma_f32_16x16x32_bf16 v[168:171], v[104:107], v[40:43], v[168:171]
    v_mfma_f32_16x16x32_bf16 v[196:199], v[20:23], v[104:107], v[196:199]
    ds_read_b64_tr_b16 v[124:125], v133 offset:20480
    ds_read_b64_tr_b16 v[126:127], v133 offset:23040
    s_add_u32 m0, s43, 2048
    s_nop 0
    buffer_load_dwordx4 v147, s[16:19], s57 offen lds
    s_waitcnt lgkmcnt(8)
    v_mfma_f32_16x16x32_bf16 v[172:175], v[108:111], v[40:43], v[172:175]
    v_mfma_f32_16x16x32_bf16 v[200:203], v[20:23], v[108:111], v[200:203]
    ds_read_b64_tr_b16 v[104:105], v133 offset:20512
    ds_read_b64_tr_b16 v[106:107], v133 offset:23072
    s_add_u32 m0, s43, 3072
    s_nop 0
    buffer_load_dwordx4 v148, s[16:19], s57 offen lds
    s_waitcnt lgkmcnt(8)
    v_mfma_f32_16x16x32_bf16 v[176:179], v[112:115], v[40:43], v[176:179]
    v_mfma_f32_16x16x32_bf16 v[204:207], v[20:23], v[112:115], v[204:207]
    ds_read_b64_tr_b16 v[108:109], v133 offset:20544
    ds_read_b64_tr_b16 v[110:111], v133 offset:23104
    s_add_u32 m0, s41, 61440
    s_nop 0
    buffer_load_dwordx4 v5, s[20:23], s58 offen lds
    s_waitcnt lgkmcnt(8)
    v_mfma_f32_16x16x32_bf16 v[180:183], v[40:43], v[116:119], v[180:183]
    v_mfma_f32_16x16x32_bf16 v[208:211], v[20:23], v[116:119], v[208:211]
    ds_read_b64_tr_b16 v[112:113], v133 offset:20576
    ds_read_b64_tr_b16 v[114:115], v133 offset:23136
    s_add_u32 m0, s41, 62464
    s_nop 0
    buffer_load_dwordx4 v6, s[20:23], s58 offen lds
    s_waitcnt lgkmcnt(8)
    v_mfma_f32_16x16x32_bf16 v[184:187], v[40:43], v[120:123], v[184:187]
    v_mfma_f32_16x16x32_bf16 v[212:215], v[20:23], v[120:123], v[212:215]
    ds_read_b64_tr_b16 v[116:117], v133 offset:20608
    ds_read_b64_tr_b16 v[118:119], v133 offset:23168
    s_add_u32 m0, s41, 63488
    s_nop 0
    buffer_load_dwordx4 v7, s[20:23], s58 offen lds
    s_waitcnt lgkmcnt(8)
    v_mfma_f32_16x16x32_bf16 v[160:163], v[124:127], v[44:47], v[160:163]
    ds_read_b64_tr_b16 v[120:121], v137 offset:5120
    ds_read_b64_tr_b16 v[122:123], v137 offset:5280
    s_add_u32 m0, s41, 64512
    s_nop 0
    buffer_load_dwordx4 v8, s[20:23], s58 offen lds
    s_waitcnt lgkmcnt(8)
    v_mfma_f32_16x16x32_bf16 v[164:167], v[104:107], v[44:47], v[164:167]
    ds_read_b64_tr_b16 v[124:125], v137 offset:5152
    ds_read_b64_tr_b16 v[126:127], v137 offset:5312
    s_add_u32 m0, s41, 65536
    s_nop 0
    buffer_load_dwordx4 v9, s[20:23], s58 offen lds
    s_waitcnt lgkmcnt(8)
    v_mfma_f32_16x16x32_bf16 v[168:171], v[108:111], v[44:47], v[168:171]
    ds_read_b64_tr_b16 v[104:105], v134 offset:20480
    ds_read_b64_tr_b16 v[106:107], v134 offset:23040
    s_waitcnt lgkmcnt(8)
    v_mfma_f32_16x16x32_bf16 v[172:175], v[112:115], v[44:47], v[172:175]
    ds_read_b64_tr_b16 v[108:109], v134 offset:20512
    ds_read_b64_tr_b16 v[110:111], v134 offset:23072
    s_waitcnt lgkmcnt(8)
    v_mfma_f32_16x16x32_bf16 v[176:179], v[116:119], v[44:47], v[176:179]
    ds_read_b64_tr_b16 v[112:113], v134 offset:20544
    ds_read_b64_tr_b16 v[114:115], v134 offset:23104
    s_waitcnt lgkmcnt(8)
    v_mfma_f32_16x16x32_bf16 v[180:183], v[44:47], v[120:123], v[180:183]
    ds_read_b64_tr_b16 v[116:117], v134 offset:20576
    ds_read_b64_tr_b16 v[118:119], v134 offset:23136
    s_waitcnt lgkmcnt(8)
    v_mfma_f32_16x16x32_bf16 v[184:187], v[44:47], v[124:127], v[184:187]
    ds_read_b64_tr_b16 v[120:121], v134 offset:20608
    ds_read_b64_tr_b16 v[122:123], v134 offset:23168
    s_waitcnt lgkmcnt(8)
    v_mfma_f32_16x16x32_bf16 v[160:163], v[104:107], v[48:51], v[160:163]
    ds_read_b64_tr_b16 v[124:125], v138 offset:5120
    ds_read_b64_tr_b16 v[126:127], v138 offset:5280
    s_waitcnt lgkmcnt(8)
    v_mfma_f32_16x16x32_bf16 v[164:167], v[108:111], v[48:51], v[164:167]
    ds_read_b64_tr_b16 v[104:105], v138 offset:5152
    ds_read_b64_tr_b16 v[106:107], v138 offset:5312
    s_waitcnt lgkmcnt(8)
    v_mfma_f32_16x16x32_bf16 v[168:171], v[112:115], v[48:51], v[168:171]
    ds_read_b64_tr_b16 v[108:109], v135 offset:20480
    ds_read_b64_tr_b16 v[110:111], v135 offset:23040
    s_waitcnt lgkmcnt(8)
    v_mfma_f32_16x16x32_bf16 v[172:175], v[116:119], v[48:51], v[172:175]
    ds_read_b64_tr_b16 v[112:113], v135 offset:20512
    ds_read_b64_tr_b16 v[114:115], v135 offset:23072
    s_waitcnt lgkmcnt(8)
    v_mfma_f32_16x16x32_bf16 v[176:179], v[120:123], v[48:51], v[176:179]
    ds_read_b64_tr_b16 v[116:117], v135 offset:20544
    ds_read_b64_tr_b16 v[118:119], v135 offset:23104
    s_waitcnt lgkmcnt(8)
    v_mfma_f32_16x16x32_bf16 v[180:183], v[48:51], v[124:127], v[180:183]
    ds_read_b64_tr_b16 v[120:121], v135 offset:20576
    ds_read_b64_tr_b16 v[122:123], v135 offset:23136
    s_waitcnt lgkmcnt(8)
    v_mfma_f32_16x16x32_bf16 v[184:187], v[48:51], v[104:107], v[184:187]
    ds_read_b64_tr_b16 v[124:125], v135 offset:20608
    ds_read_b64_tr_b16 v[126:127], v135 offset:23168
    s_waitcnt lgkmcnt(8)
    v_mfma_f32_16x16x32_bf16 v[160:163], v[108:111], v[52:55], v[160:163]
    ds_read_b64_tr_b16 v[104:105], v139 offset:5120
    ds_read_b64_tr_b16 v[106:107], v139 offset:5280
    s_waitcnt lgkmcnt(8)
    v_mfma_f32_16x16x32_bf16 v[164:167], v[112:115], v[52:55], v[164:167]
    ds_read_b64_tr_b16 v[108:109], v139 offset:5152
    ds_read_b64_tr_b16 v[110:111], v139 offset:5312
    s_waitcnt lgkmcnt(8)
    v_mfma_f32_16x16x32_bf16 v[168:171], v[116:119], v[52:55], v[168:171]
    s_waitcnt vmcnt(9)
    ds_read_b128 v[24:27], v149 offset:32768
    ds_read_b128 v[28:31], v150 offset:32768
    ds_read_b128 v[32:35], v151 offset:32768
    ds_read_b128 v[36:39], v152 offset:32768
    s_barrier
    ds_read_b64_tr_b16 v[112:113], v132 offset:40960
    ds_read_b64_tr_b16 v[114:115], v132 offset:43520
    s_waitcnt lgkmcnt(8)
    v_mfma_f32_16x16x32_bf16 v[172:175], v[120:123], v[52:55], v[172:175]
    ds_read_b64_tr_b16 v[116:117], v132 offset:40992
    ds_read_b64_tr_b16 v[118:119], v132 offset:43552
    s_waitcnt lgkmcnt(8)
    v_mfma_f32_16x16x32_bf16 v[176:179], v[124:127], v[52:55], v[176:179]
    ds_read_b64_tr_b16 v[120:121], v132 offset:41024
    ds_read_b64_tr_b16 v[122:123], v132 offset:43584
    s_waitcnt lgkmcnt(8)
    v_mfma_f32_16x16x32_bf16 v[180:183], v[52:55], v[104:107], v[180:183]
    ds_read_b64_tr_b16 v[124:125], v132 offset:41056
    ds_read_b64_tr_b16 v[126:127], v132 offset:43616
    s_waitcnt lgkmcnt(8)
    v_mfma_f32_16x16x32_bf16 v[184:187], v[52:55], v[108:111], v[184:187]
    ds_read_b64_tr_b16 v[104:105], v132 offset:41088
    ds_read_b64_tr_b16 v[106:107], v132 offset:43648
    s_waitcnt lgkmcnt(8)
    v_dot2_f32_bf16 v16, v24, v20, v16
    v_dot2_f32_bf16 v18, v24, v24, v18
    v_dot2_f32_bf16 v17, v25, v20, v17
    v_dot2_f32_bf16 v19, v25, v25, v19
    v_dot2_f32_bf16 v16, v26, v20, v16
    v_dot2_f32_bf16 v18, v26, v26, v18
    v_dot2_f32_bf16 v17, v27, v20, v17
    v_dot2_f32_bf16 v19, v27, v27, v19
    v_dot2_f32_bf16 v16, v28, v20, v16
    v_dot2_f32_bf16 v18, v28, v28, v18
    v_dot2_f32_bf16 v17, v29, v20, v17
    v_dot2_f32_bf16 v19, v29, v29, v19
    v_dot2_f32_bf16 v16, v30, v20, v16
    v_dot2_f32_bf16 v18, v30, v30, v18
    v_dot2_f32_bf16 v17, v31, v20, v17
    v_dot2_f32_bf16 v19, v31, v31, v19
    v_dot2_f32_bf16 v16, v32, v20, v16
    v_dot2_f32_bf16 v18, v32, v32, v18
    v_dot2_f32_bf16 v17, v33, v20, v17
    v_dot2_f32_bf16 v19, v33, v33, v19
    v_dot2_f32_bf16 v16, v34, v20, v16
    v_dot2_f32_bf16 v18, v34, v34, v18
    v_dot2_f32_bf16 v17, v35, v20, v17
    v_dot2_f32_bf16 v19, v35, v35, v19
    v_dot2_f32_bf16 v16, v36, v20, v16
    v_dot2_f32_bf16 v18, v36, v36, v18
    v_dot2_f32_bf16 v17, v37, v20, v17
    v_dot2_f32_bf16 v19, v37, v37, v19
    v_dot2_f32_bf16 v16, v38, v20, v16
    v_dot2_f32_bf16 v18, v38, v38, v18
    v_dot2_f32_bf16 v17, v39, v20, v17
    v_dot2_f32_bf16 v19, v39, v39, v19
    v_mfma_f32_16x16x32_bf16 v[160:163], v[112:115], v[24:27], v[160:163]
    v_mfma_f32_16x16x32_bf16 v[188:191], v[20:23], v[112:115], v[188:191]
    ds_read_b64_tr_b16 v[108:109], v136 offset:10240
    ds_read_b64_tr_b16 v[110:111], v136 offset:10400
    s_sub_u32 s57, s56, 1
    s_cselect_b32 s59, 5, 0
    s_add_u32 s57, s57, s59
    s_mul_i32 s58, s57, 163840
    s_add_u32 s58, s58, s37
    s_lshl_b32 s57, s57, 8
    s_add_u32 m0, s43, 16384
    s_nop 0
    buffer_load_dwordx4 v145, s[16:19], s57 offen lds
    s_waitcnt lgkmcnt(8)
    v_mfma_f32_16x16x32_bf16 v[164:167], v[116:119], v[24:27], v[164:167]
    v_mfma_f32_16x16x32_bf16 v[192:195], v[20:23], v[116:119], v[192:195]
    ds_read_b64_tr_b16 v[112:113], v136 offset:10272
    ds_read_b64_tr_b16 v[114:115], v136 offset:10432
    s_add_u32 m0, s43, 17408
    s_nop 0
    buffer_load_dwordx4 v146, s[16:19], s57 offen lds
    s_waitcnt lgkmcnt(8)
    v_mfma_f32_16x16x32_bf16 v[168:171], v[120:123], v[24:27], v[168:171]
    v_mfma_f32_16x16x32_bf16 v[196:199], v[20:23], v[120:123], v[196:199]
    ds_read_b64_tr_b16 v[116:117], v133 offset:40960
    ds_read_b64_tr_b16 v[118:119], v133 offset:43520
    s_add_u32 m0, s43, 18432
    s_nop 0
    buffer_load_dwordx4 v147, s[16:19], s57 offen lds
    s_waitcnt lgkmcnt(8)
    v_mfma_f32_16x16x32_bf16 v[172:175], v[124:127], v[24:27], v[172:175]
    v_mfma_f32_16x16x32_bf16 v[200:203], v[20:23], v[124:127], v[200:203]
    ds_read_b64_tr_b16 v[120:121], v133 offset:40992
    ds_read_b64_tr_b16 v[122:123], v133 offset:43552
    s_add_u32 m0, s43, 19456
    s_nop 0
    buffer_load_dwordx4 v148, s[16:19], s57 offen lds
    s_waitcnt lgkmcnt(8)
    v_mfma_f32_16x16x32_bf16 v[176:179], v[104:107], v[24:27], v[176:179]
    v_mfma_f32_16x16x32_bf16 v[204:207], v[20:23], v[104:107], v[204:207]
    ds_read_b64_tr_b16 v[124:125], v133 offset:41024
    ds_read_b64_tr_b16 v[126:127], v133 offset:43584
    s_add_u32 m0, s41, 0
    s_nop 0
    buffer_load_dwordx4 v5, s[20:23], s58 offen lds
    s_waitcnt lgkmcnt(8)
    v_mfma_f32_16x16x32_bf16 v[180:183], v[24:27], v[108:111], v[180:183]
    v_mfma_f32_16x16x32_bf16 v[208:211], v[20:23], v[108:111], v[208:211]
    ds_read_b64_tr_b16 v[104:105], v133 offset:41056
    ds_read_b64_tr_b16 v[106:107], v133 offset:43616
    s_add_u32 m0, s41, 1024
    s_nop 0
    buffer_load_dwordx4 v6, s[20:23], s58 offen lds
    s_waitcnt lgkmcnt(8)
    v_mfma_f32_16x16x32_bf16 v[184:187], v[24:27], v[112:115], v[184:187]
    v_mfma_f32_16x16x32_bf16 v[212:215], v[20:23], v[112:115], v[212:215]
    ds_read_b64_tr_b16 v[108:109], v133 offset:41088
    ds_read_b64_tr_b16 v[110:111], v133 offset:43648
    s_add_u32 m0, s41, 2048
    s_nop 0
    buffer_load_dwordx4 v7, s[20:23], s58 offen lds
    s_waitcnt lgkmcnt(8)
    v_mfma_f32_16x16x32_bf16 v[160:163], v[116:119], v[28:31], v[160:163]
    ds_read_b64_tr_b16 v[112:113], v137 offset:10240
    ds_read_b64_tr_b16 v[114:115], v137 offset:10400
    s_add_u32 m0, s41, 3072
    s_nop 0
    buffer_load_dwordx4 v8, s[20:23], s58 offen lds
    s_waitcnt lgkmcnt(8)
    v_mfma_f32_16x16x32_bf16 v[164:167], v[120:123], v[28:31], v[164:167]
    ds_read_b64_tr_b16 v[116:117], v137 offset:10272
    ds_read_b64_tr_b16 v[118:119], v137 offset:10432
    s_add_u32 m0, s41, 4096
    s_nop 0
    buffer_load_dwordx4 v9, s[20:23], s58 offen lds
    s_waitcnt lgkmcnt(8)
    v_mfma_f32_16x16x32_bf16 v[168:171], v[124:127], v[28:31], v[168:171]
    ds_read_b64_tr_b16 v[120:121], v134 offset:40960
    ds_read_b64_tr_b16 v[122:123], v134 offset:43520
    s_waitcnt lgkmcnt(8)
    v_mfma_f32_16x16x32_bf16 v[172:175], v[104:107], v[28:31], v[172:175]
    ds_read_b64_tr_b16 v[124:125], v134 offset:40992
    ds_read_b64_tr_b16 v[126:127], v134 offset:43552
    s_waitcnt lgkmcnt(8)
    v_mfma_f32_16x16x32_bf16 v[176:179], v[108:111], v[28:31], v[176:179]
    ds_read_b64_tr_b16 v[104:105], v134 offset:41024
    ds_read_b64_tr_b16 v[106:107], v134 offset:43584
    s_waitcnt lgkmcnt(8)
    v_mfma_f32_16x16x32_bf16 v[180:183], v[28:31], v[112:115], v[180:183]
    ds_read_b64_tr_b16 v[108:109], v134 offset:41056
    ds_read_b64_tr_b16 v[110:111], v134 offset:43616
    s_waitcnt lgkmcnt(8)
    v_mfma_f32_16x16x32_bf16 v[184:187], v[28:31], v[116:119], v[184:187]
    ds_read_b64_tr_b16 v[112:113], v134 offset:41088
    ds_read_b64_tr_b16 v[114:115], v134 offset:43648
    s_waitcnt lgkmcnt(8)
    v_mfma_f32_16x16x32_bf16 v[160:163], v[120:123], v[32:35], v[160:163]
    ds_read_b64_tr_b16 v[116:117], v138 offset:10240
    ds_read_b64_tr_b16 v[118:119], v138 offset:10400
    s_waitcnt lgkmcnt(8)
    v_mfma_f32_16x16x32_bf16 v[164:167], v[124:127], v[32:35], v[164:167]
    ds_read_b64_tr_b16 v[120:121], v138 offset:10272
    ds_read_b64_tr_b16 v[122:123], v138 offset:10432
    s_waitcnt lgkmcnt(8)
    v_mfma_f32_16x16x32_bf16 v[168:171], v[104:107], v[32:35], v[168:171]
    ds_read_b64_tr_b16 v[124:125], v135 offset:40960
    ds_read_b64_tr_b16 v[126:127], v135 offset:43520
    s_waitcnt lgkmcnt(8)
    v_mfma_f32_16x16x32_bf16 v[172:175], v[108:111], v[32:35], v[172:175]
    ds_read_b64_tr_b16 v[104:105], v135 offset:40992
    ds_read_b64_tr_b16 v[106:107], v135 offset:43552
    s_waitcnt lgkmcnt(8)
    v_mfma_f32_16x16x32_bf16 v[176:179], v[112:115], v[32:35], v[176:179]
    ds_read_b64_tr_b16 v[108:109], v135 offset:41024
    ds_read_b64_tr_b16 v[110:111], v135 offset:43584
    s_waitcnt lgkmcnt(8)
    v_mfma_f32_16x16x32_bf16 v[180:183], v[32:35], v[116:119], v[180:183]
    ds_read_b64_tr_b16 v[112:113], v135 offset:41056
    ds_read_b64_tr_b16 v[114:115], v135 offset:43616
    s_waitcnt lgkmcnt(8)
    v_mfma_f32_16x16x32_bf16 v[184:187], v[32:35], v[120:123], v[184:187]
    ds_read_b64_tr_b16 v[116:117], v135 offset:41088
    ds_read_b64_tr_b16 v[118:119], v135 offset:43648
    s_waitcnt lgkmcnt(8)
    v_mfma_f32_16x16x32_bf16 v[160:163], v[124:127], v[36:39], v[160:163]
    ds_read_b64_tr_b16 v[120:121], v139 offset:10240
    ds_read_b64_tr_b16 v[122:123], v139 offset:10400
    s_waitcnt lgkmcnt(8)
    v_mfma_f32_16x16x32_bf16 v[164:167], v[104:107], v[36:39], v[164:167]
    ds_read_b64_tr_b16 v[124:125], v139 offset:10272
    ds_read_b64_tr_b16 v[126:127], v139 offset:10432
    s_waitcnt lgkmcnt(8)
    v_mfma_f32_16x16x32_bf16 v[168:171], v[108:111], v[36:39], v[168:171]
    s_waitcnt vmcnt(9)
    ds_read_b128 v[40:43], v149 offset:0
    ds_read_b128 v[44:47], v150 offset:0
    ds_read_b128 v[48:51], v151 offset:0
    ds_read_b128 v[52:55], v152 offset:0
    s_barrier
    ds_read_b64_tr_b16 v[104:105], v132 offset:61440
    ds_read_b64_tr_b16 v[106:107], v132 offset:64000
    s_waitcnt lgkmcnt(8)
    v_mfma_f32_16x16x32_bf16 v[172:175], v[112:115], v[36:39], v[172:175]
    ds_read_b64_tr_b16 v[108:109], v132 offset:61472
    ds_read_b64_tr_b16 v[110:111], v132 offset:64032
    s_waitcnt lgkmcnt(8)
    v_mfma_f32_16x16x32_bf16 v[176:179], v[116:119], v[36:39], v[176:179]
    ds_read_b64_tr_b16 v[112:113], v132 offset:61504
    ds_read_b64_tr_b16 v[114:115], v132 offset:64064
    s_waitcnt lgkmcnt(8)
    v_mfma_f32_16x16x32_bf16 v[180:183], v[36:39], v[120:123], v[180:183]
    ds_read_b64_tr_b16 v[116:117], v132 offset:61536
    ds_read_b64_tr_b16 v[118:119], v132 offset:64096
    s_waitcnt lgkmcnt(8)
    v_mfma_f32_16x16x32_bf16 v[184:187], v[36:39], v[124:127], v[184:187]
    ds_read_b64_tr_b16 v[120:121], v132 offset:61568
    ds_read_b64_tr_b16 v[122:123], v132 offset:64128
    s_waitcnt lgkmcnt(8)
    v_dot2_f32_bf16 v16, v40, v20, v16
    v_dot2_f32_bf16 v18, v40, v40, v18
    v_dot2_f32_bf16 v17, v41, v20, v17
    v_dot2_f32_bf16 v19, v41, v41, v19
    v_dot2_f32_bf16 v16, v42, v20, v16
    v_dot2_f32_bf16 v18, v42, v42, v18
    v_dot2_f32_bf16 v17, v43, v20, v17
    v_dot2_f32_bf16 v19, v43, v43, v19
    v_dot2_f32_bf16 v16, v44, v20, v16
    v_dot2_f32_bf16 v18, v44, v44, v18
    v_dot2_f32_bf16 v17, v45, v20, v17
    v_dot2_f32_bf16 v19, v45, v45, v19
    v_dot2_f32_bf16 v16, v46, v20, v16
    v_dot2_f32_bf16 v18, v46, v46, v18
    v_dot2_f32_bf16 v17, v47, v20, v17
    v_dot2_f32_bf16 v19, v47, v47, v19
    v_dot2_f32_bf16 v16, v48, v20, v16
    v_dot2_f32_bf16 v18, v48, v48, v18
    v_dot2_f32_bf16 v17, v49, v20, v17
    v_dot2_f32_bf16 v19, v49, v49, v19
    v_dot2_f32_bf16 v16, v50, v20, v16
    v_dot2_f32_bf16 v18, v50, v50, v18
    v_dot2_f32_bf16 v17, v51, v20, v17
    v_dot2_f32_bf16 v19, v51, v51, v19
    v_dot2_f32_bf16 v16, v52, v20, v16
    v_dot2_f32_bf16 v18, v52, v52, v18
    v_dot2_f32_bf16 v17, v53, v20, v17
    v_dot2_f32_bf16 v19, v53, v53, v19
    v_dot2_f32_bf16 v16, v54, v20, v16
    v_dot2_f32_bf16 v18, v54, v54, v18
    v_dot2_f32_bf16 v17, v55, v20, v17
    v_dot2_f32_bf16 v19, v55, v55, v19
    v_mfma_f32_16x16x32_bf16 v[160:163], v[104:107], v[40:43], v[160:163]
    v_mfma_f32_16x16x32_bf16 v[188:191], v[20:23], v[104:107], v[188:191]
    ds_read_b64_tr_b16 v[124:125], v136 offset:15360
    ds_read_b64_tr_b16 v[126:127], v136 offset:15520
    s_waitcnt lgkmcnt(8)
    v_mfma_f32_16x16x32_bf16 v[164:167], v[108:111], v[40:43], v[164:167]
    v_mfma_f32_16x16x32_bf16 v[192:195], v[20:23], v[108:111], v[192:195]
    ds_read_b64_tr_b16 v[104:105], v136 offset:15392
    ds_read_b64_tr_b16 v[106:107], v136 offset:15552
    s_waitcnt lgkmcnt(8)
    v_mfma_f32_16x16x32_bf16 v[168:171], v[112:115], v[40:43], v[168:171]
    v_mfma_f32_16x16x32_bf16 v[196:199], v[20:23], v[112:115], v[196:199]
    ds_read_b64_tr_b16 v[108:109], v133 offset:61440
    ds_read_b64_tr_b16 v[110:111], v133 offset:64000
    s_waitcnt lgkmcnt(8)
    v_mfma_f32_16x16x32_bf16 v[172:175], v[116:119], v[40:43], v[172:175]
    v_mfma_f32_16x16x32_bf16 v[200:203], v[20:23], v[116:119], v[200:203]
    ds_read_b64_tr_b16 v[112:113], v133 offset:61472
    ds_read_b64_tr_b16 v[114:115], v133 offset:64032
    s_waitcnt lgkmcnt(8)
    v_mfma_f32_16x16x32_bf16 v[176:179], v[120:123], v[40:43], v[176:179]
    v_mfma_f32_16x16x32_bf16 v[204:207], v[20:23], v[120:123], v[204:207]
    ds_read_b64_tr_b16 v[116:117], v133 offset:61504
    ds_read_b64_tr_b16 v[118:119], v133 offset:64064
    s_waitcnt lgkmcnt(8)
    v_mfma_f32_16x16x32_bf16 v[180:183], v[40:43], v[124:127], v[180:183]
    v_mfma_f32_16x16x32_bf16 v[208:211], v[20:23], v[124:127], v[208:211]
    ds_read_b64_tr_b16 v[120:121], v133 offset:61536
    ds_read_b64_tr_b16 v[122:123], v133 offset:64096
    s_waitcnt lgkmcnt(8)
    v_mfma_f32_16x16x32_bf16 v[184:187], v[40:43], v[104:107], v[184:187]
    v_mfma_f32_16x16x32_bf16 v[212:215], v[20:23], v[104:107], v[212:215]
    ds_read_b64_tr_b16 v[124:125], v133 offset:61568
    ds_read_b64_tr_b16 v[126:127], v133 offset:64128
    s_waitcnt lgkmcnt(8)
    v_mfma_f32_16x16x32_bf16 v[160:163], v[108:111], v[44:47], v[160:163]
    ds_read_b64_tr_b16 v[104:105], v137 offset:15360
    ds_read_b64_tr_b16 v[106:107], v137 offset:15520
    s_waitcnt lgkmcnt(8)
    v_mfma_f32_16x16x32_bf16 v[164:167], v[112:115], v[44:47], v[164:167]
    ds_read_b64_tr_b16 v[108:109], v137 offset:15392
    ds_read_b64_tr_b16 v[110:111], v137 offset:15552
    s_waitcnt lgkmcnt(8)
    v_mfma_f32_16x16x32_bf16 v[168:171], v[116:119], v[44:47], v[168:171]
    ds_read_b64_tr_b16 v[112:113], v134 offset:61440
    ds_read_b64_tr_b16 v[114:115], v134 offset:64000
    s_waitcnt lgkmcnt(8)
    v_mfma_f32_16x16x32_bf16 v[172:175], v[120:123], v[44:47], v[172:175]
    ds_read_b64_tr_b16 v[116:117], v134 offset:61472
    ds_read_b64_tr_b16 v[118:119], v134 offset:64032
    s_waitcnt lgkmcnt(8)
    v_mfma_f32_16x16x32_bf16 v[176:179], v[124:127], v[44:47], v[176:179]
    ds_read_b64_tr_b16 v[120:121], v134 offset:61504
    ds_read_b64_tr_b16 v[122:123], v134 offset:64064
    s_waitcnt lgkmcnt(8)
    v_mfma_f32_16x16x32_bf16 v[180:183], v[44:47], v[104:107], v[180:183]
    ds_read_b64_tr_b16 v[124:125], v134 offset:61536
    ds_read_b64_tr_b16 v[126:127], v134 offset:64096
    s_waitcnt lgkmcnt(8)
    v_mfma_f32_16x16x32_bf16 v[184:187], v[44:47], v[108:111], v[184:187]
    ds_read_b64_tr_b16 v[104:105], v134 offset:61568
    ds_read_b64_tr_b16 v[106:107], v134 offset:64128
    s_waitcnt lgkmcnt(8)
    v_mfma_f32_16x16x32_bf16 v[160:163], v[112:115], v[48:51], v[160:163]
    ds_read_b64_tr_b16 v[108:109], v138 offset:15360
    ds_read_b64_tr_b16 v[110:111], v138 offset:15520
    s_waitcnt lgkmcnt(8)
    v_mfma_f32_16x16x32_bf16 v[164:167], v[116:119], v[48:51], v[164:167]
    ds_read_b64_tr_b16 v[112:113], v138 offset:15392
    ds_read_b64_tr_b16 v[114:115], v138 offset:15552
    s_waitcnt lgkmcnt(8)
    v_mfma_f32_16x16x32_bf16 v[168:171], v[120:123], v[48:51], v[168:171]
    ds_read_b64_tr_b16 v[116:117], v135 offset:61440
    ds_read_b64_tr_b16 v[118:119], v135 offset:64000
    s_waitcnt lgkmcnt(8)
    v_mfma_f32_16x16x32_bf16 v[172:175], v[124:127], v[48:51], v[172:175]
    ds_read_b64_tr_b16 v[120:121], v135 offset:61472
    ds_read_b64_tr_b16 v[122:123], v135 offset:64032
    s_waitcnt lgkmcnt(8)
    v_mfma_f32_16x16x32_bf16 v[176:179], v[104:107], v[48:51], v[176:179]
    ds_read_b64_tr_b16 v[124:125], v135 offset:61504
    ds_read_b64_tr_b16 v[126:127], v135 offset:64064
    s_waitcnt lgkmcnt(8)
    v_mfma_f32_16x16x32_bf16 v[180:183], v[48:51], v[108:111], v[180:183]
    ds_read_b64_tr_b16 v[104:105], v135 offset:61536
    ds_read_b64_tr_b16 v[106:107], v135 offset:64096
    s_waitcnt lgkmcnt(8)
    v_mfma_f32_16x16x32_bf16 v[184:187], v[48:51], v[112:115], v[184:187]
    ds_read_b64_tr_b16 v[108:109], v135 offset:61568
    ds_read_b64_tr_b16 v[110:111], v135 offset:64128
    s_waitcnt lgkmcnt(8)
    v_mfma_f32_16x16x32_bf16 v[160:163], v[116:119], v[52:55], v[160:163]
    ds_read_b64_tr_b16 v[112:113], v139 offset:15360
    ds_read_b64_tr_b16 v[114:115], v139 offset:15520
    s_waitcnt lgkmcnt(8)
    v_mfma_f32_16x16x32_bf16 v[164:167], v[120:123], v[52:55], v[164:167]
    ds_read_b64_tr_b16 v[116:117], v139 offset:15392
    ds_read_b64_tr_b16 v[118:119], v139 offset:15552
    s_waitcnt lgkmcnt(8)
    v_mfma_f32_16x16x32_bf16 v[168:171], v[124:127], v[52:55], v[168:171]
    s_waitcnt vmcnt(0)
    ds_read_b128 v[24:27], v149 offset:16384
    ds_read_b128 v[28:31], v150 offset:16384
    ds_read_b128 v[32:35], v151 offset:16384
    ds_read_b128 v[36:39], v152 offset:16384
    s_barrier
    ds_read_b64_tr_b16 v[120:121], v132 offset:0
    ds_read_b64_tr_b16 v[122:123], v132 offset:2560
    s_waitcnt lgkmcnt(8)
    v_mfma_f32_16x16x32_bf16 v[172:175], v[104:107], v[52:55], v[172:175]
    ds_read_b64_tr_b16 v[124:125], v132 offset:32
    ds_read_b64_tr_b16 v[126:127], v132 offset:2592
    s_waitcnt lgkmcnt(8)
    v_mfma_f32_16x16x32_bf16 v[176:179], v[108:111], v[52:55], v[176:179]
    ds_read_b64_tr_b16 v[104:105], v132 offset:64
    ds_read_b64_tr_b16 v[106:107], v132 offset:2624
    s_waitcnt lgkmcnt(8)
    v_mfma_f32_16x16x32_bf16 v[180:183], v[52:55], v[112:115], v[180:183]
    ds_read_b64_tr_b16 v[108:109], v132 offset:96
    ds_read_b64_tr_b16 v[110:111], v132 offset:2656
    s_waitcnt lgkmcnt(8)
    v_mfma_f32_16x16x32_bf16 v[184:187], v[52:55], v[116:119], v[184:187]
    ds_read_b64_tr_b16 v[112:113], v132 offset:128
    ds_read_b64_tr_b16 v[114:115], v132 offset:2688
    s_waitcnt lgkmcnt(8)
    v_dot2_f32_bf16 v16, v24, v20, v16
    v_dot2_f32_bf16 v18, v24, v24, v18
    v_dot2_f32_bf16 v17, v25, v20, v17
    v_dot2_f32_bf16 v19, v25, v25, v19
    v_dot2_f32_bf16 v16, v26, v20, v16
    v_dot2_f32_bf16 v18, v26, v26, v18
    v_dot2_f32_bf16 v17, v27, v20, v17
    v_dot2_f32_bf16 v19, v27, v27, v19
    v_dot2_f32_bf16 v16, v28, v20, v16
    v_dot2_f32_bf16 v18, v28, v28, v18
    v_dot2_f32_bf16 v17, v29, v20, v17
    v_dot2_f32_bf16 v19, v29, v29, v19
    v_dot2_f32_bf16 v16, v30, v20, v16
    v_dot2_f32_bf16 v18, v30, v30, v18
    v_dot2_f32_bf16 v17, v31, v20, v17
    v_dot2_f32_bf16 v19, v31, v31, v19
    v_dot2_f32_bf16 v16, v32, v20, v16
    v_dot2_f32_bf16 v18, v32, v32, v18
    v_dot2_f32_bf16 v17, v33, v20, v17
    v_dot2_f32_bf16 v19, v33, v33, v19
    v_dot2_f32_bf16 v16, v34, v20, v16
    v_dot2_f32_bf16 v18, v34, v34, v18
    v_dot2_f32_bf16 v17, v35, v20, v17
    v_dot2_f32_bf16 v19, v35, v35, v19
    v_dot2_f32_bf16 v16, v36, v20, v16
    v_dot2_f32_bf16 v18, v36, v36, v18
    v_dot2_f32_bf16 v17, v37, v20, v17
    v_dot2_f32_bf16 v19, v37, v37, v19
    v_dot2_f32_bf16 v16, v38, v20, v16
    v_dot2_f32_bf16 v18, v38, v38, v18
    v_dot2_f32_bf16 v17, v39, v20, v17
    v_dot2_f32_bf16 v19, v39, v39, v19
    v_mfma_f32_16x16x32_bf16 v[160:163], v[120:123], v[24:27], v[160:163]
    v_mfma_f32_16x16x32_bf16 v[188:191], v[20:23], v[120:123], v[188:191]
    ds_read_b64_tr_b16 v[116:117], v136 offset:20480
    ds_read_b64_tr_b16 v[118:119], v136 offset:20640
    s_waitcnt lgkmcnt(8)
    v_mfma_f32_16x16x32_bf16 v[164:167], v[124:127], v[24:27], v[164:167]
    v_mfma_f32_16x16x32_bf16 v[192:195], v[20:23], v[124:127], v[192:195]
    ds_read_b64_tr_b16 v[120:121], v136 offset:20512
    ds_read_b64_tr_b16 v[122:123], v136 offset:20672
    s_waitcnt lgkmcnt(8)
    v_mfma_f32_16x16x32_bf16 v[168:171], v[104:107], v[24:27], v[168:171]
    v_mfma_f32_16x16x32_bf16 v[196:199], v[20:23], v[104:107], v[196:199]
    ds_read_b64_tr_b16 v[124:125], v133 offset:0
    ds_read_b64_tr_b16 v[126:127], v133 offset:2560
    s_waitcnt lgkmcnt(8)
    v_mfma_f32_16x16x32_bf16 v[172:175], v[108:111], v[24:27], v[172:175]
    v_mfma_f32_16x16x32_bf16 v[200:203], v[20:23], v[108:111], v[200:203]
    ds_read_b64_tr_b16 v[104:105], v133 offset:32
    ds_read_b64_tr_b16 v[106:107], v133 offset:2592
    s_waitcnt lgkmcnt(8)
    v_mfma_f32_16x16x32_bf16 v[176:179], v[112:115], v[24:27], v[176:179]
    v_mfma_f32_16x16x32_bf16 v[204:207], v[20:23], v[112:115], v[204:207]
    ds_read_b64_tr_b16 v[108:109], v133 offset:64
    ds_read_b64_tr_b16 v[110:111], v133 offset:2624
    s_waitcnt lgkmcnt(8)
    v_mfma_f32_16x16x32_bf16 v[180:183], v[24:27], v[116:119], v[180:183]
    v_mfma_f32_16x16x32_bf16 v[208:211], v[20:23], v[116:119], v[208:211]
    ds_read_b64_tr_b16 v[112:113], v133 offset:96
    ds_read_b64_tr_b16 v[114:115], v133 offset:2656
    s_waitcnt lgkmcnt(8)
    v_mfma_f32_16x16x32_bf16 v[184:187], v[24:27], v[120:123], v[184:187]
    v_mfma_f32_16x16x32_bf16 v[212:215], v[20:23], v[120:123], v[212:215]
    ds_read_b64_tr_b16 v[116:117], v133 offset:128
    ds_read_b64_tr_b16 v[118:119], v133 offset:2688
    s_waitcnt lgkmcnt(8)
    v_mfma_f32_16x16x32_bf16 v[160:163], v[124:127], v[28:31], v[160:163]
    ds_read_b64_tr_b16 v[120:121], v137 offset:20480
    ds_read_b64_tr_b16 v[122:123], v137 offset:20640
    s_waitcnt lgkmcnt(8)
    v_mfma_f32_16x16x32_bf16 v[164:167], v[104:107], v[28:31], v[164:167]
    ds_read_b64_tr_b16 v[124:125], v137 offset:20512
    ds_read_b64_tr_b16 v[126:127], v137 offset:20672
    s_waitcnt lgkmcnt(8)
    v_mfma_f32_16x16x32_bf16 v[168:171], v[108:111], v[28:31], v[168:171]
    ds_read_b64_tr_b16 v[104:105], v134 offset:0
    ds_read_b64_tr_b16 v[106:107], v134 offset:2560
    s_waitcnt lgkmcnt(8)
    v_mfma_f32_16x16x32_bf16 v[172:175], v[112:115], v[28:31], v[172:175]
    ds_read_b64_tr_b16 v[108:109], v134 offset:32
    ds_read_b64_tr_b16 v[110:111], v134 offset:2592
    s_waitcnt lgkmcnt(8)
    v_mfma_f32_16x16x32_bf16 v[176:179], v[116:119], v[28:31], v[176:179]
    ds_read_b64_tr_b16 v[112:113], v134 offset:64
    ds_read_b64_tr_b16 v[114:115], v134 offset:2624
    s_waitcnt lgkmcnt(8)
    v_mfma_f32_16x16x32_bf16 v[180:183], v[28:31], v[120:123], v[180:183]
    ds_read_b64_tr_b16 v[116:117], v134 offset:96
    ds_read_b64_tr_b16 v[118:119], v134 offset:2656
    s_waitcnt lgkmcnt(8)
    v_mfma_f32_16x16x32_bf16 v[184:187], v[28:31], v[124:127], v[184:187]
    ds_read_b64_tr_b16 v[120:121], v134 offset:128
    ds_read_b64_tr_b16 v[122:123], v134 offset:2688
    s_waitcnt lgkmcnt(8)
    v_mfma_f32_16x16x32_bf16 v[160:163], v[104:107], v[32:35], v[160:163]
    ds_read_b64_tr_b16 v[124:125], v138 offset:20480
    ds_read_b64_tr_b16 v[126:127], v138 offset:20640
    s_waitcnt lgkmcnt(8)
    v_mfma_f32_16x16x32_bf16 v[164:167], v[108:111], v[32:35], v[164:167]
    ds_read_b64_tr_b16 v[104:105], v138 offset:20512
    ds_read_b64_tr_b16 v[106:107], v138 offset:20672
    s_waitcnt lgkmcnt(8)
    v_mfma_f32_16x16x32_bf16 v[168:171], v[112:115], v[32:35], v[168:171]
    ds_read_b64_tr_b16 v[108:109], v135 offset:0
    ds_read_b64_tr_b16 v[110:111], v135 offset:2560
    s_waitcnt lgkmcnt(8)
    v_mfma_f32_16x16x32_bf16 v[172:175], v[116:119], v[32:35], v[172:175]
    ds_read_b64_tr_b16 v[112:113], v135 offset:32
    ds_read_b64_tr_b16 v[114:115], v135 offset:2592
    s_waitcnt lgkmcnt(8)
    v_mfma_f32_16x16x32_bf16 v[176:179], v[120:123], v[32:35], v[176:179]
    ds_read_b64_tr_b16 v[116:117], v135 offset:64
    ds_read_b64_tr_b16 v[118:119], v135 offset:2624
    s_waitcnt lgkmcnt(8)
    v_mfma_f32_16x16x32_bf16 v[180:183], v[32:35], v[124:127], v[180:183]
    ds_read_b64_tr_b16 v[120:121], v135 offset:96
    ds_read_b64_tr_b16 v[122:123], v135 offset:2656
    s_waitcnt lgkmcnt(8)
    v_mfma_f32_16x16x32_bf16 v[184:187], v[32:35], v[104:107], v[184:187]
    ds_read_b64_tr_b16 v[124:125], v135 offset:128
    ds_read_b64_tr_b16 v[126:127], v135 offset:2688
    s_waitcnt lgkmcnt(8)
    v_mfma_f32_16x16x32_bf16 v[160:163], v[108:111], v[36:39], v[160:163]
    ds_read_b64_tr_b16 v[104:105], v139 offset:20480
    ds_read_b64_tr_b16 v[106:107], v139 offset:20640
    s_waitcnt lgkmcnt(8)
    v_mfma_f32_16x16x32_bf16 v[164:167], v[112:115], v[36:39], v[164:167]
    ds_read_b64_tr_b16 v[108:109], v139 offset:20512
    ds_read_b64_tr_b16 v[110:111], v139 offset:20672
    s_waitcnt lgkmcnt(8)
    v_mfma_f32_16x16x32_bf16 v[168:171], v[116:119], v[36:39], v[168:171]
    s_waitcnt lgkmcnt(6)
    v_mfma_f32_16x16x32_bf16 v[172:175], v[120:123], v[36:39], v[172:175]
    s_waitcnt lgkmcnt(4)
    v_mfma_f32_16x16x32_bf16 v[176:179], v[124:127], v[36:39], v[176:179]
    s_waitcnt lgkmcnt(2)
    v_mfma_f32_16x16x32_bf16 v[180:183], v[36:39], v[104:107], v[180:183]
    s_waitcnt lgkmcnt(0)
    v_mfma_f32_16x16x32_bf16 v[184:187], v[36:39], v[108:111], v[184:187]
    s_branch k1_epi
.globl k2_kernel
.p2align 8
.type k2_kernel,@function
k2_kernel:
    s_cmp_ge_u32 s2, 256
    s_cbranch_scc1 k2_end
    s_load_dwordx2 s[12:13], s[0:1], 96
    s_load_dwordx4 s[4:7], s[0:1], 48
    s_load_dwordx2 s[8:9], s[0:1], 64
    v_lshrrev_b32 v1, 6, v0
    s_nop 0
    v_readfirstlane_b32 s34, v1
    v_and_b32 v1, 63, v0
    v_and_b32 v2, 31, v1
    v_lshrrev_b32 v3, 5, v1
    v_lshlrev_b32 v11, 4, v1
    s_cmp_ge_u32 s34, 8
    s_cbranch_scc1 k2_helper
    s_and_b32 s35, s2, 7
    s_lshr_b32 s36, s2, 3
    s_lshl_b32 s32, s35, 2
    s_and_b32 s35, s36, 3
    s_add_u32 s32, s32, s35
    s_lshr_b32 s33, s36, 2
    s_lshr_b32 s38, s34, 2
    s_and_b32 s35, s34, 3
    s_lshl_b32 s40, s33, 2
    s_add_u32 s40, s40, s35
    v_lshlrev_b32 v4, 3, v2
    v_lshlrev_b32 v6, 3, v1
    s_mul_i32 s41, s38, 81920
    s_and_b32 s36, s34, 3
    s_lshl_b32 s36, s36, 10
    s_add_u32 s41, s41, s36
    s_lshl_b32 s35, s40, 6
    s_lshl_b32 s36, s32, 1
    s_add_u32 s35, s35, s36
    s_mul_i32 s35, s35, 1280
    s_add_u32 s35, s35, 0
    s_mov_b32 s54, 3407872
    s_waitcnt lgkmcnt(0)
    s_mov_b32 s16, s12
    s_mov_b32 s17, s13
    s_mov_b32 s18, 0x1a00000
    s_mov_b32 s19, 0x00020000
    s_add_u32 s20, s12, 0x300000
    s_addc_u32 s21, s13, 0
    s_mov_b32 s22, 0x28000
    s_mov_b32 s23, 0x00020000
    buffer_load_dwordx4 v[16:19], v11, s[16:19], s35 offen
    buffer_load_dwordx2 v[20:21], v4, s[16:19], s35 offen offset:1024
    buffer_load_dwordx4 v[24:27], v11, s[16:19], s35 offen offset:1280
    buffer_load_dwordx2 v[28:29], v4, s[16:19], s35 offen offset:2304
    buffer_load_dwordx2 v[144:145], v6, s[16:19], s54 offen
    s_add_u32 m0, s41, 0
    s_add_u32 s55, s41, 0
    buffer_load_dwordx4 v11, s[20:23], s55 offen lds
    s_add_u32 m0, s41, 4096
    s_add_u32 s55, s41, 4096
    buffer_load_dwordx4 v11, s[20:23], s55 offen lds
    s_mov_b32 s42, 0x000fffff
    s_mov_b32 s43, 0x000fffff
    s_mov_b32 s50, -1
    s_mov_b32 s51, 0
    s_lshl_b32 s37, s34, 2
    s_mul_i32 s35, s38, 81920
    v_add_u32 v8, s35, v11
    v_add_u32 v9, s35, v4
    v_mul_u32_u24 v10, 20, v3
    v_add_u32 v10, v10, v2
    v_lshlrev_b32 v10, 4, v10
    v_add_u32 v10, s35, v10
    v_mov_b32 v116, 0x3f803f80
    v_mov_b32 v117, 0x00003f80
    v_mov_b32 v124, 0x3f803f80
    v_mov_b32 v125, 0x00003f80
    v_and_b32 v6, 27, v2
    v_cmp_eq_u32 vcc, 24, v6
    v_mov_b32 v7, 0x3f803f80
    s_nop 0
    v_cndmask_b32 v7, 0, v7, vcc
    v_mov_b32 v128, v7
    v_mov_b32 v129, v7
    v_mov_b32 v130, v7
    v_mov_b32 v131, v7
    v_mov_b32 v132, v7
    v_mov_b32 v133, v7
    v_mov_b32 v134, v7
    v_mov_b32 v135, v7
    v_mov_b32 v136, v7
    v_mov_b32 v137, v7
    v_mov_b32 v138, v7
    v_mov_b32 v139, v7
    v_mov_b32 v140, v7
    v_mov_b32 v141, v7
    v_mov_b32 v142, v7
    v_mov_b32 v143, v7
    v_mov_b32 v80, 0
    v_mov_b32 v81, 0
    v_mov_b32 v82, 0
    v_mov_b32 v83, 0
    v_mov_b32 v84, 0
    v_mov_b32 v85, 0
    v_mov_b32 v86, 0
    v_mov_b32 v87, 0
    v_mov_b32 v88, 0
    v_mov_b32 v89, 0
    v_mov_b32 v90, 0
    v_mov_b32 v91, 0
    v_mov_b32 v92, 0
    v_mov_b32 v93, 0
    v_mov_b32 v94, 0
    v_mov_b32 v95, 0
    v_mov_b32 v96, 0
    v_mov_b32 v97, 0
    v_mov_b32 v98, 0
    v_mov_b32 v99, 0
    v_mov_b32 v100, 0
    v_mov_b32 v101, 0
    v_mov_b32 v102, 0
    v_mov_b32 v103, 0
    v_mov_b32 v104, 0
    v_mov_b32 v105, 0
    v_mov_b32 v106, 0
    v_mov_b32 v107, 0
    v_mov_b32 v108, 0
    v_mov_b32 v109, 0
    v_mov_b32 v110, 0
    v_mov_b32 v111, 0
    v_mov_b32 v72, 0
    v_mov_b32 v73, 0
    v_mov_b32 v74, 0
    v_mov_b32 v75, 0
    v_mov_b32 v76, 0
    v_mov_b32 v77, 0
    v_mov_b32 v78, 0
    v_mov_b32 v79, 0
    v_mov_b32 v148, 0
    v_mov_b32 v149, 0
    v_cmp_eq_u32 vcc, 0, v3
    s_waitcnt vmcnt(2)
    v_cndmask_b32 v20, 0, v20, vcc
    v_cndmask_b32 v21, 0, v21, vcc
    v_cndmask_b32 v28, 0, v28, vcc
    v_cndmask_b32 v29, 0, v29, vcc
    v_max_f32 v12, v144, v145
    v_dot2_f32_bf16 v148, v16, v16, v148
    v_dot2_f32_bf16 v149, v24, v24, v149
    v_max_f32_dpp v12, v12, v12 row_ror:8 row_mask:0xf bank_mask:0xf
    v_dot2_f32_bf16 v148, v17, v17, v148
    v_dot2_f32_bf16 v149, v25, v25, v149
    v_max_f32_dpp v12, v12, v12 row_ror:4 row_mask:0xf bank_mask:0xf
    v_dot2_f32_bf16 v148, v18, v18, v148
    v_dot2_f32_bf16 v149, v26, v26, v149
    v_max_f32_dpp v12, v12, v12 row_ror:2 row_mask:0xf bank_mask:0xf
    v_dot2_f32_bf16 v148, v19, v19, v148
    v_dot2_f32_bf16 v149, v27, v27, v149
    v_max_f32_dpp v12, v12, v12 row_ror:1 row_mask:0xf bank_mask:0xf
    v_dot2_f32_bf16 v148, v20, v20, v148
    v_dot2_f32_bf16 v149, v28, v28, v149
    v_mov_b32 v4, v12
    v_dot2_f32_bf16 v148, v21, v21, v148
    v_dot2_f32_bf16 v149, v29, v29, v149
    v_permlane16_swap_b32 v12, v4
    s_nop 0
    v_max_f32 v12, v12, v4
    v_mov_b32 v5, v148
    v_mov_b32 v6, v149
    v_mov_b32 v4, v12
    v_permlane32_swap_b32 v148, v5
    v_permlane32_swap_b32 v149, v6
    v_permlane32_swap_b32 v12, v4
    v_add_f32 v148, v148, v5
    v_add_f32 v149, v149, v6
    v_max_f32 v12, v12, v4
    v_mul_f32 v148, v148, v12
    v_mul_f32 v149, v149, v12
    v_sqrt_f32 v148, v148
    v_sqrt_f32 v149, v149
    v_mul_f32 v148, 0x3f820000, v148
    v_mul_f32 v149, 0x3f820000, v149
    v_lshrrev_b32 v148, 16, v148
    v_lshrrev_b32 v149, 16, v149
    v_add_u32 v148, 0x8001, v148
    v_add_u32 v149, 0x8001, v149
    v_cndmask_b32 v20, v148, v20, vcc
    v_cndmask_b32 v28, v149, v28, vcc
    s_waitcnt vmcnt(0)
    s_barrier
    ds_read_b128 v[112:115], v8 offset:0
    s_mov_b64 exec, s[50:51]
    ds_read_b64 v[116:117], v9 offset:2304
    s_mov_b64 exec, -1
    s_mov_b64 exec, s[42:43]
    ds_read_b128 v[128:131], v10 offset:1024
    ds_read_b128 v[132:135], v10 offset:1664
    s_mov_b64 exec, -1
    ds_read_b128 v[120:123], v8 offset:2560
    s_mov_b64 exec, s[50:51]
    ds_read_b64 v[124:125], v9 offset:4864
    s_mov_b64 exec, -1
    s_waitcnt lgkmcnt(4)
    v_mfma_f32_32x32x16_bf16 v[32:47], v[112:115], v[16:19], 0
    v_mfma_f32_32x32x8_bf16 v[32:47], v[116:117], v[20:21], v[32:47]
    s_add_u32 m0, s41, 8192
    s_add_u32 s55, s41, 8192
    buffer_load_dwordx4 v11, s[20:23], s55 offen lds
    s_add_u32 m0, s41, 12288
    s_add_u32 s55, s41, 12288
    buffer_load_dwordx4 v11, s[20:23], s55 offen lds
    s_add_u32 m0, s41, 16384
    s_add_u32 s55, s41, 16384
    buffer_load_dwordx4 v11, s[20:23], s55 offen lds
    s_add_u32 m0, s41, 20480
    s_add_u32 s55, s41, 20480
    buffer_load_dwordx4 v11, s[20:23], s55 offen lds
    s_add_u32 m0, s41, 24576
    s_add_u32 s55, s41, 24576
    buffer_load_dwordx4 v11, s[20:23], s55 offen lds
    s_add_u32 m0, s41, 28672
    s_add_u32 s55, s41, 28672
    buffer_load_dwordx4 v11, s[20:23], s55 offen lds
    s_setprio 3
    v_mfma_f32_32x32x16_bf16 v[48:63], v[112:115], v[24:27], 0
    v_exp_f32 v32, v32
    v_exp_f32 v33, v33
    v_exp_f32 v34, v34
    v_exp_f32 v35, v35
    v_mfma_f32_32x32x8_bf16 v[48:63], v[116:117], v[28:29], v[48:63]
    v_exp_f32 v36, v36
    v_exp_f32 v37, v37
    v_exp_f32 v38, v38
    v_exp_f32 v39, v39
    v_cvt_pk_bf16_f32 v64, v32, v33
    v_cvt_pk_bf16_f32 v65, v34, v35
    v_mfma_f32_32x32x16_bf16 v[96:111], v[136:139], v[72:75], v[96:111]
    v_exp_f32 v40, v40
    v_exp_f32 v41, v41
    v_exp_f32 v42, v42
    v_exp_f32 v43, v43
    v_cvt_pk_bf16_f32 v66, v36, v37
    v_cvt_pk_bf16_f32 v67, v38, v39
    v_mfma_f32_32x32x16_bf16 v[96:111], v[140:143], v[76:79], v[96:111]
    v_exp_f32 v44, v44
    v_exp_f32 v45, v45
    v_exp_f32 v46, v46
    v_exp_f32 v47, v47
    v_cvt_pk_bf16_f32 v68, v40, v41
    v_cvt_pk_bf16_f32 v69, v42, v43
    v_cvt_pk_bf16_f32 v70, v44, v45
    v_cvt_pk_bf16_f32 v71, v46, v47
    s_waitcnt lgkmcnt(0)
    ds_read_b128 v[112:115], v8 offset:5120
    s_mov_b64 exec, s[50:51]
    ds_read_b64 v[116:117], v9 offset:7424
    s_mov_b64 exec, s[42:43]
    ds_read_b128 v[136:139], v10 offset:3584
    ds_read_b128 v[140:143], v10 offset:4224
    s_mov_b64 exec, -1
    v_mfma_f32_32x32x16_bf16 v[32:47], v[120:123], v[16:19], 0
    v_exp_f32 v48, v48
    v_exp_f32 v49, v49
    v_exp_f32 v50, v50
    v_exp_f32 v51, v51
    v_mfma_f32_32x32x8_bf16 v[32:47], v[124:125], v[20:21], v[32:47]
    v_exp_f32 v52, v52
    v_exp_f32 v53, v53
    v_exp_f32 v54, v54
    v_exp_f32 v55, v55
    v_cvt_pk_bf16_f32 v72, v48, v49
    v_cvt_pk_bf16_f32 v73, v50, v51
    v_mfma_f32_32x32x16_bf16 v[80:95], v[128:131], v[64:67], v[80:95]
    v_exp_f32 v56, v56
    v_exp_f32 v57, v57
    v_exp_f32 v58, v58
    v_exp_f32 v59, v59
    v_cvt_pk_bf16_f32 v74, v52, v53
    v_cvt_pk_bf16_f32 v75, v54, v55
    v_mfma_f32_32x32x16_bf16 v[80:95], v[132:135], v[68:71], v[80:95]
    v_exp_f32 v60, v60
    v_exp_f32 v61, v61
    v_exp_f32 v62, v62
    v_exp_f32 v63, v63
    v_cvt_pk_bf16_f32 v76, v56, v57
    v_cvt_pk_bf16_f32 v77, v58, v59
    v_cvt_pk_bf16_f32 v78, v60, v61
    v_cvt_pk_bf16_f32 v79, v62, v63
    s_setprio 2
    v_mfma_f32_32x32x16_bf16 v[48:63], v[120:123], v[24:27], 0
    v_exp_f32 v32, v32
    v_exp_f32 v33, v33
    v_exp_f32 v34, v34
    v_exp_f32 v35, v35
    v_mfma_f32_32x32x8_bf16 v[48:63], v[124:125], v[28:29], v[48:63]
    v_exp_f32 v36, v36
    v_exp_f32 v37, v37
    v_exp_f32 v38, v38
    v_exp_f32 v39, v39
    v_cvt_pk_bf16_f32 v64, v32, v33
    v_cvt_pk_bf16_f32 v65, v34, v35
    v_mfma_f32_32x32x16_bf16 v[96:111], v[128:131], v[72:75], v[96:111]
    v_exp_f32 v40, v40
    v_exp_f32 v41, v41
    v_exp_f32 v42, v42
    v_exp_f32 v43, v43
    v_cvt_pk_bf16_f32 v66, v36, v37
    v_cvt_pk_bf16_f32 v67, v38, v39
    v_mfma_f32_32x32x16_bf16 v[96:111], v[132:135], v[76:79], v[96:111]
    v_exp_f32 v44, v44
    v_exp_f32 v45, v45
    v_exp_f32 v46, v46
    v_exp_f32 v47, v47
    v_cvt_pk_bf16_f32 v68, v40, v41
    v_cvt_pk_bf16_f32 v69, v42, v43
    v_cvt_pk_bf16_f32 v70, v44, v45
    v_cvt_pk_bf16_f32 v71, v46, v47
    s_waitcnt lgkmcnt(0)
    s_waitcnt vmcnt(0)
    s_barrier
    v_mov_b32 v4, 0
    v_mov_b32 v5, s37
    ds_write_b32 v5, v4
    ds_read_b128 v[120:123], v8 offset:7680
    s_mov_b64 exec, s[50:51]
    ds_read_b64 v[124:125], v9 offset:9984
    s_mov_b64 exec, s[42:43]
    ds_read_b128 v[128:131], v10 offset:6144
    ds_read_b128 v[132:135], v10 offset:6784
    s_mov_b64 exec, -1
    v_mfma_f32_32x32x16_bf16 v[32:47], v[112:115], v[16:19], 0
    v_exp_f32 v48, v48
    v_exp_f32 v49, v49
    v_exp_f32 v50, v50
    v_exp_f32 v51, v51
    v_mfma_f32_32x32x8_bf16 v[32:47], v[116:117], v[20:21], v[32:47]
    v_exp_f32 v52, v52
    v_exp_f32 v53, v53
    v_exp_f32 v54, v54
    v_exp_f32 v55, v55
    v_cvt_pk_bf16_f32 v72, v48, v49
    v_cvt_pk_bf16_f32 v73, v50, v51
    v_mfma_f32_32x32x16_bf16 v[80:95], v[136:139], v[64:67], v[80:95]
    v_exp_f32 v56, v56
    v_exp_f32 v57, v57
    v_exp_f32 v58, v58
    v_exp_f32 v59, v59
    v_cvt_pk_bf16_f32 v74, v52, v53
    v_cvt_pk_bf16_f32 v75, v54, v55
    v_mfma_f32_32x32x16_bf16 v[80:95], v[140:143], v[68:71], v[80:95]
    v_exp_f32 v60, v60
    v_exp_f32 v61, v61
    v_exp_f32 v62, v62
    v_exp_f32 v63, v63
    v_cvt_pk_bf16_f32 v76, v56, v57
    v_cvt_pk_bf16_f32 v77, v58, v59
    v_cvt_pk_bf16_f32 v78, v60, v61
    v_cvt_pk_bf16_f32 v79, v62, v63
    s_setprio 3
    v_mfma_f32_32x32x16_bf16 v[48:63], v[112:115], v[24:27], 0
    v_exp_f32 v32, v32
    v_exp_f32 v33, v33
    v_exp_f32 v34, v34
    v_exp_f32 v35, v35
    v_mfma_f32_32x32x8_bf16 v[48:63], v[116:117], v[28:29], v[48:63]
    v_exp_f32 v36, v36
    v_exp_f32 v37, v37
    v_exp_f32 v38, v38
    v_exp_f32 v39, v39
    v_cvt_pk_bf16_f32 v64, v32, v33
    v_cvt_pk_bf16_f32 v65, v34, v35
    v_mfma_f32_32x32x16_bf16 v[96:111], v[136:139], v[72:75], v[96:111]
    v_exp_f32 v40, v40
    v_exp_f32 v41, v41
    v_exp_f32 v42, v42
    v_exp_f32 v43, v43
    v_cvt_pk_bf16_f32 v66, v36, v37
    v_cvt_pk_bf16_f32 v67, v38, v39
    v_mfma_f32_32x32x16_bf16 v[96:111], v[140:143], v[76:79], v[96:111]
    v_exp_f32 v44, v44
    v_exp_f32 v45, v45
    v_exp_f32 v46, v46
    v_exp_f32 v47, v47
    v_cvt_pk_bf16_f32 v68, v40, v41
    v_cvt_pk_bf16_f32 v69, v42, v43
    v_cvt_pk_bf16_f32 v70, v44, v45
    v_cvt_pk_bf16_f32 v71, v46, v47
    s_waitcnt lgkmcnt(0)
    ds_read_b128 v[112:115], v8 offset:10240
    s_mov_b64 exec, s[50:51]
    ds_read_b64 v[116:117], v9 offset:12544
    s_mov_b64 exec, s[42:43]
    ds_read_b128 v[136:139], v10 offset:8704
    ds_read_b128 v[140:143], v10 offset:9344
    s_mov_b64 exec, -1
    v_mfma_f32_32x32x16_bf16 v[32:47], v[120:123], v[16:19], 0
    v_exp_f32 v48, v48
    v_exp_f32 v49, v49
    v_exp_f32 v50, v50
    v_exp_f32 v51, v51
    v_mfma_f32_32x32x8_bf16 v[32:47], v[124:125], v[20:21], v[32:47]
    v_exp_f32 v52, v52
    v_exp_f32 v53, v53
    v_exp_f32 v54, v54
    v_exp_f32 v55, v55
    v_cvt_pk_bf16_f32 v72, v48, v49
    v_cvt_pk_bf16_f32 v73, v50, v51
    v_mfma_f32_32x32x16_bf16 v[80:95], v[128:131], v[64:67], v[80:95]
    v_exp_f32 v56, v56
    v_exp_f32 v57, v57
    v_exp_f32 v58, v58
    v_exp_f32 v59, v59
    v_cvt_pk_bf16_f32 v74, v52, v53
    v_cvt_pk_bf16_f32 v75, v54, v55
    v_mfma_f32_32x32x16_bf16 v[80:95], v[132:135], v[68:71], v[80:95]
    v_exp_f32 v60, v60
    v_exp_f32 v61, v61
    v_exp_f32 v62, v62
    v_exp_f32 v63, v63
    v_cvt_pk_bf16_f32 v76, v56, v57
    v_cvt_pk_bf16_f32 v77, v58, v59
    v_cvt_pk_bf16_f32 v78, v60, v61
    v_cvt_pk_bf16_f32 v79, v62, v63
    v_mfma_f32_32x32x16_bf16 v[48:63], v[120:123], v[24:27], 0
    v_exp_f32 v32, v32
    v_exp_f32 v33, v33
    v_exp_f32 v34, v34
    v_exp_f32 v35, v35
    v_mfma_f32_32x32x8_bf16 v[48:63], v[124:125], v[28:29], v[48:63]
    v_exp_f32 v36, v36
    v_exp_f32 v37, v37
    v_exp_f32 v38, v38
    v_exp_f32 v39, v39
    v_cvt_pk_bf16_f32 v64, v32, v33
    v_cvt_pk_bf16_f32 v65, v34, v35
    v_mfma_f32_32x32x16_bf16 v[96:111], v[128:131], v[72:75], v[96:111]
    v_exp_f32 v40, v40
    v_exp_f32 v41, v41
    v_exp_f32 v42, v42
    v_exp_f32 v43, v43
    v_cvt_pk_bf16_f32 v66, v36, v37
    v_cvt_pk_bf16_f32 v67, v38, v39
    v_mfma_f32_32x32x16_bf16 v[96:111], v[132:135], v[76:79], v[96:111]
    v_exp_f32 v44, v44
    v_exp_f32 v45, v45
    v_exp_f32 v46, v46
    v_exp_f32 v47, v47
    v_cvt_pk_bf16_f32 v68, v40, v41
    v_cvt_pk_bf16_f32 v69, v42, v43
    v_cvt_pk_bf16_f32 v70, v44, v45
    v_cvt_pk_bf16_f32 v71, v46, v47
    s_waitcnt lgkmcnt(0)
    ds_read_b128 v[120:123], v8 offset:12800
    s_mov_b64 exec, s[50:51]
    ds_read_b64 v[124:125], v9 offset:15104
    s_mov_b64 exec, s[42:43]
    ds_read_b128 v[128:131], v10 offset:11264
    ds_read_b128 v[132:135], v10 offset:11904
    s_mov_b64 exec, -1
    v_mfma_f32_32x32x16_bf16 v[32:47], v[112:115], v[16:19], 0
    v_exp_f32 v48, v48
    v_exp_f32 v49, v49
    v_exp_f32 v50, v50
    v_exp_f32 v51, v51
    v_mfma_f32_32x32x8_bf16 v[32:47], v[116:117], v[20:21], v[32:47]
    v_exp_f32 v52, v52
    v_exp_f32 v53, v53
    v_exp_f32 v54, v54
    v_exp_f32 v55, v55
    v_cvt_pk_bf16_f32 v72, v48, v49
    v_cvt_pk_bf16_f32 v73, v50, v51
    v_mfma_f32_32x32x16_bf16 v[80:95], v[136:139], v[64:67], v[80:95]
    v_exp_f32 v56, v56
    v_exp_f32 v57, v57
    v_exp_f32 v58, v58
    v_exp_f32 v59, v59
    v_cvt_pk_bf16_f32 v74, v52, v53
    v_cvt_pk_bf16_f32 v75, v54, v55
    v_mfma_f32_32x32x16_bf16 v[80:95], v[140:143], v[68:71], v[80:95]
    v_exp_f32 v60, v60
    v_exp_f32 v61, v61
    v_exp_f32 v62, v62
    v_exp_f32 v63, v63
    v_cvt_pk_bf16_f32 v76, v56, v57
    v_cvt_pk_bf16_f32 v77, v58, v59
    v_cvt_pk_bf16_f32 v78, v60, v61
    v_cvt_pk_bf16_f32 v79, v62, v63
    v_mfma_f32_32x32x16_bf16 v[48:63], v[112:115], v[24:27], 0
    v_exp_f32 v32, v32
    v_exp_f32 v33, v33
    v_exp_f32 v34, v34
    v_exp_f32 v35, v35
    v_mfma_f32_32x32x8_bf16 v[48:63], v[116:117], v[28:29], v[48:63]
    v_exp_f32 v36, v36
    v_exp_f32 v37, v37
    v_exp_f32 v38, v38
    v_exp_f32 v39, v39
    v_cvt_pk_bf16_f32 v64, v32, v33
    v_cvt_pk_bf16_f32 v65, v34, v35
    v_mfma_f32_32x32x16_bf16 v[96:111], v[136:139], v[72:75], v[96:111]
    v_exp_f32 v40, v40
    v_exp_f32 v41, v41
    v_exp_f32 v42, v42
    v_exp_f32 v43, v43
    v_cvt_pk_bf16_f32 v66, v36, v37
    v_cvt_pk_bf16_f32 v67, v38, v39
    v_mfma_f32_32x32x16_bf16 v[96:111], v[140:143], v[76:79], v[96:111]
    v_exp_f32 v44, v44
    v_exp_f32 v45, v45
    v_exp_f32 v46, v46
    v_exp_f32 v47, v47
    v_cvt_pk_bf16_f32 v68, v40, v41
    v_cvt_pk_bf16_f32 v69, v42, v43
    v_cvt_pk_bf16_f32 v70, v44, v45
    v_cvt_pk_bf16_f32 v71, v46, v47
    s_waitcnt lgkmcnt(0)
    ds_read_b128 v[112:115], v8 offset:15360
    s_mov_b64 exec, s[50:51]
    ds_read_b64 v[116:117], v9 offset:17664
    s_mov_b64 exec, s[42:43]
    ds_read_b128 v[136:139], v10 offset:13824
    ds_read_b128 v[140:143], v10 offset:14464
    s_mov_b64 exec, -1
    v_mfma_f32_32x32x16_bf16 v[32:47], v[120:123], v[16:19], 0
    v_exp_f32 v48, v48
    v_exp_f32 v49, v49
    v_exp_f32 v50, v50
    v_exp_f32 v51, v51
    v_mfma_f32_32x32x8_bf16 v[32:47], v[124:125], v[20:21], v[32:47]
    v_exp_f32 v52, v52
    v_exp_f32 v53, v53
    v_exp_f32 v54, v54
    v_exp_f32 v55, v55
    v_cvt_pk_bf16_f32 v72, v48, v49
    v_cvt_pk_bf16_f32 v73, v50, v51
    v_mfma_f32_32x32x16_bf16 v[80:95], v[128:131], v[64:67], v[80:95]
    v_exp_f32 v56, v56
    v_exp_f32 v57, v57
    v_exp_f32 v58, v58
    v_exp_f32 v59, v59
    v_cvt_pk_bf16_f32 v74, v52, v53
    v_cvt_pk_bf16_f32 v75, v54, v55
    v_mfma_f32_32x32x16_bf16 v[80:95], v[132:135], v[68:71], v[80:95]
    v_exp_f32 v60, v60
    v_exp_f32 v61, v61
    v_exp_f32 v62, v62
    v_exp_f32 v63, v63
    v_cvt_pk_bf16_f32 v76, v56, v57
    v_cvt_pk_bf16_f32 v77, v58, v59
    v_cvt_pk_bf16_f32 v78, v60, v61
    v_cvt_pk_bf16_f32 v79, v62, v63
    v_mfma_f32_32x32x16_bf16 v[48:63], v[120:123], v[24:27], 0
    v_exp_f32 v32, v32
    v_exp_f32 v33, v33
    v_exp_f32 v34, v34
    v_exp_f32 v35, v35
    v_mfma_f32_32x32x8_bf16 v[48:63], v[124:125], v[28:29], v[48:63]
    v_exp_f32 v36, v36
    v_exp_f32 v37, v37
    v_exp_f32 v38, v38
    v_exp_f32 v39, v39
    v_cvt_pk_bf16_f32 v64, v32, v33
    v_cvt_pk_bf16_f32 v65, v34, v35
    v_mfma_f32_32x32x16_bf16 v[96:111], v[128:131], v[72:75], v[96:111]
    v_exp_f32 v40, v40
    v_exp_f32 v41, v41
    v_exp_f32 v42, v42
    v_exp_f32 v43, v43
    v_cvt_pk_bf16_f32 v66, v36, v37
    v_cvt_pk_bf16_f32 v67, v38, v39
    v_mfma_f32_32x32x16_bf16 v[96:111], v[132:135], v[76:79], v[96:111]
    v_exp_f32 v44, v44
    v_exp_f32 v45, v45
    v_exp_f32 v46, v46
    v_exp_f32 v47, v47
    v_cvt_pk_bf16_f32 v68, v40, v41
    v_cvt_pk_bf16_f32 v69, v42, v43
    v_cvt_pk_bf16_f32 v70, v44, v45
    v_cvt_pk_bf16_f32 v71, v46, v47
    s_waitcnt lgkmcnt(0)
    ds_read_b128 v[120:123], v8 offset:17920
    s_mov_b64 exec, s[50:51]
    ds_read_b64 v[124:125], v9 offset:20224
    s_mov_b64 exec, s[42:43]
    ds_read_b128 v[128:131], v10 offset:16384
    ds_read_b128 v[132:135], v10 offset:17024
    s_mov_b64 exec, -1
    v_mfma_f32_32x32x16_bf16 v[32:47], v[112:115], v[16:19], 0
    v_exp_f32 v48, v48
    v_exp_f32 v49, v49
    v_exp_f32 v50, v50
    v_exp_f32 v51, v51
    v_mfma_f32_32x32x8_bf16 v[32:47], v[116:117], v[20:21], v[32:47]
    v_exp_f32 v52, v52
    v_exp_f32 v53, v53
    v_exp_f32 v54, v54
    v_exp_f32 v55, v55
    v_cvt_pk_bf16_f32 v72, v48, v49
    v_cvt_pk_bf16_f32 v73, v50, v51
    v_mfma_f32_32x32x16_bf16 v[80:95], v[136:139], v[64:67], v[80:95]
    v_exp_f32 v56, v56
    v_exp_f32 v57, v57
    v_exp_f32 v58, v58
    v_exp_f32 v59, v59
    v_cvt_pk_bf16_f32 v74, v52, v53
    v_cvt_pk_bf16_f32 v75, v54, v55
    v_mfma_f32_32x32x16_bf16 v[80:95], v[140:143], v[68:71], v[80:95]
    v_exp_f32 v60, v60
    v_exp_f32 v61, v61
    v_exp_f32 v62, v62
    v_exp_f32 v63, v63
    v_cvt_pk_bf16_f32 v76, v56, v57
    v_cvt_pk_bf16_f32 v77, v58, v59
    v_cvt_pk_bf16_f32 v78, v60, v61
    v_cvt_pk_bf16_f32 v79, v62, v63
    v_mfma_f32_32x32x16_bf16 v[48:63], v[112:115], v[24:27], 0
    v_exp_f32 v32, v32
    v_exp_f32 v33, v33
    v_exp_f32 v34, v34
    v_exp_f32 v35, v35
    v_mfma_f32_32x32x8_bf16 v[48:63], v[116:117], v[28:29], v[48:63]
    v_exp_f32 v36, v36
    v_exp_f32 v37, v37
    v_exp_f32 v38, v38
    v_exp_f32 v39, v39
    v_cvt_pk_bf16_f32 v64, v32, v33
    v_cvt_pk_bf16_f32 v65, v34, v35
    v_mfma_f32_32x32x16_bf16 v[96:111], v[136:139], v[72:75], v[96:111]
    v_exp_f32 v40, v40
    v_exp_f32 v41, v41
    v_exp_f32 v42, v42
    v_exp_f32 v43, v43
    v_cvt_pk_bf16_f32 v66, v36, v37
    v_cvt_pk_bf16_f32 v67, v38, v39
    v_mfma_f32_32x32x16_bf16 v[96:111], v[140:143], v[76:79], v[96:111]
    v_exp_f32 v44, v44
    v_exp_f32 v45, v45
    v_exp_f32 v46, v46
    v_exp_f32 v47, v47
    v_cvt_pk_bf16_f32 v68, v40, v41
    v_cvt_pk_bf16_f32 v69, v42, v43
    v_cvt_pk_bf16_f32 v70, v44, v45
    v_cvt_pk_bf16_f32 v71, v46, v47
    s_waitcnt lgkmcnt(0)
    ds_read_b128 v[112:115], v8 offset:20480
    s_mov_b64 exec, s[50:51]
    ds_read_b64 v[116:117], v9 offset:22784
    s_mov_b64 exec, s[42:43]
    ds_read_b128 v[136:139], v10 offset:18944
    ds_read_b128 v[140:143], v10 offset:19584
    s_mov_b64 exec, -1
    v_mfma_f32_32x32x16_bf16 v[32:47], v[120:123], v[16:19], 0
    v_exp_f32 v48, v48
    v_exp_f32 v49, v49
    v_exp_f32 v50, v50
    v_exp_f32 v51, v51
    v_mfma_f32_32x32x8_bf16 v[32:47], v[124:125], v[20:21], v[32:47]
    v_exp_f32 v52, v52
    v_exp_f32 v53, v53
    v_exp_f32 v54, v54
    v_exp_f32 v55, v55
    v_cvt_pk_bf16_f32 v72, v48, v49
    v_cvt_pk_bf16_f32 v73, v50, v51
    v_mfma_f32_32x32x16_bf16 v[80:95], v[128:131], v[64:67], v[80:95]
    v_exp_f32 v56, v56
    v_exp_f32 v57, v57
    v_exp_f32 v58, v58
    v_exp_f32 v59, v59
    v_cvt_pk_bf16_f32 v74, v52, v53
    v_cvt_pk_bf16_f32 v75, v54, v55
    v_mfma_f32_32x32x16_bf16 v[80:95], v[132:135], v[68:71], v[80:95]
    v_exp_f32 v60, v60
    v_exp_f32 v61, v61
    v_exp_f32 v62, v62
    v_exp_f32 v63, v63
    v_cvt_pk_bf16_f32 v76, v56, v57
    v_cvt_pk_bf16_f32 v77, v58, v59
    v_cvt_pk_bf16_f32 v78, v60, v61
    v_cvt_pk_bf16_f32 v79, v62, v63
    s_setprio 2
    v_mfma_f32_32x32x16_bf16 v[48:63], v[120:123], v[24:27], 0
    v_exp_f32 v32, v32
    v_exp_f32 v33, v33
    v_exp_f32 v34, v34
    v_exp_f32 v35, v35
    v_mfma_f32_32x32x8_bf16 v[48:63], v[124:125], v[28:29], v[48:63]
    v_exp_f32 v36, v36
    v_exp_f32 v37, v37
    v_exp_f32 v38, v38
    v_exp_f32 v39, v39
    v_cvt_pk_bf16_f32 v64, v32, v33
    v_cvt_pk_bf16_f32 v65, v34, v35
    v_mfma_f32_32x32x16_bf16 v[96:111], v[128:131], v[72:75], v[96:111]
    v_exp_f32 v40, v40
    v_exp_f32 v41, v41
    v_exp_f32 v42, v42
    v_exp_f32 v43, v43
    v_cvt_pk_bf16_f32 v66, v36, v37
    v_cvt_pk_bf16_f32 v67, v38, v39
    v_mfma_f32_32x32x16_bf16 v[96:111], v[132:135], v[76:79], v[96:111]
    v_exp_f32 v44, v44
    v_exp_f32 v45, v45
    v_exp_f32 v46, v46
    v_exp_f32 v47, v47
    v_cvt_pk_bf16_f32 v68, v40, v41
    v_cvt_pk_bf16_f32 v69, v42, v43
    v_cvt_pk_bf16_f32 v70, v44, v45
    v_cvt_pk_bf16_f32 v71, v46, v47
    s_waitcnt lgkmcnt(0)
    ds_read_b128 v[120:123], v8 offset:23040
    s_mov_b64 exec, s[50:51]
    ds_read_b64 v[124:125], v9 offset:25344
    s_mov_b64 exec, s[42:43]
    ds_read_b128 v[128:131], v10 offset:21504
    ds_read_b128 v[132:135], v10 offset:22144
    s_mov_b64 exec, -1
    v_mfma_f32_32x32x16_bf16 v[32:47], v[112:115], v[16:19], 0
    v_exp_f32 v48, v48
    v_exp_f32 v49, v49
    v_exp_f32 v50, v50
    v_exp_f32 v51, v51
    v_mfma_f32_32x32x8_bf16 v[32:47], v[116:117], v[20:21], v[32:47]
    v_exp_f32 v52, v52
    v_exp_f32 v53, v53
    v_exp_f32 v54, v54
    v_exp_f32 v55, v55
    v_cvt_pk_bf16_f32 v72, v48, v49
    v_cvt_pk_bf16_f32 v73, v50, v51
    v_mfma_f32_32x32x16_bf16 v[80:95], v[136:139], v[64:67], v[80:95]
    v_exp_f32 v56, v56
    v_exp_f32 v57, v57
    v_exp_f32 v58, v58
    v_exp_f32 v59, v59
    v_cvt_pk_bf16_f32 v74, v52, v53
    v_cvt_pk_bf16_f32 v75, v54, v55
    v_mfma_f32_32x32x16_bf16 v[80:95], v[140:143], v[68:71], v[80:95]
    v_exp_f32 v60, v60
    v_exp_f32 v61, v61
    v_exp_f32 v62, v62
    v_exp_f32 v63, v63
    v_cvt_pk_bf16_f32 v76, v56, v57
    v_cvt_pk_bf16_f32 v77, v58, v59
    v_cvt_pk_bf16_f32 v78, v60, v61
    v_cvt_pk_bf16_f32 v79, v62, v63
    v_mfma_f32_32x32x16_bf16 v[48:63], v[112:115], v[24:27], 0
    v_exp_f32 v32, v32
    v_exp_f32 v33, v33
    v_exp_f32 v34, v34
    v_exp_f32 v35, v35
    v_mfma_f32_32x32x8_bf16 v[48:63], v[116:117], v[28:29], v[48:63]
    v_exp_f32 v36, v36
    v_exp_f32 v37, v37
    v_exp_f32 v38, v38
    v_exp_f32 v39, v39
    v_cvt_pk_bf16_f32 v64, v32, v33
    v_cvt_pk_bf16_f32 v65, v34, v35
    v_mfma_f32_32x32x16_bf16 v[96:111], v[136:139], v[72:75], v[96:111]
    v_exp_f32 v40, v40
    v_exp_f32 v41, v41
    v_exp_f32 v42, v42
    v_exp_f32 v43, v43
    v_cvt_pk_bf16_f32 v66, v36, v37
    v_cvt_pk_bf16_f32 v67, v38, v39
    v_mfma_f32_32x32x16_bf16 v[96:111], v[140:143], v[76:79], v[96:111]
    v_exp_f32 v44, v44
    v_exp_f32 v45, v45
    v_exp_f32 v46, v46
    v_exp_f32 v47, v47
    v_cvt_pk_bf16_f32 v68, v40, v41
    v_cvt_pk_bf16_f32 v69, v42, v43
    v_cvt_pk_bf16_f32 v70, v44, v45
    v_cvt_pk_bf16_f32 v71, v46, v47
    s_waitcnt lgkmcnt(0)
    ds_read_b128 v[112:115], v8 offset:25600
    s_mov_b64 exec, s[50:51]
    ds_read_b64 v[116:117], v9 offset:27904
    s_mov_b64 exec, s[42:43]
    ds_read_b128 v[136:139], v10 offset:24064
    ds_read_b128 v[140:143], v10 offset:24704
    s_mov_b64 exec, -1
    v_mfma_f32_32x32x16_bf16 v[32:47], v[120:123], v[16:19], 0
    v_exp_f32 v48, v48
    v_exp_f32 v49, v49
    v_exp_f32 v50, v50
    v_exp_f32 v51, v51
    v_mfma_f32_32x32x8_bf16 v[32:47], v[124:125], v[20:21], v[32:47]
    v_exp_f32 v52, v52
    v_exp_f32 v53, v53
    v_exp_f32 v54, v54
    v_exp_f32 v55, v55
    v_cvt_pk_bf16_f32 v72, v48, v49
    v_cvt_pk_bf16_f32 v73, v50, v51
    v_mfma_f32_32x32x16_bf16 v[80:95], v[128:131], v[64:67], v[80:95]
    v_exp_f32 v56, v56
    v_exp_f32 v57, v57
    v_exp_f32 v58, v58
    v_exp_f32 v59, v59
    v_cvt_pk_bf16_f32 v74, v52, v53
    v_cvt_pk_bf16_f32 v75, v54, v55
    v_mfma_f32_32x32x16_bf16 v[80:95], v[132:135], v[68:71], v[80:95]
    v_exp_f32 v60, v60
    v_exp_f32 v61, v61
    v_exp_f32 v62, v62
    v_exp_f32 v63, v63
    v_cvt_pk_bf16_f32 v76, v56, v57
    v_cvt_pk_bf16_f32 v77, v58, v59
    v_cvt_pk_bf16_f32 v78, v60, v61
    v_cvt_pk_bf16_f32 v79, v62, v63
    s_setprio 1
    v_mfma_f32_32x32x16_bf16 v[48:63], v[120:123], v[24:27], 0
    v_exp_f32 v32, v32
    v_exp_f32 v33, v33
    v_exp_f32 v34, v34
    v_exp_f32 v35, v35
    v_mfma_f32_32x32x8_bf16 v[48:63], v[124:125], v[28:29], v[48:63]
    v_exp_f32 v36, v36
    v_exp_f32 v37, v37
    v_exp_f32 v38, v38
    v_exp_f32 v39, v39
    v_cvt_pk_bf16_f32 v64, v32, v33
    v_cvt_pk_bf16_f32 v65, v34, v35
    v_mfma_f32_32x32x16_bf16 v[96:111], v[128:131], v[72:75], v[96:111]
    v_exp_f32 v40, v40
    v_exp_f32 v41, v41
    v_exp_f32 v42, v42
    v_exp_f32 v43, v43
    v_cvt_pk_bf16_f32 v66, v36, v37
    v_cvt_pk_bf16_f32 v67, v38, v39
    v_mfma_f32_32x32x16_bf16 v[96:111], v[132:135], v[76:79], v[96:111]
    v_exp_f32 v44, v44
    v_exp_f32 v45, v45
    v_exp_f32 v46, v46
    v_exp_f32 v47, v47
    v_cvt_pk_bf16_f32 v68, v40, v41
    v_cvt_pk_bf16_f32 v69, v42, v43
    v_cvt_pk_bf16_f32 v70, v44, v45
    v_cvt_pk_bf16_f32 v71, v46, v47
    s_waitcnt lgkmcnt(0)
    ds_read_b128 v[120:123], v8 offset:28160
    s_mov_b64 exec, s[50:51]
    ds_read_b64 v[124:125], v9 offset:30464
    s_mov_b64 exec, s[42:43]
    ds_read_b128 v[128:131], v10 offset:26624
    ds_read_b128 v[132:135], v10 offset:27264
    s_mov_b64 exec, -1
    v_mfma_f32_32x32x16_bf16 v[32:47], v[112:115], v[16:19], 0
    v_exp_f32 v48, v48
    v_exp_f32 v49, v49
    v_exp_f32 v50, v50
    v_exp_f32 v51, v51
    v_mfma_f32_32x32x8_bf16 v[32:47], v[116:117], v[20:21], v[32:47]
    v_exp_f32 v52, v52
    v_exp_f32 v53, v53
    v_exp_f32 v54, v54
    v_exp_f32 v55, v55
    v_cvt_pk_bf16_f32 v72, v48, v49
    v_cvt_pk_bf16_f32 v73, v50, v51
    v_mfma_f32_32x32x16_bf16 v[80:95], v[136:139], v[64:67], v[80:95]
    v_exp_f32 v56, v56
    v_exp_f32 v57, v57
    v_exp_f32 v58, v58
    v_exp_f32 v59, v59
    v_cvt_pk_bf16_f32 v74, v52, v53
    v_cvt_pk_bf16_f32 v75, v54, v55
    v_mfma_f32_32x32x16_bf16 v[80:95], v[140:143], v[68:71], v[80:95]
    v_exp_f32 v60, v60
    v_exp_f32 v61, v61
    v_exp_f32 v62, v62
    v_exp_f32 v63, v63
    v_cvt_pk_bf16_f32 v76, v56, v57
    v_cvt_pk_bf16_f32 v77, v58, v59
    v_cvt_pk_bf16_f32 v78, v60, v61
    v_cvt_pk_bf16_f32 v79, v62, v63
    s_setprio 0
    v_mfma_f32_32x32x16_bf16 v[48:63], v[112:115], v[24:27], 0
    v_exp_f32 v32, v32
    v_exp_f32 v33, v33
    v_exp_f32 v34, v34
    v_exp_f32 v35, v35
    v_mfma_f32_32x32x8_bf16 v[48:63], v[116:117], v[28:29], v[48:63]
    v_exp_f32 v36, v36
    v_exp_f32 v37, v37
    v_exp_f32 v38, v38
    v_exp_f32 v39, v39
    v_cvt_pk_bf16_f32 v64, v32, v33
    v_cvt_pk_bf16_f32 v65, v34, v35
    v_mfma_f32_32x32x16_bf16 v[96:111], v[136:139], v[72:75], v[96:111]
    v_exp_f32 v40, v40
    v_exp_f32 v41, v41
    v_exp_f32 v42, v42
    v_exp_f32 v43, v43
    v_cvt_pk_bf16_f32 v66, v36, v37
    v_cvt_pk_bf16_f32 v67, v38, v39
    v_mfma_f32_32x32x16_bf16 v[96:111], v[140:143], v[76:79], v[96:111]
    v_exp_f32 v44, v44
    v_exp_f32 v45, v45
    v_exp_f32 v46, v46
    v_exp_f32 v47, v47
    v_cvt_pk_bf16_f32 v68, v40, v41
    v_cvt_pk_bf16_f32 v69, v42, v43
    v_cvt_pk_bf16_f32 v70, v44, v45
    v_cvt_pk_bf16_f32 v71, v46, v47
    s_waitcnt lgkmcnt(0)
    s_barrier
    ds_read_b128 v[112:115], v8 offset:30720
    s_mov_b64 exec, s[50:51]
    ds_read_b64 v[116:117], v9 offset:33024
    s_mov_b64 exec, s[42:43]
    ds_read_b128 v[136:139], v10 offset:29184
    ds_read_b128 v[140:143], v10 offset:29824
    s_mov_b64 exec, -1
    v_mfma_f32_32x32x16_bf16 v[32:47], v[120:123], v[16:19], 0
    v_exp_f32 v48, v48
    v_exp_f32 v49, v49
    v_exp_f32 v50, v50
    v_exp_f32 v51, v51
    v_mfma_f32_32x32x8_bf16 v[32:47], v[124:125], v[20:21], v[32:47]
    v_exp_f32 v52, v52
    v_exp_f32 v53, v53
    v_exp_f32 v54, v54
    v_exp_f32 v55, v55
    v_cvt_pk_bf16_f32 v72, v48, v49
    v_cvt_pk_bf16_f32 v73, v50, v51
    v_mfma_f32_32x32x16_bf16 v[80:95], v[128:131], v[64:67], v[80:95]
    v_exp_f32 v56, v56
    v_exp_f32 v57, v57
    v_exp_f32 v58, v58
    v_exp_f32 v59, v59
    v_cvt_pk_bf16_f32 v74, v52, v53
    v_cvt_pk_bf16_f32 v75, v54, v55
    v_mfma_f32_32x32x16_bf16 v[80:95], v[132:135], v[68:71], v[80:95]
    v_exp_f32 v60, v60
    v_exp_f32 v61, v61
    v_exp_f32 v62, v62
    v_exp_f32 v63, v63
    v_cvt_pk_bf16_f32 v76, v56, v57
    v_cvt_pk_bf16_f32 v77, v58, v59
    v_cvt_pk_bf16_f32 v78, v60, v61
    v_cvt_pk_bf16_f32 v79, v62, v63
    s_setprio 3
    v_mfma_f32_32x32x16_bf16 v[48:63], v[120:123], v[24:27], 0
    v_exp_f32 v32, v32
    v_exp_f32 v33, v33
    v_exp_f32 v34, v34
    v_exp_f32 v35, v35
    v_mfma_f32_32x32x8_bf16 v[48:63], v[124:125], v[28:29], v[48:63]
    v_exp_f32 v36, v36
    v_exp_f32 v37, v37
    v_exp_f32 v38, v38
    v_exp_f32 v39, v39
    v_cvt_pk_bf16_f32 v64, v32, v33
    v_cvt_pk_bf16_f32 v65, v34, v35
    v_mfma_f32_32x32x16_bf16 v[96:111], v[128:131], v[72:75], v[96:111]
    v_exp_f32 v40, v40
    v_exp_f32 v41, v41
    v_exp_f32 v42, v42
    v_exp_f32 v43, v43
    v_cvt_pk_bf16_f32 v66, v36, v37
    v_cvt_pk_bf16_f32 v67, v38, v39
    v_mfma_f32_32x32x16_bf16 v[96:111], v[132:135], v[76:79], v[96:111]
    v_exp_f32 v44, v44
    v_exp_f32 v45, v45
    v_exp_f32 v46, v46
    v_exp_f32 v47, v47
    v_cvt_pk_bf16_f32 v68, v40, v41
    v_cvt_pk_bf16_f32 v69, v42, v43
    v_cvt_pk_bf16_f32 v70, v44, v45
    v_cvt_pk_bf16_f32 v71, v46, v47
    s_waitcnt lgkmcnt(0)
    ds_read_b128 v[120:123], v8 offset:33280
    s_mov_b64 exec, s[50:51]
    ds_read_b64 v[124:125], v9 offset:35584
    s_mov_b64 exec, s[42:43]
    ds_read_b128 v[128:131], v10 offset:31744
    ds_read_b128 v[132:135], v10 offset:32384
    s_mov_b64 exec, -1
    v_mfma_f32_32x32x16_bf16 v[32:47], v[112:115], v[16:19], 0
    v_exp_f32 v48, v48
    v_exp_f32 v49, v49
    v_exp_f32 v50, v50
    v_exp_f32 v51, v51
    v_mfma_f32_32x32x8_bf16 v[32:47], v[116:117], v[20:21], v[32:47]
    v_exp_f32 v52, v52
    v_exp_f32 v53, v53
    v_exp_f32 v54, v54
    v_exp_f32 v55, v55
    v_cvt_pk_bf16_f32 v72, v48, v49
    v_cvt_pk_bf16_f32 v73, v50, v51
    v_mfma_f32_32x32x16_bf16 v[80:95], v[136:139], v[64:67], v[80:95]
    v_exp_f32 v56, v56
    v_exp_f32 v57, v57
    v_exp_f32 v58, v58
    v_exp_f32 v59, v59
    v_cvt_pk_bf16_f32 v74, v52, v53
    v_cvt_pk_bf16_f32 v75, v54, v55
    v_mfma_f32_32x32x16_bf16 v[80:95], v[140:143], v[68:71], v[80:95]
    v_exp_f32 v60, v60
    v_exp_f32 v61, v61
    v_exp_f32 v62, v62
    v_exp_f32 v63, v63
    v_cvt_pk_bf16_f32 v76, v56, v57
    v_cvt_pk_bf16_f32 v77, v58, v59
    v_cvt_pk_bf16_f32 v78, v60, v61
    v_cvt_pk_bf16_f32 v79, v62, v63
    v_mfma_f32_32x32x16_bf16 v[48:63], v[112:115], v[24:27], 0
    v_exp_f32 v32, v32
    v_exp_f32 v33, v33
    v_exp_f32 v34, v34
    v_exp_f32 v35, v35
    v_mfma_f32_32x32x8_bf16 v[48:63], v[116:117], v[28:29], v[48:63]
    v_exp_f32 v36, v36
    v_exp_f32 v37, v37
    v_exp_f32 v38, v38
    v_exp_f32 v39, v39
    v_cvt_pk_bf16_f32 v64, v32, v33
    v_cvt_pk_bf16_f32 v65, v34, v35
    v_mfma_f32_32x32x16_bf16 v[96:111], v[136:139], v[72:75], v[96:111]
    v_exp_f32 v40, v40
    v_exp_f32 v41, v41
    v_exp_f32 v42, v42
    v_exp_f32 v43, v43
    v_cvt_pk_bf16_f32 v66, v36, v37
    v_cvt_pk_bf16_f32 v67, v38, v39
    v_mfma_f32_32x32x16_bf16 v[96:111], v[140:143], v[76:79], v[96:111]
    v_exp_f32 v44, v44
    v_exp_f32 v45, v45
    v_exp_f32 v46, v46
    v_exp_f32 v47, v47
    v_cvt_pk_bf16_f32 v68, v40, v41
    v_cvt_pk_bf16_f32 v69, v42, v43
    v_cvt_pk_bf16_f32 v70, v44, v45
    v_cvt_pk_bf16_f32 v71, v46, v47
    s_waitcnt lgkmcnt(0)
    ds_read_b128 v[112:115], v8 offset:35840
    s_mov_b64 exec, s[50:51]
    ds_read_b64 v[116:117], v9 offset:38144
    s_mov_b64 exec, s[42:43]
    ds_read_b128 v[136:139], v10 offset:34304
    ds_read_b128 v[140:143], v10 offset:34944
    s_mov_b64 exec, -1
    v_mfma_f32_32x32x16_bf16 v[32:47], v[120:123], v[16:19], 0
    v_exp_f32 v48, v48
    v_exp_f32 v49, v49
    v_exp_f32 v50, v50
    v_exp_f32 v51, v51
    v_mfma_f32_32x32x8_bf16 v[32:47], v[124:125], v[20:21], v[32:47]
    v_exp_f32 v52, v52
    v_exp_f32 v53, v53
    v_exp_f32 v54, v54
    v_exp_f32 v55, v55
    v_cvt_pk_bf16_f32 v72, v48, v49
    v_cvt_pk_bf16_f32 v73, v50, v51
    v_mfma_f32_32x32x16_bf16 v[80:95], v[128:131], v[64:67], v[80:95]
    v_exp_f32 v56, v56
    v_exp_f32 v57, v57
    v_exp_f32 v58, v58
    v_exp_f32 v59, v59
    v_cvt_pk_bf16_f32 v74, v52, v53
    v_cvt_pk_bf16_f32 v75, v54, v55
    v_mfma_f32_32x32x16_bf16 v[80:95], v[132:135], v[68:71], v[80:95]
    v_exp_f32 v60, v60
    v_exp_f32 v61, v61
    v_exp_f32 v62, v62
    v_exp_f32 v63, v63
    v_cvt_pk_bf16_f32 v76, v56, v57
    v_cvt_pk_bf16_f32 v77, v58, v59
    v_cvt_pk_bf16_f32 v78, v60, v61
    v_cvt_pk_bf16_f32 v79, v62, v63
    v_mfma_f32_32x32x16_bf16 v[48:63], v[120:123], v[24:27], 0
    v_exp_f32 v32, v32
    v_exp_f32 v33, v33
    v_exp_f32 v34, v34
    v_exp_f32 v35, v35
    v_mfma_f32_32x32x8_bf16 v[48:63], v[124:125], v[28:29], v[48:63]
    v_exp_f32 v36, v36
    v_exp_f32 v37, v37
    v_exp_f32 v38, v38
    v_exp_f32 v39, v39
    v_cvt_pk_bf16_f32 v64, v32, v33
    v_cvt_pk_bf16_f32 v65, v34, v35
    v_mfma_f32_32x32x16_bf16 v[96:111], v[128:131], v[72:75], v[96:111]
    v_exp_f32 v40, v40
    v_exp_f32 v41, v41
    v_exp_f32 v42, v42
    v_exp_f32 v43, v43
    v_cvt_pk_bf16_f32 v66, v36, v37
    v_cvt_pk_bf16_f32 v67, v38, v39
    v_mfma_f32_32x32x16_bf16 v[96:111], v[132:135], v[76:79], v[96:111]
    v_exp_f32 v44, v44
    v_exp_f32 v45, v45
    v_exp_f32 v46, v46
    v_exp_f32 v47, v47
    v_cvt_pk_bf16_f32 v68, v40, v41
    v_cvt_pk_bf16_f32 v69, v42, v43
    v_cvt_pk_bf16_f32 v70, v44, v45
    v_cvt_pk_bf16_f32 v71, v46, v47
    s_waitcnt lgkmcnt(0)
    ds_read_b128 v[120:123], v8 offset:38400
    s_mov_b64 exec, s[50:51]
    ds_read_b64 v[124:125], v9 offset:40704
    s_mov_b64 exec, s[42:43]
    ds_read_b128 v[128:131], v10 offset:36864
    ds_read_b128 v[132:135], v10 offset:37504
    s_mov_b64 exec, -1
    v_mfma_f32_32x32x16_bf16 v[32:47], v[112:115], v[16:19], 0
    v_exp_f32 v48, v48
    v_exp_f32 v49, v49
    v_exp_f32 v50, v50
    v_exp_f32 v51, v51
    v_mfma_f32_32x32x8_bf16 v[32:47], v[116:117], v[20:21], v[32:47]
    v_exp_f32 v52, v52
    v_exp_f32 v53, v53
    v_exp_f32 v54, v54
    v_exp_f32 v55, v55
    v_cvt_pk_bf16_f32 v72, v48, v49
    v_cvt_pk_bf16_f32 v73, v50, v51
    v_mfma_f32_32x32x16_bf16 v[80:95], v[136:139], v[64:67], v[80:95]
    v_exp_f32 v56, v56
    v_exp_f32 v57, v57
    v_exp_f32 v58, v58
    v_exp_f32 v59, v59
    v_cvt_pk_bf16_f32 v74, v52, v53
    v_cvt_pk_bf16_f32 v75, v54, v55
    v_mfma_f32_32x32x16_bf16 v[80:95], v[140:143], v[68:71], v[80:95]
    v_exp_f32 v60, v60
    v_exp_f32 v61, v61
    v_exp_f32 v62, v62
    v_exp_f32 v63, v63
    v_cvt_pk_bf16_f32 v76, v56, v57
    v_cvt_pk_bf16_f32 v77, v58, v59
    v_cvt_pk_bf16_f32 v78, v60, v61
    v_cvt_pk_bf16_f32 v79, v62, v63
    v_mfma_f32_32x32x16_bf16 v[48:63], v[112:115], v[24:27], 0
    v_exp_f32 v32, v32
    v_exp_f32 v33, v33
    v_exp_f32 v34, v34
    v_exp_f32 v35, v35
    v_mfma_f32_32x32x8_bf16 v[48:63], v[116:117], v[28:29], v[48:63]
    v_exp_f32 v36, v36
    v_exp_f32 v37, v37
    v_exp_f32 v38, v38
    v_exp_f32 v39, v39
    v_cvt_pk_bf16_f32 v64, v32, v33
    v_cvt_pk_bf16_f32 v65, v34, v35
    v_mfma_f32_32x32x16_bf16 v[96:111], v[136:139], v[72:75], v[96:111]
    v_exp_f32 v40, v40
    v_exp_f32 v41, v41
    v_exp_f32 v42, v42
    v_exp_f32 v43, v43
    v_cvt_pk_bf16_f32 v66, v36, v37
    v_cvt_pk_bf16_f32 v67, v38, v39
    v_mfma_f32_32x32x16_bf16 v[96:111], v[140:143], v[76:79], v[96:111]
    v_exp_f32 v44, v44
    v_exp_f32 v45, v45
    v_exp_f32 v46, v46
    v_exp_f32 v47, v47
    v_cvt_pk_bf16_f32 v68, v40, v41
    v_cvt_pk_bf16_f32 v69, v42, v43
    v_cvt_pk_bf16_f32 v70, v44, v45
    v_cvt_pk_bf16_f32 v71, v46, v47
    s_waitcnt lgkmcnt(0)
    ds_read_b128 v[112:115], v8 offset:40960
    s_mov_b64 exec, s[50:51]
    ds_read_b64 v[116:117], v9 offset:43264
    s_mov_b64 exec, s[42:43]
    ds_read_b128 v[136:139], v10 offset:39424
    ds_read_b128 v[140:143], v10 offset:40064
    s_mov_b64 exec, -1
    v_mfma_f32_32x32x16_bf16 v[32:47], v[120:123], v[16:19], 0
    v_exp_f32 v48, v48
    v_exp_f32 v49, v49
    v_exp_f32 v50, v50
    v_exp_f32 v51, v51
    v_mfma_f32_32x32x8_bf16 v[32:47], v[124:125], v[20:21], v[32:47]
    v_exp_f32 v52, v52
    v_exp_f32 v53, v53
    v_exp_f32 v54, v54
    v_exp_f32 v55, v55
    v_cvt_pk_bf16_f32 v72, v48, v49
    v_cvt_pk_bf16_f32 v73, v50, v51
    v_mfma_f32_32x32x16_bf16 v[80:95], v[128:131], v[64:67], v[80:95]
    v_exp_f32 v56, v56
    v_exp_f32 v57, v57
    v_exp_f32 v58, v58
    v_exp_f32 v59, v59
    v_cvt_pk_bf16_f32 v74, v52, v53
    v_cvt_pk_bf16_f32 v75, v54, v55
    v_mfma_f32_32x32x16_bf16 v[80:95], v[132:135], v[68:71], v[80:95]
    v_exp_f32 v60, v60
    v_exp_f32 v61, v61
    v_exp_f32 v62, v62
    v_exp_f32 v63, v63
    v_cvt_pk_bf16_f32 v76, v56, v57
    v_cvt_pk_bf16_f32 v77, v58, v59
    v_cvt_pk_bf16_f32 v78, v60, v61
    v_cvt_pk_bf16_f32 v79, v62, v63
    v_mfma_f32_32x32x16_bf16 v[48:63], v[120:123], v[24:27], 0
    v_exp_f32 v32, v32
    v_exp_f32 v33, v33
    v_exp_f32 v34, v34
    v_exp_f32 v35, v35
    v_mfma_f32_32x32x8_bf16 v[48:63], v[124:125], v[28:29], v[48:63]
    v_exp_f32 v36, v36
    v_exp_f32 v37, v37
    v_exp_f32 v38, v38
    v_exp_f32 v39, v39
    v_cvt_pk_bf16_f32 v64, v32, v33
    v_cvt_pk_bf16_f32 v65, v34, v35
    v_mfma_f32_32x32x16_bf16 v[96:111], v[128:131], v[72:75], v[96:111]
    v_exp_f32 v40, v40
    v_exp_f32 v41, v41
    v_exp_f32 v42, v42
    v_exp_f32 v43, v43
    v_cvt_pk_bf16_f32 v66, v36, v37
    v_cvt_pk_bf16_f32 v67, v38, v39
    v_mfma_f32_32x32x16_bf16 v[96:111], v[132:135], v[76:79], v[96:111]
    v_exp_f32 v44, v44
    v_exp_f32 v45, v45
    v_exp_f32 v46, v46
    v_exp_f32 v47, v47
    v_cvt_pk_bf16_f32 v68, v40, v41
    v_cvt_pk_bf16_f32 v69, v42, v43
    v_cvt_pk_bf16_f32 v70, v44, v45
    v_cvt_pk_bf16_f32 v71, v46, v47
    s_waitcnt lgkmcnt(0)
    ds_read_b128 v[120:123], v8 offset:43520
    s_mov_b64 exec, s[50:51]
    ds_read_b64 v[124:125], v9 offset:45824
    s_mov_b64 exec, s[42:43]
    ds_read_b128 v[128:131], v10 offset:41984
    ds_read_b128 v[132:135], v10 offset:42624
    s_mov_b64 exec, -1
    v_mfma_f32_32x32x16_bf16 v[32:47], v[112:115], v[16:19], 0
    v_exp_f32 v48, v48
    v_exp_f32 v49, v49
    v_exp_f32 v50, v50
    v_exp_f32 v51, v51
    v_mfma_f32_32x32x8_bf16 v[32:47], v[116:117], v[20:21], v[32:47]
    v_exp_f32 v52, v52
    v_exp_f32 v53, v53
    v_exp_f32 v54, v54
    v_exp_f32 v55, v55
    v_cvt_pk_bf16_f32 v72, v48, v49
    v_cvt_pk_bf16_f32 v73, v50, v51
    v_mfma_f32_32x32x16_bf16 v[80:95], v[136:139], v[64:67], v[80:95]
    v_exp_f32 v56, v56
    v_exp_f32 v57, v57
    v_exp_f32 v58, v58
    v_exp_f32 v59, v59
    v_cvt_pk_bf16_f32 v74, v52, v53
    v_cvt_pk_bf16_f32 v75, v54, v55
    v_mfma_f32_32x32x16_bf16 v[80:95], v[140:143], v[68:71], v[80:95]
    v_exp_f32 v60, v60
    v_exp_f32 v61, v61
    v_exp_f32 v62, v62
    v_exp_f32 v63, v63
    v_cvt_pk_bf16_f32 v76, v56, v57
    v_cvt_pk_bf16_f32 v77, v58, v59
    v_cvt_pk_bf16_f32 v78, v60, v61
    v_cvt_pk_bf16_f32 v79, v62, v63
    v_mfma_f32_32x32x16_bf16 v[48:63], v[112:115], v[24:27], 0
    v_exp_f32 v32, v32
    v_exp_f32 v33, v33
    v_exp_f32 v34, v34
    v_exp_f32 v35, v35
    v_mfma_f32_32x32x8_bf16 v[48:63], v[116:117], v[28:29], v[48:63]
    v_exp_f32 v36, v36
    v_exp_f32 v37, v37
    v_exp_f32 v38, v38
    v_exp_f32 v39, v39
    v_cvt_pk_bf16_f32 v64, v32, v33
    v_cvt_pk_bf16_f32 v65, v34, v35
    v_mfma_f32_32x32x16_bf16 v[96:111], v[136:139], v[72:75], v[96:111]
    v_exp_f32 v40, v40
    v_exp_f32 v41, v41
    v_exp_f32 v42, v42
    v_exp_f32 v43, v43
    v_cvt_pk_bf16_f32 v66, v36, v37
    v_cvt_pk_bf16_f32 v67, v38, v39
    v_mfma_f32_32x32x16_bf16 v[96:111], v[140:143], v[76:79], v[96:111]
    v_exp_f32 v44, v44
    v_exp_f32 v45, v45
    v_exp_f32 v46, v46
    v_exp_f32 v47, v47
    v_cvt_pk_bf16_f32 v68, v40, v41
    v_cvt_pk_bf16_f32 v69, v42, v43
    v_cvt_pk_bf16_f32 v70, v44, v45
    v_cvt_pk_bf16_f32 v71, v46, v47
    s_waitcnt lgkmcnt(0)
    ds_read_b128 v[112:115], v8 offset:46080
    s_mov_b64 exec, s[50:51]
    ds_read_b64 v[116:117], v9 offset:48384
    s_mov_b64 exec, s[42:43]
    ds_read_b128 v[136:139], v10 offset:44544
    ds_read_b128 v[140:143], v10 offset:45184
    s_mov_b64 exec, -1
    v_mfma_f32_32x32x16_bf16 v[32:47], v[120:123], v[16:19], 0
    v_exp_f32 v48, v48
    v_exp_f32 v49, v49
    v_exp_f32 v50, v50
    v_exp_f32 v51, v51
    v_mfma_f32_32x32x8_bf16 v[32:47], v[124:125], v[20:21], v[32:47]
    v_exp_f32 v52, v52
    v_exp_f32 v53, v53
    v_exp_f32 v54, v54
    v_exp_f32 v55, v55
    v_cvt_pk_bf16_f32 v72, v48, v49
    v_cvt_pk_bf16_f32 v73, v50, v51
    v_mfma_f32_32x32x16_bf16 v[80:95], v[128:131], v[64:67], v[80:95]
    v_exp_f32 v56, v56
    v_exp_f32 v57, v57
    v_exp_f32 v58, v58
    v_exp_f32 v59, v59
    v_cvt_pk_bf16_f32 v74, v52, v53
    v_cvt_pk_bf16_f32 v75, v54, v55
    v_mfma_f32_32x32x16_bf16 v[80:95], v[132:135], v[68:71], v[80:95]
    v_exp_f32 v60, v60
    v_exp_f32 v61, v61
    v_exp_f32 v62, v62
    v_exp_f32 v63, v63
    v_cvt_pk_bf16_f32 v76, v56, v57
    v_cvt_pk_bf16_f32 v77, v58, v59
    v_cvt_pk_bf16_f32 v78, v60, v61
    v_cvt_pk_bf16_f32 v79, v62, v63
    v_mfma_f32_32x32x16_bf16 v[48:63], v[120:123], v[24:27], 0
    v_exp_f32 v32, v32
    v_exp_f32 v33, v33
    v_exp_f32 v34, v34
    v_exp_f32 v35, v35
    v_mfma_f32_32x32x8_bf16 v[48:63], v[124:125], v[28:29], v[48:63]
    v_exp_f32 v36, v36
    v_exp_f32 v37, v37
    v_exp_f32 v38, v38
    v_exp_f32 v39, v39
    v_cvt_pk_bf16_f32 v64, v32, v33
    v_cvt_pk_bf16_f32 v65, v34, v35
    v_mfma_f32_32x32x16_bf16 v[96:111], v[128:131], v[72:75], v[96:111]
    v_exp_f32 v40, v40
    v_exp_f32 v41, v41
    v_exp_f32 v42, v42
    v_exp_f32 v43, v43
    v_cvt_pk_bf16_f32 v66, v36, v37
    v_cvt_pk_bf16_f32 v67, v38, v39
    v_mfma_f32_32x32x16_bf16 v[96:111], v[132:135], v[76:79], v[96:111]
    v_exp_f32 v44, v44
    v_exp_f32 v45, v45
    v_exp_f32 v46, v46
    v_exp_f32 v47, v47
    v_cvt_pk_bf16_f32 v68, v40, v41
    v_cvt_pk_bf16_f32 v69, v42, v43
    v_cvt_pk_bf16_f32 v70, v44, v45
    v_cvt_pk_bf16_f32 v71, v46, v47
    s_waitcnt lgkmcnt(0)
    ds_read_b128 v[120:123], v8 offset:48640
    s_mov_b64 exec, s[50:51]
    ds_read_b64 v[124:125], v9 offset:50944
    s_mov_b64 exec, s[42:43]
    ds_read_b128 v[128:131], v10 offset:47104
    ds_read_b128 v[132:135], v10 offset:47744
    s_mov_b64 exec, -1
    v_mfma_f32_32x32x16_bf16 v[32:47], v[112:115], v[16:19], 0
    v_exp_f32 v48, v48
    v_exp_f32 v49, v49
    v_exp_f32 v50, v50
    v_exp_f32 v51, v51
    v_mfma_f32_32x32x8_bf16 v[32:47], v[116:117], v[20:21], v[32:47]
    v_exp_f32 v52, v52
    v_exp_f32 v53, v53
    v_exp_f32 v54, v54
    v_exp_f32 v55, v55
    v_cvt_pk_bf16_f32 v72, v48, v49
    v_cvt_pk_bf16_f32 v73, v50, v51
    v_mfma_f32_32x32x16_bf16 v[80:95], v[136:139], v[64:67], v[80:95]
    v_exp_f32 v56, v56
    v_exp_f32 v57, v57
    v_exp_f32 v58, v58
    v_exp_f32 v59, v59
    v_cvt_pk_bf16_f32 v74, v52, v53
    v_cvt_pk_bf16_f32 v75, v54, v55
    v_mfma_f32_32x32x16_bf16 v[80:95], v[140:143], v[68:71], v[80:95]
    v_exp_f32 v60, v60
    v_exp_f32 v61, v61
    v_exp_f32 v62, v62
    v_exp_f32 v63, v63
    v_cvt_pk_bf16_f32 v76, v56, v57
    v_cvt_pk_bf16_f32 v77, v58, v59
    v_cvt_pk_bf16_f32 v78, v60, v61
    v_cvt_pk_bf16_f32 v79, v62, v63
    v_mfma_f32_32x32x16_bf16 v[48:63], v[112:115], v[24:27], 0
    v_exp_f32 v32, v32
    v_exp_f32 v33, v33
    v_exp_f32 v34, v34
    v_exp_f32 v35, v35
    v_mfma_f32_32x32x8_bf16 v[48:63], v[116:117], v[28:29], v[48:63]
    v_exp_f32 v36, v36
    v_exp_f32 v37, v37
    v_exp_f32 v38, v38
    v_exp_f32 v39, v39
    v_cvt_pk_bf16_f32 v64, v32, v33
    v_cvt_pk_bf16_f32 v65, v34, v35
    v_mfma_f32_32x32x16_bf16 v[96:111], v[136:139], v[72:75], v[96:111]
    v_exp_f32 v40, v40
    v_exp_f32 v41, v41
    v_exp_f32 v42, v42
    v_exp_f32 v43, v43
    v_cvt_pk_bf16_f32 v66, v36, v37
    v_cvt_pk_bf16_f32 v67, v38, v39
    v_mfma_f32_32x32x16_bf16 v[96:111], v[140:143], v[76:79], v[96:111]
    v_exp_f32 v44, v44
    v_exp_f32 v45, v45
    v_exp_f32 v46, v46
    v_exp_f32 v47, v47
    v_cvt_pk_bf16_f32 v68, v40, v41
    v_cvt_pk_bf16_f32 v69, v42, v43
    v_cvt_pk_bf16_f32 v70, v44, v45
    v_cvt_pk_bf16_f32 v71, v46, v47
    s_waitcnt lgkmcnt(0)
    ds_read_b128 v[112:115], v8 offset:51200
    s_mov_b64 exec, s[50:51]
    ds_read_b64 v[116:117], v9 offset:53504
    s_mov_b64 exec, s[42:43]
    ds_read_b128 v[136:139], v10 offset:49664
    ds_read_b128 v[140:143], v10 offset:50304
    s_mov_b64 exec, -1
    v_mfma_f32_32x32x16_bf16 v[32:47], v[120:123], v[16:19], 0
    v_exp_f32 v48, v48
    v_exp_f32 v49, v49
    v_exp_f32 v50, v50
    v_exp_f32 v51, v51
    v_mfma_f32_32x32x8_bf16 v[32:47], v[124:125], v[20:21], v[32:47]
    v_exp_f32 v52, v52
    v_exp_f32 v53, v53
    v_exp_f32 v54, v54
    v_exp_f32 v55, v55
    v_cvt_pk_bf16_f32 v72, v48, v49
    v_cvt_pk_bf16_f32 v73, v50, v51
    v_mfma_f32_32x32x16_bf16 v[80:95], v[128:131], v[64:67], v[80:95]
    v_exp_f32 v56, v56
    v_exp_f32 v57, v57
    v_exp_f32 v58, v58
    v_exp_f32 v59, v59
    v_cvt_pk_bf16_f32 v74, v52, v53
    v_cvt_pk_bf16_f32 v75, v54, v55
    v_mfma_f32_32x32x16_bf16 v[80:95], v[132:135], v[68:71], v[80:95]
    v_exp_f32 v60, v60
    v_exp_f32 v61, v61
    v_exp_f32 v62, v62
    v_exp_f32 v63, v63
    v_cvt_pk_bf16_f32 v76, v56, v57
    v_cvt_pk_bf16_f32 v77, v58, v59
    v_cvt_pk_bf16_f32 v78, v60, v61
    v_cvt_pk_bf16_f32 v79, v62, v63
    v_mfma_f32_32x32x16_bf16 v[48:63], v[120:123], v[24:27], 0
    v_exp_f32 v32, v32
    v_exp_f32 v33, v33
    v_exp_f32 v34, v34
    v_exp_f32 v35, v35
    v_mfma_f32_32x32x8_bf16 v[48:63], v[124:125], v[28:29], v[48:63]
    v_exp_f32 v36, v36
    v_exp_f32 v37, v37
    v_exp_f32 v38, v38
    v_exp_f32 v39, v39
    v_cvt_pk_bf16_f32 v64, v32, v33
    v_cvt_pk_bf16_f32 v65, v34, v35
    v_mfma_f32_32x32x16_bf16 v[96:111], v[128:131], v[72:75], v[96:111]
    v_exp_f32 v40, v40
    v_exp_f32 v41, v41
    v_exp_f32 v42, v42
    v_exp_f32 v43, v43
    v_cvt_pk_bf16_f32 v66, v36, v37
    v_cvt_pk_bf16_f32 v67, v38, v39
    v_mfma_f32_32x32x16_bf16 v[96:111], v[132:135], v[76:79], v[96:111]
    v_exp_f32 v44, v44
    v_exp_f32 v45, v45
    v_exp_f32 v46, v46
    v_exp_f32 v47, v47
    v_cvt_pk_bf16_f32 v68, v40, v41
    v_cvt_pk_bf16_f32 v69, v42, v43
    v_cvt_pk_bf16_f32 v70, v44, v45
    v_cvt_pk_bf16_f32 v71, v46, v47
    s_waitcnt lgkmcnt(0)
    ds_read_b128 v[120:123], v8 offset:53760
    s_mov_b64 exec, s[50:51]
    ds_read_b64 v[124:125], v9 offset:56064
    s_mov_b64 exec, s[42:43]
    ds_read_b128 v[128:131], v10 offset:52224
    ds_read_b128 v[132:135], v10 offset:52864
    s_mov_b64 exec, -1
    v_mfma_f32_32x32x16_bf16 v[32:47], v[112:115], v[16:19], 0
    v_exp_f32 v48, v48
    v_exp_f32 v49, v49
    v_exp_f32 v50, v50
    v_exp_f32 v51, v51
    v_mfma_f32_32x32x8_bf16 v[32:47], v[116:117], v[20:21], v[32:47]
    v_exp_f32 v52, v52
    v_exp_f32 v53, v53
    v_exp_f32 v54, v54
    v_exp_f32 v55, v55
    v_cvt_pk_bf16_f32 v72, v48, v49
    v_cvt_pk_bf16_f32 v73, v50, v51
    v_mfma_f32_32x32x16_bf16 v[80:95], v[136:139], v[64:67], v[80:95]
    v_exp_f32 v56, v56
    v_exp_f32 v57, v57
    v_exp_f32 v58, v58
    v_exp_f32 v59, v59
    v_cvt_pk_bf16_f32 v74, v52, v53
    v_cvt_pk_bf16_f32 v75, v54, v55
    v_mfma_f32_32x32x16_bf16 v[80:95], v[140:143], v[68:71], v[80:95]
    v_exp_f32 v60, v60
    v_exp_f32 v61, v61
    v_exp_f32 v62, v62
    v_exp_f32 v63, v63
    v_cvt_pk_bf16_f32 v76, v56, v57
    v_cvt_pk_bf16_f32 v77, v58, v59
    v_cvt_pk_bf16_f32 v78, v60, v61
    v_cvt_pk_bf16_f32 v79, v62, v63
    v_mfma_f32_32x32x16_bf16 v[48:63], v[112:115], v[24:27], 0
    v_exp_f32 v32, v32
    v_exp_f32 v33, v33
    v_exp_f32 v34, v34
    v_exp_f32 v35, v35
    v_mfma_f32_32x32x8_bf16 v[48:63], v[116:117], v[28:29], v[48:63]
    v_exp_f32 v36, v36
    v_exp_f32 v37, v37
    v_exp_f32 v38, v38
    v_exp_f32 v39, v39
    v_cvt_pk_bf16_f32 v64, v32, v33
    v_cvt_pk_bf16_f32 v65, v34, v35
    v_mfma_f32_32x32x16_bf16 v[96:111], v[136:139], v[72:75], v[96:111]
    v_exp_f32 v40, v40
    v_exp_f32 v41, v41
    v_exp_f32 v42, v42
    v_exp_f32 v43, v43
    v_cvt_pk_bf16_f32 v66, v36, v37
    v_cvt_pk_bf16_f32 v67, v38, v39
    v_mfma_f32_32x32x16_bf16 v[96:111], v[140:143], v[76:79], v[96:111]
    v_exp_f32 v44, v44
    v_exp_f32 v45, v45
    v_exp_f32 v46, v46
    v_exp_f32 v47, v47
    v_cvt_pk_bf16_f32 v68, v40, v41
    v_cvt_pk_bf16_f32 v69, v42, v43
    v_cvt_pk_bf16_f32 v70, v44, v45
    v_cvt_pk_bf16_f32 v71, v46, v47
    s_waitcnt lgkmcnt(0)
    ds_read_b128 v[112:115], v8 offset:56320
    s_mov_b64 exec, s[50:51]
    ds_read_b64 v[116:117], v9 offset:58624
    s_mov_b64 exec, s[42:43]
    ds_read_b128 v[136:139], v10 offset:54784
    ds_read_b128 v[140:143], v10 offset:55424
    s_mov_b64 exec, -1
    v_mfma_f32_32x32x16_bf16 v[32:47], v[120:123], v[16:19], 0
    v_exp_f32 v48, v48
    v_exp_f32 v49, v49
    v_exp_f32 v50, v50
    v_exp_f32 v51, v51
    v_mfma_f32_32x32x8_bf16 v[32:47], v[124:125], v[20:21], v[32:47]
    v_exp_f32 v52, v52
    v_exp_f32 v53, v53
    v_exp_f32 v54, v54
    v_exp_f32 v55, v55
    v_cvt_pk_bf16_f32 v72, v48, v49
    v_cvt_pk_bf16_f32 v73, v50, v51
    v_mfma_f32_32x32x16_bf16 v[80:95], v[128:131], v[64:67], v[80:95]
    v_exp_f32 v56, v56
    v_exp_f32 v57, v57
    v_exp_f32 v58, v58
    v_exp_f32 v59, v59
    v_cvt_pk_bf16_f32 v74, v52, v53
    v_cvt_pk_bf16_f32 v75, v54, v55
    v_mfma_f32_32x32x16_bf16 v[80:95], v[132:135], v[68:71], v[80:95]
    v_exp_f32 v60, v60
    v_exp_f32 v61, v61
    v_exp_f32 v62, v62
    v_exp_f32 v63, v63
    v_cvt_pk_bf16_f32 v76, v56, v57
    v_cvt_pk_bf16_f32 v77, v58, v59
    v_cvt_pk_bf16_f32 v78, v60, v61
    v_cvt_pk_bf16_f32 v79, v62, v63
    v_mfma_f32_32x32x16_bf16 v[48:63], v[120:123], v[24:27], 0
    v_exp_f32 v32, v32
    v_exp_f32 v33, v33
    v_exp_f32 v34, v34
    v_exp_f32 v35, v35
    v_mfma_f32_32x32x8_bf16 v[48:63], v[124:125], v[28:29], v[48:63]
    v_exp_f32 v36, v36
    v_exp_f32 v37, v37
    v_exp_f32 v38, v38
    v_exp_f32 v39, v39
    v_cvt_pk_bf16_f32 v64, v32, v33
    v_cvt_pk_bf16_f32 v65, v34, v35
    v_mfma_f32_32x32x16_bf16 v[96:111], v[128:131], v[72:75], v[96:111]
    v_exp_f32 v40, v40
    v_exp_f32 v41, v41
    v_exp_f32 v42, v42
    v_exp_f32 v43, v43
    v_cvt_pk_bf16_f32 v66, v36, v37
    v_cvt_pk_bf16_f32 v67, v38, v39
    v_mfma_f32_32x32x16_bf16 v[96:111], v[132:135], v[76:79], v[96:111]
    v_exp_f32 v44, v44
    v_exp_f32 v45, v45
    v_exp_f32 v46, v46
    v_exp_f32 v47, v47
    v_cvt_pk_bf16_f32 v68, v40, v41
    v_cvt_pk_bf16_f32 v69, v42, v43
    v_cvt_pk_bf16_f32 v70, v44, v45
    v_cvt_pk_bf16_f32 v71, v46, v47
    s_waitcnt lgkmcnt(0)
    ds_read_b128 v[120:123], v8 offset:58880
    s_mov_b64 exec, s[50:51]
    ds_read_b64 v[124:125], v9 offset:61184
    s_mov_b64 exec, s[42:43]
    ds_read_b128 v[128:131], v10 offset:57344
    ds_read_b128 v[132:135], v10 offset:57984
    s_mov_b64 exec, -1
    v_mfma_f32_32x32x16_bf16 v[32:47], v[112:115], v[16:19], 0
    v_exp_f32 v48, v48
    v_exp_f32 v49, v49
    v_exp_f32 v50, v50
    v_exp_f32 v51, v51
    v_mfma_f32_32x32x8_bf16 v[32:47], v[116:117], v[20:21], v[32:47]
    v_exp_f32 v52, v52
    v_exp_f32 v53, v53
    v_exp_f32 v54, v54
    v_exp_f32 v55, v55
    v_cvt_pk_bf16_f32 v72, v48, v49
    v_cvt_pk_bf16_f32 v73, v50, v51
    v_mfma_f32_32x32x16_bf16 v[80:95], v[136:139], v[64:67], v[80:95]
    v_exp_f32 v56, v56
    v_exp_f32 v57, v57
    v_exp_f32 v58, v58
    v_exp_f32 v59, v59
    v_cvt_pk_bf16_f32 v74, v52, v53
    v_cvt_pk_bf16_f32 v75, v54, v55
    v_mfma_f32_32x32x16_bf16 v[80:95], v[140:143], v[68:71], v[80:95]
    v_exp_f32 v60, v60
    v_exp_f32 v61, v61
    v_exp_f32 v62, v62
    v_exp_f32 v63, v63
    v_cvt_pk_bf16_f32 v76, v56, v57
    v_cvt_pk_bf16_f32 v77, v58, v59
    v_cvt_pk_bf16_f32 v78, v60, v61
    v_cvt_pk_bf16_f32 v79, v62, v63
    v_mfma_f32_32x32x16_bf16 v[48:63], v[112:115], v[24:27], 0
    v_exp_f32 v32, v32
    v_exp_f32 v33, v33
    v_exp_f32 v34, v34
    v_exp_f32 v35, v35
    v_mfma_f32_32x32x8_bf16 v[48:63], v[116:117], v[28:29], v[48:63]
    v_exp_f32 v36, v36
    v_exp_f32 v37, v37
    v_exp_f32 v38, v38
    v_exp_f32 v39, v39
    v_cvt_pk_bf16_f32 v64, v32, v33
    v_cvt_pk_bf16_f32 v65, v34, v35
    v_mfma_f32_32x32x16_bf16 v[96:111], v[136:139], v[72:75], v[96:111]
    v_exp_f32 v40, v40
    v_exp_f32 v41, v41
    v_exp_f32 v42, v42
    v_exp_f32 v43, v43
    v_cvt_pk_bf16_f32 v66, v36, v37
    v_cvt_pk_bf16_f32 v67, v38, v39
    v_mfma_f32_32x32x16_bf16 v[96:111], v[140:143], v[76:79], v[96:111]
    v_exp_f32 v44, v44
    v_exp_f32 v45, v45
    v_exp_f32 v46, v46
    v_exp_f32 v47, v47
    v_cvt_pk_bf16_f32 v68, v40, v41
    v_cvt_pk_bf16_f32 v69, v42, v43
    v_cvt_pk_bf16_f32 v70, v44, v45
    v_cvt_pk_bf16_f32 v71, v46, v47
    s_waitcnt lgkmcnt(0)
    v_add_u32 v8, 61440, v8
    v_add_u32 v9, 61440, v9
    ds_read_b128 v[112:115], v8 offset:0
    s_mov_b64 exec, s[50:51]
    ds_read_b64 v[116:117], v9 offset:2304
    s_mov_b64 exec, s[42:43]
    ds_read_b128 v[136:139], v10 offset:59904
    ds_read_b128 v[140:143], v10 offset:60544
    s_mov_b64 exec, -1
    v_mfma_f32_32x32x16_bf16 v[32:47], v[120:123], v[16:19], 0
    v_exp_f32 v48, v48
    v_exp_f32 v49, v49
    v_exp_f32 v50, v50
    v_exp_f32 v51, v51
    v_mfma_f32_32x32x8_bf16 v[32:47], v[124:125], v[20:21], v[32:47]
    v_exp_f32 v52, v52
    v_exp_f32 v53, v53
    v_exp_f32 v54, v54
    v_exp_f32 v55, v55
    v_cvt_pk_bf16_f32 v72, v48, v49
    v_cvt_pk_bf16_f32 v73, v50, v51
    v_mfma_f32_32x32x16_bf16 v[80:95], v[128:131], v[64:67], v[80:95]
    v_exp_f32 v56, v56
    v_exp_f32 v57, v57
    v_exp_f32 v58, v58
    v_exp_f32 v59, v59
    v_cvt_pk_bf16_f32 v74, v52, v53
    v_cvt_pk_bf16_f32 v75, v54, v55
    v_mfma_f32_32x32x16_bf16 v[80:95], v[132:135], v[68:71], v[80:95]
    v_exp_f32 v60, v60
    v_exp_f32 v61, v61
    v_exp_f32 v62, v62
    v_exp_f32 v63, v63
    v_cvt_pk_bf16_f32 v76, v56, v57
    v_cvt_pk_bf16_f32 v77, v58, v59
    v_cvt_pk_bf16_f32 v78, v60, v61
    v_cvt_pk_bf16_f32 v79, v62, v63
    v_mfma_f32_32x32x16_bf16 v[48:63], v[120:123], v[24:27], 0
    v_exp_f32 v32, v32
    v_exp_f32 v33, v33
    v_exp_f32 v34, v34
    v_exp_f32 v35, v35
    v_mfma_f32_32x32x8_bf16 v[48:63], v[124:125], v[28:29], v[48:63]
    v_exp_f32 v36, v36
    v_exp_f32 v37, v37
    v_exp_f32 v38, v38
    v_exp_f32 v39, v39
    v_cvt_pk_bf16_f32 v64, v32, v33
    v_cvt_pk_bf16_f32 v65, v34, v35
    v_mfma_f32_32x32x16_bf16 v[96:111], v[128:131], v[72:75], v[96:111]
    v_exp_f32 v40, v40
    v_exp_f32 v41, v41
    v_exp_f32 v42, v42
    v_exp_f32 v43, v43
    v_cvt_pk_bf16_f32 v66, v36, v37
    v_cvt_pk_bf16_f32 v67, v38, v39
    v_mfma_f32_32x32x16_bf16 v[96:111], v[132:135], v[76:79], v[96:111]
    v_exp_f32 v44, v44
    v_exp_f32 v45, v45
    v_exp_f32 v46, v46
    v_exp_f32 v47, v47
    v_cvt_pk_bf16_f32 v68, v40, v41
    v_cvt_pk_bf16_f32 v69, v42, v43
    v_cvt_pk_bf16_f32 v70, v44, v45
    v_cvt_pk_bf16_f32 v71, v46, v47
    s_waitcnt lgkmcnt(0)
    ds_read_b128 v[120:123], v8 offset:2560
    s_mov_b64 exec, s[50:51]
    ds_read_b64 v[124:125], v9 offset:4864
    s_mov_b64 exec, -1
    v_add_u32 v10, 61440, v10
    s_mov_b64 exec, s[42:43]
    ds_read_b128 v[128:131], v10 offset:1024
    ds_read_b128 v[132:135], v10 offset:1664
    s_mov_b64 exec, -1
    v_mfma_f32_32x32x16_bf16 v[32:47], v[112:115], v[16:19], 0
    v_exp_f32 v48, v48
    v_exp_f32 v49, v49
    v_exp_f32 v50, v50
    v_exp_f32 v51, v51
    v_mfma_f32_32x32x8_bf16 v[32:47], v[116:117], v[20:21], v[32:47]
    v_exp_f32 v52, v52
    v_exp_f32 v53, v53
    v_exp_f32 v54, v54
    v_exp_f32 v55, v55
    v_cvt_pk_bf16_f32 v72, v48, v49
    v_cvt_pk_bf16_f32 v73, v50, v51
    v_mfma_f32_32x32x16_bf16 v[80:95], v[136:139], v[64:67], v[80:95]
    v_exp_f32 v56, v56
    v_exp_f32 v57, v57
    v_exp_f32 v58, v58
    v_exp_f32 v59, v59
    v_cvt_pk_bf16_f32 v74, v52, v53
    v_cvt_pk_bf16_f32 v75, v54, v55
    v_mfma_f32_32x32x16_bf16 v[80:95], v[140:143], v[68:71], v[80:95]
    v_exp_f32 v60, v60
    v_exp_f32 v61, v61
    v_exp_f32 v62, v62
    v_exp_f32 v63, v63
    v_cvt_pk_bf16_f32 v76, v56, v57
    v_cvt_pk_bf16_f32 v77, v58, v59
    v_cvt_pk_bf16_f32 v78, v60, v61
    v_cvt_pk_bf16_f32 v79, v62, v63
    v_mfma_f32_32x32x16_bf16 v[48:63], v[112:115], v[24:27], 0
    v_exp_f32 v32, v32
    v_exp_f32 v33, v33
    v_exp_f32 v34, v34
    v_exp_f32 v35, v35
    v_mfma_f32_32x32x8_bf16 v[48:63], v[116:117], v[28:29], v[48:63]
    v_exp_f32 v36, v36
    v_exp_f32 v37, v37
    v_exp_f32 v38, v38
    v_exp_f32 v39, v39
    v_cvt_pk_bf16_f32 v64, v32, v33
    v_cvt_pk_bf16_f32 v65, v34, v35
    v_mfma_f32_32x32x16_bf16 v[96:111], v[136:139], v[72:75], v[96:111]
    v_exp_f32 v40, v40
    v_exp_f32 v41, v41
    v_exp_f32 v42, v42
    v_exp_f32 v43, v43
    v_cvt_pk_bf16_f32 v66, v36, v37
    v_cvt_pk_bf16_f32 v67, v38, v39
    v_mfma_f32_32x32x16_bf16 v[96:111], v[140:143], v[76:79], v[96:111]
    v_exp_f32 v44, v44
    v_exp_f32 v45, v45
    v_exp_f32 v46, v46
    v_exp_f32 v47, v47
    v_cvt_pk_bf16_f32 v68, v40, v41
    v_cvt_pk_bf16_f32 v69, v42, v43
    v_cvt_pk_bf16_f32 v70, v44, v45
    v_cvt_pk_bf16_f32 v71, v46, v47
    s_waitcnt lgkmcnt(0)
    ds_read_b128 v[112:115], v8 offset:5120
    s_mov_b64 exec, s[50:51]
    ds_read_b64 v[116:117], v9 offset:7424
    s_mov_b64 exec, s[42:43]
    ds_read_b128 v[136:139], v10 offset:3584
    ds_read_b128 v[140:143], v10 offset:4224
    s_mov_b64 exec, -1
    v_mfma_f32_32x32x16_bf16 v[32:47], v[120:123], v[16:19], 0
    v_exp_f32 v48, v48
    v_exp_f32 v49, v49
    v_exp_f32 v50, v50
    v_exp_f32 v51, v51
    v_mfma_f32_32x32x8_bf16 v[32:47], v[124:125], v[20:21], v[32:47]
    v_exp_f32 v52, v52
    v_exp_f32 v53, v53
    v_exp_f32 v54, v54
    v_exp_f32 v55, v55
    v_cvt_pk_bf16_f32 v72, v48, v49
    v_cvt_pk_bf16_f32 v73, v50, v51
    v_mfma_f32_32x32x16_bf16 v[80:95], v[128:131], v[64:67], v[80:95]
    v_exp_f32 v56, v56
    v_exp_f32 v57, v57
    v_exp_f32 v58, v58
    v_exp_f32 v59, v59
    v_cvt_pk_bf16_f32 v74, v52, v53
    v_cvt_pk_bf16_f32 v75, v54, v55
    v_mfma_f32_32x32x16_bf16 v[80:95], v[132:135], v[68:71], v[80:95]
    v_exp_f32 v60, v60
    v_exp_f32 v61, v61
    v_exp_f32 v62, v62
    v_exp_f32 v63, v63
    v_cvt_pk_bf16_f32 v76, v56, v57
    v_cvt_pk_bf16_f32 v77, v58, v59
    v_cvt_pk_bf16_f32 v78, v60, v61
    v_cvt_pk_bf16_f32 v79, v62, v63
    s_setprio 2
    v_mfma_f32_32x32x16_bf16 v[48:63], v[120:123], v[24:27], 0
    v_exp_f32 v32, v32
    v_exp_f32 v33, v33
    v_exp_f32 v34, v34
    v_exp_f32 v35, v35
    v_mfma_f32_32x32x8_bf16 v[48:63], v[124:125], v[28:29], v[48:63]
    v_exp_f32 v36, v36
    v_exp_f32 v37, v37
    v_exp_f32 v38, v38
    v_exp_f32 v39, v39
    v_cvt_pk_bf16_f32 v64, v32, v33
    v_cvt_pk_bf16_f32 v65, v34, v35
    v_mfma_f32_32x32x16_bf16 v[96:111], v[128:131], v[72:75], v[96:111]
    v_exp_f32 v40, v40
    v_exp_f32 v41, v41
    v_exp_f32 v42, v42
    v_exp_f32 v43, v43
    v_cvt_pk_bf16_f32 v66, v36, v37
    v_cvt_pk_bf16_f32 v67, v38, v39
    v_mfma_f32_32x32x16_bf16 v[96:111], v[132:135], v[76:79], v[96:111]
    v_exp_f32 v44, v44
    v_exp_f32 v45, v45
    v_exp_f32 v46, v46
    v_exp_f32 v47, v47
    v_cvt_pk_bf16_f32 v68, v40, v41
    v_cvt_pk_bf16_f32 v69, v42, v43
    v_cvt_pk_bf16_f32 v70, v44, v45
    v_cvt_pk_bf16_f32 v71, v46, v47
    s_waitcnt lgkmcnt(0)
    ds_read_b128 v[120:123], v8 offset:7680
    s_mov_b64 exec, s[50:51]
    ds_read_b64 v[124:125], v9 offset:9984
    s_mov_b64 exec, s[42:43]
    ds_read_b128 v[128:131], v10 offset:6144
    ds_read_b128 v[132:135], v10 offset:6784
    s_mov_b64 exec, -1
    v_mfma_f32_32x32x16_bf16 v[32:47], v[112:115], v[16:19], 0
    v_exp_f32 v48, v48
    v_exp_f32 v49, v49
    v_exp_f32 v50, v50
    v_exp_f32 v51, v51
    v_mfma_f32_32x32x8_bf16 v[32:47], v[116:117], v[20:21], v[32:47]
    v_exp_f32 v52, v52
    v_exp_f32 v53, v53
    v_exp_f32 v54, v54
    v_exp_f32 v55, v55
    v_cvt_pk_bf16_f32 v72, v48, v49
    v_cvt_pk_bf16_f32 v73, v50, v51
    v_mfma_f32_32x32x16_bf16 v[80:95], v[136:139], v[64:67], v[80:95]
    v_exp_f32 v56, v56
    v_exp_f32 v57, v57
    v_exp_f32 v58, v58
    v_exp_f32 v59, v59
    v_cvt_pk_bf16_f32 v74, v52, v53
    v_cvt_pk_bf16_f32 v75, v54, v55
    v_mfma_f32_32x32x16_bf16 v[80:95], v[140:143], v[68:71], v[80:95]
    v_exp_f32 v60, v60
    v_exp_f32 v61, v61
    v_exp_f32 v62, v62
    v_exp_f32 v63, v63
    v_cvt_pk_bf16_f32 v76, v56, v57
    v_cvt_pk_bf16_f32 v77, v58, v59
    v_cvt_pk_bf16_f32 v78, v60, v61
    v_cvt_pk_bf16_f32 v79, v62, v63
    v_mfma_f32_32x32x16_bf16 v[48:63], v[112:115], v[24:27], 0
    v_exp_f32 v32, v32
    v_exp_f32 v33, v33
    v_exp_f32 v34, v34
    v_exp_f32 v35, v35
    v_mfma_f32_32x32x8_bf16 v[48:63], v[116:117], v[28:29], v[48:63]
    v_exp_f32 v36, v36
    v_exp_f32 v37, v37
    v_exp_f32 v38, v38
    v_exp_f32 v39, v39
    v_cvt_pk_bf16_f32 v64, v32, v33
    v_cvt_pk_bf16_f32 v65, v34, v35
    v_mfma_f32_32x32x16_bf16 v[96:111], v[136:139], v[72:75], v[96:111]
    v_exp_f32 v40, v40
    v_exp_f32 v41, v41
    v_exp_f32 v42, v42
    v_exp_f32 v43, v43
    v_cvt_pk_bf16_f32 v66, v36, v37
    v_cvt_pk_bf16_f32 v67, v38, v39
    v_mfma_f32_32x32x16_bf16 v[96:111], v[140:143], v[76:79], v[96:111]
    v_exp_f32 v44, v44
    v_exp_f32 v45, v45
    v_exp_f32 v46, v46
    v_exp_f32 v47, v47
    v_cvt_pk_bf16_f32 v68, v40, v41
    v_cvt_pk_bf16_f32 v69, v42, v43
    v_cvt_pk_bf16_f32 v70, v44, v45
    v_cvt_pk_bf16_f32 v71, v46, v47
    s_waitcnt lgkmcnt(0)
    ds_read_b128 v[112:115], v8 offset:10240
    s_mov_b64 exec, s[50:51]
    ds_read_b64 v[116:117], v9 offset:12544
    s_mov_b64 exec, s[42:43]
    ds_read_b128 v[136:139], v10 offset:8704
    ds_read_b128 v[140:143], v10 offset:9344
    s_mov_b64 exec, -1
    v_mfma_f32_32x32x16_bf16 v[32:47], v[120:123], v[16:19], 0
    v_exp_f32 v48, v48
    v_exp_f32 v49, v49
    v_exp_f32 v50, v50
    v_exp_f32 v51, v51
    v_mfma_f32_32x32x8_bf16 v[32:47], v[124:125], v[20:21], v[32:47]
    v_exp_f32 v52, v52
    v_exp_f32 v53, v53
    v_exp_f32 v54, v54
    v_exp_f32 v55, v55
    v_cvt_pk_bf16_f32 v72, v48, v49
    v_cvt_pk_bf16_f32 v73, v50, v51
    v_mfma_f32_32x32x16_bf16 v[80:95], v[128:131], v[64:67], v[80:95]
    v_exp_f32 v56, v56
    v_exp_f32 v57, v57
    v_exp_f32 v58, v58
    v_exp_f32 v59, v59
    v_cvt_pk_bf16_f32 v74, v52, v53
    v_cvt_pk_bf16_f32 v75, v54, v55
    v_mfma_f32_32x32x16_bf16 v[80:95], v[132:135], v[68:71], v[80:95]
    v_exp_f32 v60, v60
    v_exp_f32 v61, v61
    v_exp_f32 v62, v62
    v_exp_f32 v63, v63
    v_cvt_pk_bf16_f32 v76, v56, v57
    v_cvt_pk_bf16_f32 v77, v58, v59
    v_cvt_pk_bf16_f32 v78, v60, v61
    v_cvt_pk_bf16_f32 v79, v62, v63
    v_mfma_f32_32x32x16_bf16 v[48:63], v[120:123], v[24:27], 0
    v_exp_f32 v32, v32
    v_exp_f32 v33, v33
    v_exp_f32 v34, v34
    v_exp_f32 v35, v35
    v_mfma_f32_32x32x8_bf16 v[48:63], v[124:125], v[28:29], v[48:63]
    v_exp_f32 v36, v36
    v_exp_f32 v37, v37
    v_exp_f32 v38, v38
    v_exp_f32 v39, v39
    v_cvt_pk_bf16_f32 v64, v32, v33
    v_cvt_pk_bf16_f32 v65, v34, v35
    v_mfma_f32_32x32x16_bf16 v[96:111], v[128:131], v[72:75], v[96:111]
    v_exp_f32 v40, v40
    v_exp_f32 v41, v41
    v_exp_f32 v42, v42
    v_exp_f32 v43, v43
    v_cvt_pk_bf16_f32 v66, v36, v37
    v_cvt_pk_bf16_f32 v67, v38, v39
    v_mfma_f32_32x32x16_bf16 v[96:111], v[132:135], v[76:79], v[96:111]
    v_exp_f32 v44, v44
    v_exp_f32 v45, v45
    v_exp_f32 v46, v46
    v_exp_f32 v47, v47
    v_cvt_pk_bf16_f32 v68, v40, v41
    v_cvt_pk_bf16_f32 v69, v42, v43
    v_cvt_pk_bf16_f32 v70, v44, v45
    v_cvt_pk_bf16_f32 v71, v46, v47
    s_waitcnt lgkmcnt(0)
    ds_read_b128 v[120:123], v8 offset:12800
    s_mov_b64 exec, s[50:51]
    ds_read_b64 v[124:125], v9 offset:15104
    s_mov_b64 exec, s[42:43]
    ds_read_b128 v[128:131], v10 offset:11264
    ds_read_b128 v[132:135], v10 offset:11904
    s_mov_b64 exec, -1
    v_mfma_f32_32x32x16_bf16 v[32:47], v[112:115], v[16:19], 0
    v_exp_f32 v48, v48
    v_exp_f32 v49, v49
    v_exp_f32 v50, v50
    v_exp_f32 v51, v51
    v_mfma_f32_32x32x8_bf16 v[32:47], v[116:117], v[20:21], v[32:47]
    v_exp_f32 v52, v52
    v_exp_f32 v53, v53
    v_exp_f32 v54, v54
    v_exp_f32 v55, v55
    v_cvt_pk_bf16_f32 v72, v48, v49
    v_cvt_pk_bf16_f32 v73, v50, v51
    v_mfma_f32_32x32x16_bf16 v[80:95], v[136:139], v[64:67], v[80:95]
    v_exp_f32 v56, v56
    v_exp_f32 v57, v57
    v_exp_f32 v58, v58
    v_exp_f32 v59, v59
    v_cvt_pk_bf16_f32 v74, v52, v53
    v_cvt_pk_bf16_f32 v75, v54, v55
    v_mfma_f32_32x32x16_bf16 v[80:95], v[140:143], v[68:71], v[80:95]
    v_exp_f32 v60, v60
    v_exp_f32 v61, v61
    v_exp_f32 v62, v62
    v_exp_f32 v63, v63
    v_cvt_pk_bf16_f32 v76, v56, v57
    v_cvt_pk_bf16_f32 v77, v58, v59
    v_cvt_pk_bf16_f32 v78, v60, v61
    v_cvt_pk_bf16_f32 v79, v62, v63
    v_mfma_f32_32x32x16_bf16 v[48:63], v[112:115], v[24:27], 0
    v_exp_f32 v32, v32
    v_exp_f32 v33, v33
    v_exp_f32 v34, v34
    v_exp_f32 v35, v35
    v_mfma_f32_32x32x8_bf16 v[48:63], v[116:117], v[28:29], v[48:63]
    v_exp_f32 v36, v36
    v_exp_f32 v37, v37
    v_exp_f32 v38, v38
    v_exp_f32 v39, v39
    v_cvt_pk_bf16_f32 v64, v32, v33
    v_cvt_pk_bf16_f32 v65, v34, v35
    v_mfma_f32_32x32x16_bf16 v[96:111], v[136:139], v[72:75], v[96:111]
    v_exp_f32 v40, v40
    v_exp_f32 v41, v41
    v_exp_f32 v42, v42
    v_exp_f32 v43, v43
    v_cvt_pk_bf16_f32 v66, v36, v37
    v_cvt_pk_bf16_f32 v67, v38, v39
    v_mfma_f32_32x32x16_bf16 v[96:111], v[140:143], v[76:79], v[96:111]
    v_exp_f32 v44, v44
    v_exp_f32 v45, v45
    v_exp_f32 v46, v46
    v_exp_f32 v47, v47
    v_cvt_pk_bf16_f32 v68, v40, v41
    v_cvt_pk_bf16_f32 v69, v42, v43
    v_cvt_pk_bf16_f32 v70, v44, v45
    v_cvt_pk_bf16_f32 v71, v46, v47
    s_waitcnt lgkmcnt(0)
    ds_read_b128 v[112:115], v8 offset:15360
    s_mov_b64 exec, s[50:51]
    ds_read_b64 v[116:117], v9 offset:17664
    s_mov_b64 exec, s[42:43]
    ds_read_b128 v[136:139], v10 offset:13824
    ds_read_b128 v[140:143], v10 offset:14464
    s_mov_b64 exec, -1
    v_mfma_f32_32x32x16_bf16 v[32:47], v[120:123], v[16:19], 0
    v_exp_f32 v48, v48
    v_exp_f32 v49, v49
    v_exp_f32 v50, v50
    v_exp_f32 v51, v51
    v_mfma_f32_32x32x8_bf16 v[32:47], v[124:125], v[20:21], v[32:47]
    v_exp_f32 v52, v52
    v_exp_f32 v53, v53
    v_exp_f32 v54, v54
    v_exp_f32 v55, v55
    v_cvt_pk_bf16_f32 v72, v48, v49
    v_cvt_pk_bf16_f32 v73, v50, v51
    v_mfma_f32_32x32x16_bf16 v[80:95], v[128:131], v[64:67], v[80:95]
    v_exp_f32 v56, v56
    v_exp_f32 v57, v57
    v_exp_f32 v58, v58
    v_exp_f32 v59, v59
    v_cvt_pk_bf16_f32 v74, v52, v53
    v_cvt_pk_bf16_f32 v75, v54, v55
    v_mfma_f32_32x32x16_bf16 v[80:95], v[132:135], v[68:71], v[80:95]
    v_exp_f32 v60, v60
    v_exp_f32 v61, v61
    v_exp_f32 v62, v62
    v_exp_f32 v63, v63
    v_cvt_pk_bf16_f32 v76, v56, v57
    v_cvt_pk_bf16_f32 v77, v58, v59
    v_cvt_pk_bf16_f32 v78, v60, v61
    v_cvt_pk_bf16_f32 v79, v62, v63
    s_setprio 1
    v_mfma_f32_32x32x16_bf16 v[48:63], v[120:123], v[24:27], 0
    v_exp_f32 v32, v32
    v_exp_f32 v33, v33
    v_exp_f32 v34, v34
    v_exp_f32 v35, v35
    v_mfma_f32_32x32x8_bf16 v[48:63], v[124:125], v[28:29], v[48:63]
    v_exp_f32 v36, v36
    v_exp_f32 v37, v37
    v_exp_f32 v38, v38
    v_exp_f32 v39, v39
    v_cvt_pk_bf16_f32 v64, v32, v33
    v_cvt_pk_bf16_f32 v65, v34, v35
    v_mfma_f32_32x32x16_bf16 v[96:111], v[128:131], v[72:75], v[96:111]
    v_exp_f32 v40, v40
    v_exp_f32 v41, v41
    v_exp_f32 v42, v42
    v_exp_f32 v43, v43
    v_cvt_pk_bf16_f32 v66, v36, v37
    v_cvt_pk_bf16_f32 v67, v38, v39
    v_mfma_f32_32x32x16_bf16 v[96:111], v[132:135], v[76:79], v[96:111]
    v_exp_f32 v44, v44
    v_exp_f32 v45, v45
    v_exp_f32 v46, v46
    v_exp_f32 v47, v47
    v_cvt_pk_bf16_f32 v68, v40, v41
    v_cvt_pk_bf16_f32 v69, v42, v43
    v_cvt_pk_bf16_f32 v70, v44, v45
    v_cvt_pk_bf16_f32 v71, v46, v47
    s_waitcnt lgkmcnt(0)
    ds_read_b128 v[120:123], v8 offset:17920
    s_mov_b64 exec, s[50:51]
    ds_read_b64 v[124:125], v9 offset:20224
    s_mov_b64 exec, s[42:43]
    ds_read_b128 v[128:131], v10 offset:16384
    ds_read_b128 v[132:135], v10 offset:17024
    s_mov_b64 exec, -1
    v_mfma_f32_32x32x16_bf16 v[32:47], v[112:115], v[16:19], 0
    v_exp_f32 v48, v48
    v_exp_f32 v49, v49
    v_exp_f32 v50, v50
    v_exp_f32 v51, v51
    v_mfma_f32_32x32x8_bf16 v[32:47], v[116:117], v[20:21], v[32:47]
    v_exp_f32 v52, v52
    v_exp_f32 v53, v53
    v_exp_f32 v54, v54
    v_exp_f32 v55, v55
    v_cvt_pk_bf16_f32 v72, v48, v49
    v_cvt_pk_bf16_f32 v73, v50, v51
    v_mfma_f32_32x32x16_bf16 v[80:95], v[136:139], v[64:67], v[80:95]
    v_exp_f32 v56, v56
    v_exp_f32 v57, v57
    v_exp_f32 v58, v58
    v_exp_f32 v59, v59
    v_cvt_pk_bf16_f32 v74, v52, v53
    v_cvt_pk_bf16_f32 v75, v54, v55
    v_mfma_f32_32x32x16_bf16 v[80:95], v[140:143], v[68:71], v[80:95]
    v_exp_f32 v60, v60
    v_exp_f32 v61, v61
    v_exp_f32 v62, v62
    v_exp_f32 v63, v63
    v_cvt_pk_bf16_f32 v76, v56, v57
    v_cvt_pk_bf16_f32 v77, v58, v59
    v_cvt_pk_bf16_f32 v78, v60, v61
    v_cvt_pk_bf16_f32 v79, v62, v63
    v_mfma_f32_32x32x16_bf16 v[48:63], v[112:115], v[24:27], 0
    v_exp_f32 v32, v32
    v_exp_f32 v33, v33
    v_exp_f32 v34, v34
    v_exp_f32 v35, v35
    v_mfma_f32_32x32x8_bf16 v[48:63], v[116:117], v[28:29], v[48:63]
    v_exp_f32 v36, v36
    v_exp_f32 v37, v37
    v_exp_f32 v38, v38
    v_exp_f32 v39, v39
    v_cvt_pk_bf16_f32 v64, v32, v33
    v_cvt_pk_bf16_f32 v65, v34, v35
    v_mfma_f32_32x32x16_bf16 v[96:111], v[136:139], v[72:75], v[96:111]
    v_exp_f32 v40, v40
    v_exp_f32 v41, v41
    v_exp_f32 v42, v42
    v_exp_f32 v43, v43
    v_cvt_pk_bf16_f32 v66, v36, v37
    v_cvt_pk_bf16_f32 v67, v38, v39
    v_mfma_f32_32x32x16_bf16 v[96:111], v[140:143], v[76:79], v[96:111]
    v_exp_f32 v44, v44
    v_exp_f32 v45, v45
    v_exp_f32 v46, v46
    v_exp_f32 v47, v47
    v_cvt_pk_bf16_f32 v68, v40, v41
    v_cvt_pk_bf16_f32 v69, v42, v43
    v_cvt_pk_bf16_f32 v70, v44, v45
    v_cvt_pk_bf16_f32 v71, v46, v47
    s_waitcnt lgkmcnt(0)
    s_mov_b64 exec, s[42:43]
    ds_read_b128 v[136:139], v10 offset:18944
    ds_read_b128 v[140:143], v10 offset:19584
    s_mov_b64 exec, -1
    v_mfma_f32_32x32x16_bf16 v[32:47], v[120:123], v[16:19], 0
    v_exp_f32 v48, v48
    v_exp_f32 v49, v49
    v_exp_f32 v50, v50
    v_exp_f32 v51, v51
    v_mfma_f32_32x32x8_bf16 v[32:47], v[124:125], v[20:21], v[32:47]
    v_exp_f32 v52, v52
    v_exp_f32 v53, v53
    v_exp_f32 v54, v54
    v_exp_f32 v55, v55
    v_cvt_pk_bf16_f32 v72, v48, v49
    v_cvt_pk_bf16_f32 v73, v50, v51
    v_mfma_f32_32x32x16_bf16 v[80:95], v[128:131], v[64:67], v[80:95]
    v_exp_f32 v56, v56
    v_exp_f32 v57, v57
    v_exp_f32 v58, v58
    v_exp_f32 v59, v59
    v_cvt_pk_bf16_f32 v74, v52, v53
    v_cvt_pk_bf16_f32 v75, v54, v55
    v_mfma_f32_32x32x16_bf16 v[80:95], v[132:135], v[68:71], v[80:95]
    v_exp_f32 v60, v60
    v_exp_f32 v61, v61
    v_exp_f32 v62, v62
    v_exp_f32 v63, v63
    v_cvt_pk_bf16_f32 v76, v56, v57
    v_cvt_pk_bf16_f32 v77, v58, v59
    v_cvt_pk_bf16_f32 v78, v60, v61
    v_cvt_pk_bf16_f32 v79, v62, v63
    s_setprio 0
    v_mfma_f32_32x32x16_bf16 v[48:63], v[120:123], v[24:27], 0
    v_exp_f32 v32, v32
    v_exp_f32 v33, v33
    v_exp_f32 v34, v34
    v_exp_f32 v35, v35
    v_mfma_f32_32x32x8_bf16 v[48:63], v[124:125], v[28:29], v[48:63]
    v_exp_f32 v36, v36
    v_exp_f32 v37, v37
    v_exp_f32 v38, v38
    v_exp_f32 v39, v39
    v_cvt_pk_bf16_f32 v64, v32, v33
    v_cvt_pk_bf16_f32 v65, v34, v35
    v_mfma_f32_32x32x16_bf16 v[96:111], v[128:131], v[72:75], v[96:111]
    v_exp_f32 v40, v40
    v_exp_f32 v41, v41
    v_exp_f32 v42, v42
    v_exp_f32 v43, v43
    v_cvt_pk_bf16_f32 v66, v36, v37
    v_cvt_pk_bf16_f32 v67, v38, v39
    v_mfma_f32_32x32x16_bf16 v[96:111], v[132:135], v[76:79], v[96:111]
    v_exp_f32 v44, v44
    v_exp_f32 v45, v45
    v_exp_f32 v46, v46
    v_exp_f32 v47, v47
    v_cvt_pk_bf16_f32 v68, v40, v41
    v_cvt_pk_bf16_f32 v69, v42, v43
    v_cvt_pk_bf16_f32 v70, v44, v45
    v_cvt_pk_bf16_f32 v71, v46, v47
    s_waitcnt lgkmcnt(0)
    v_exp_f32 v48, v48
    v_exp_f32 v49, v49
    v_exp_f32 v50, v50
    v_exp_f32 v51, v51
    v_exp_f32 v52, v52
    v_exp_f32 v53, v53
    v_exp_f32 v54, v54
    v_exp_f32 v55, v55
    v_cvt_pk_bf16_f32 v72, v48, v49
    v_cvt_pk_bf16_f32 v73, v50, v51
    v_mfma_f32_32x32x16_bf16 v[80:95], v[136:139], v[64:67], v[80:95]
    v_exp_f32 v56, v56
    v_exp_f32 v57, v57
    v_exp_f32 v58, v58
    v_exp_f32 v59, v59
    v_cvt_pk_bf16_f32 v74, v52, v53
    v_cvt_pk_bf16_f32 v75, v54, v55
    v_mfma_f32_32x32x16_bf16 v[80:95], v[140:143], v[68:71], v[80:95]
    v_exp_f32 v60, v60
    v_exp_f32 v61, v61
    v_exp_f32 v62, v62
    v_exp_f32 v63, v63
    v_cvt_pk_bf16_f32 v76, v56, v57
    v_cvt_pk_bf16_f32 v77, v58, v59
    v_cvt_pk_bf16_f32 v78, v60, v61
    v_cvt_pk_bf16_f32 v79, v62, v63
    s_nop 1
    v_mfma_f32_32x32x16_bf16 v[96:111], v[136:139], v[72:75], v[96:111]
    v_mfma_f32_32x32x16_bf16 v[96:111], v[140:143], v[76:79], v[96:111]
    s_mul_i32 s35, s38, 81920
    s_and_b32 s36, s34, 3
    s_mul_i32 s36, s36, 3328
    s_add_u32 s36, s36, 1024
    s_add_u32 s54, s35, s36
    s_xor_b32 s35, s38, 1
    s_mul_i32 s35, s35, 81920
    s_add_u32 s55, s35, s36
    v_add_u32 v4, s54, v11
    v_add_u32 v5, s55, v11
    v_lshlrev_b32 v6, 2, v1
    v_add_u32 v7, s55, v6
    v_add_u32 v6, s54, v6
    s_cmp_eq_u32 s38, 0
    s_cbranch_scc1 k2_send0
    ds_write_b128 v4, v[80:83] offset:0
    ds_write_b128 v4, v[84:87] offset:1024
    ds_write_b128 v4, v[88:91] offset:2048
    ds_write_b32 v6, v92 offset:3072
    v_mov_b32 v150, 1
    v_mov_b32 v151, s37
    s_waitcnt lgkmcnt(0)
    ds_write_b32 v151, v150
    v_mov_b32 v80, v96
    v_mov_b32 v81, v97
    v_mov_b32 v82, v98
    v_mov_b32 v83, v99
    v_mov_b32 v84, v100
    v_mov_b32 v85, v101
    v_mov_b32 v86, v102
    v_mov_b32 v87, v103
    v_mov_b32 v88, v104
    v_mov_b32 v89, v105
    v_mov_b32 v90, v106
    v_mov_b32 v91, v107
    v_mov_b32 v92, v108
    v_mov_b32 v16, v24
    v_mov_b32 v17, v25
    v_mov_b32 v18, v26
    v_mov_b32 v19, v27
    v_mov_b32 v20, v28
    v_mov_b32 v21, v29
    v_mov_b32 v22, v30
    v_mov_b32 v23, v31
    s_branch k2_sent
k2_send0:
    s_nop 3
    ds_write_b128 v4, v[96:99] offset:0
    ds_write_b128 v4, v[100:103] offset:1024
    ds_write_b128 v4, v[104:107] offset:2048
    ds_write_b32 v6, v108 offset:3072
    v_mov_b32 v150, 1
    v_mov_b32 v151, s37
    s_waitcnt lgkmcnt(0)
    ds_write_b32 v151, v150
k2_sent:
    s_lshl_b32 s35, s32, 6
    s_lshl_b32 s36, s38, 5
    s_add_u32 s35, s35, s36
    v_add_u32 v144, s35, v2
    v_lshrrev_b32 v145, 4, v144
    v_mul_u32_u24 v145, 20480, v145
    v_and_b32 v144, 15, v144
    v_lshl_add_u32 v145, v144, 4, v145
    s_mul_i32 s35, s40, 5
    v_add_u32 v144, s35, v3
    v_add_u32 v144, 0, v144
    v_lshrrev_b32 v146, 1, v144
    v_lshl_add_u32 v146, v146, 8, v145
    v_and_b32 v144, 1, v144
    v_lshl_add_u32 v13, v144, 3, v146
    v_add_u32 v144, s35, v3
    v_add_u32 v144, 2, v144
    v_lshrrev_b32 v146, 1, v144
    v_lshl_add_u32 v146, v146, 8, v145
    v_and_b32 v144, 1, v144
    v_lshl_add_u32 v14, v144, 3, v146
    v_add_u32 v144, s35, v3
    v_add_u32 v144, 4, v144
    v_lshrrev_b32 v146, 1, v144
    v_lshl_add_u32 v146, v146, 8, v145
    v_and_b32 v144, 1, v144
    v_lshl_add_u32 v15, v144, 3, v146
    v_cmp_eq_u32 vcc, 0, v3
    v_mov_b32 v144, 0x7ffffff8
    s_nop 0
    v_cndmask_b32 v15, v144, v15, vcc
    v_xor_b32 v151, 16, v151
    s_setprio 0
k2_poll:
    ds_read_b32 v150, v151
    s_waitcnt lgkmcnt(0)
    v_readfirstlane_b32 s35, v150
    s_nop 0
    s_cmp_eq_u32 s35, 1
    s_cbranch_scc1 k2_polled
    s_sleep 2
    s_branch k2_poll
k2_polled:
    ds_read_b128 v[96:99], v5 offset:0
    ds_read_b128 v[100:103], v5 offset:1024
    ds_read_b128 v[104:107], v5 offset:2048
    ds_read_b32 v108, v7 offset:3072
    s_waitcnt lgkmcnt(0)
    v_add_f32 v92, v92, v108
    v_add_f32 v80, v80, v96
    v_add_f32 v81, v81, v97
    v_add_f32 v82, v82, v98
    v_add_f32 v83, v83, v99
    v_add_f32 v84, v84, v100
    v_add_f32 v85, v85, v101
    v_add_f32 v86, v86, v102
    v_add_f32 v87, v87, v103
    v_add_f32 v88, v88, v104
    v_add_f32 v89, v89, v105
    v_add_f32 v90, v90, v106
    v_add_f32 v91, v91, v107
    v_cmp_nle_f32 vcc, 0x1f800000, v92
    s_mov_b64 s[54:55], vcc
    v_cmp_nge_f32 vcc, 0x5f800000, v92
    s_nop 1
    s_or_b64 vcc, vcc, s[54:55]
    s_cbranch_vccnz k2_fallback
k2_final:
    v_rcp_f32 v7, v92
    s_nop 0
    v_mul_f32 v80, v80, v7
    v_mul_f32 v81, v81, v7
    v_mul_f32 v82, v82, v7
    v_mul_f32 v83, v83, v7
    v_mul_f32 v84, v84, v7
    v_mul_f32 v85, v85, v7
    v_mul_f32 v86, v86, v7
    v_mul_f32 v87, v87, v7
    v_mul_f32 v88, v88, v7
    v_mul_f32 v89, v89, v7
    v_mul_f32 v90, v90, v7
    v_mul_f32 v91, v91, v7
    v_cvt_pk_bf16_f32 v64, v80, v81
    v_cvt_pk_bf16_f32 v65, v82, v83
    v_cvt_pk_bf16_f32 v66, v84, v85
    v_cvt_pk_bf16_f32 v67, v86, v87
    v_cvt_pk_bf16_f32 v68, v88, v89
    v_cvt_pk_bf16_f32 v69, v90, v91
    s_mov_b32 s35, 4194304
    buffer_store_dwordx2 v[64:65], v13, s[16:19], s35 offen
    buffer_store_dwordx2 v[66:67], v14, s[16:19], s35 offen
    buffer_store_dwordx2 v[68:69], v15, s[16:19], s35 offen
k2_end:
    s_endpgm
k2_fallback:
    v_cmp_eq_u32 vcc, 0, v3
    s_nop 1
    v_cndmask_b32 v20, 0, v20, vcc
    v_cndmask_b32 v21, 0, v21, vcc
    v_mov_b32 v148, 0xff800000
    v_lshlrev_b32 v9, 3, v2
    v_mul_u32_u24 v10, 20, v3
    v_add_u32 v10, v10, v2
    v_lshlrev_b32 v10, 4, v10
    s_mov_b32 s39, 0
k2_fb_max:
    buffer_load_dwordx4 v[112:115], v11, s[20:23], s39 offen
    s_mov_b64 exec, s[50:51]
    buffer_load_dwordx2 v[116:117], v9, s[20:23], s39 offen offset:2304
    s_mov_b64 exec, -1
    s_waitcnt vmcnt(0)
    v_mfma_f32_32x32x16_bf16 v[32:47], v[112:115], v[16:19], 0
    v_mfma_f32_32x32x8_bf16 v[32:47], v[116:117], v[20:21], v[32:47]
    s_nop 15
    v_max3_f32 v148, v32, v33, v148
    v_max3_f32 v148, v34, v35, v148
    v_max3_f32 v148, v36, v37, v148
    v_max3_f32 v148, v38, v39, v148
    v_max3_f32 v148, v40, v41, v148
    v_max3_f32 v148, v42, v43, v148
    v_max3_f32 v148, v44, v45, v148
    v_max3_f32 v148, v46, v47, v148
    s_add_u32 s39, s39, 2560
    s_cmp_lt_u32 s39, 163840
    s_cbranch_scc1 k2_fb_max
    v_mov_b32 v4, v148
    s_nop 1
    v_permlane32_swap_b32 v148, v4
    s_nop 1
    v_max_f32 v148, v148, v4
    v_cmp_eq_u32 vcc, 0, v3
    v_sub_f32 v4, 0, v148
    v_and_b32 v5, 0xffff0000, v4
    v_sub_f32 v4, v4, v5
    v_and_b32 v6, 0xffff0000, v4
    v_sub_f32 v4, v4, v6
    v_lshrrev_b32 v5, 16, v5
    v_or_b32 v5, v5, v6
    v_lshrrev_b32 v4, 16, v4
    v_cndmask_b32 v20, v5, v20, vcc
    v_cndmask_b32 v21, v4, v21, vcc
    v_mov_b32 v80, 0
    v_mov_b32 v81, 0
    v_mov_b32 v82, 0
    v_mov_b32 v83, 0
    v_mov_b32 v84, 0
    v_mov_b32 v85, 0
    v_mov_b32 v86, 0
    v_mov_b32 v87, 0
    v_mov_b32 v88, 0
    v_mov_b32 v89, 0
    v_mov_b32 v90, 0
    v_mov_b32 v91, 0
    v_mov_b32 v92, 0
    v_mov_b32 v93, 0
    v_mov_b32 v94, 0
    v_mov_b32 v95, 0
    s_mov_b32 s39, 0
k2_fb_main:
    buffer_load_dwordx4 v[112:115], v11, s[20:23], s39 offen
    s_mov_b64 exec, s[50:51]
    buffer_load_dwordx2 v[116:117], v9, s[20:23], s39 offen offset:2304
    s_mov_b64 exec, s[42:43]
    buffer_load_dwordx4 v[128:131], v10, s[20:23], s39 offen offset:1024
    buffer_load_dwordx4 v[132:135], v10, s[20:23], s39 offen offset:1664
    s_mov_b64 exec, -1
    s_waitcnt vmcnt(0)
    v_mfma_f32_32x32x16_bf16 v[32:47], v[112:115], v[16:19], 0
    v_mfma_f32_32x32x8_bf16 v[32:47], v[116:117], v[20:21], v[32:47]
    s_nop 15
    v_exp_f32 v32, v32
    v_exp_f32 v33, v33
    v_exp_f32 v34, v34
    v_exp_f32 v35, v35
    v_exp_f32 v36, v36
    v_exp_f32 v37, v37
    v_exp_f32 v38, v38
    v_exp_f32 v39, v39
    v_exp_f32 v40, v40
    v_exp_f32 v41, v41
    v_exp_f32 v42, v42
    v_exp_f32 v43, v43
    v_exp_f32 v44, v44
    v_exp_f32 v45, v45
    v_exp_f32 v46, v46
    v_exp_f32 v47, v47
    s_nop 0
    v_cvt_pk_bf16_f32 v64, v32, v33
    v_cvt_pk_bf16_f32 v65, v34, v35
    v_cvt_pk_bf16_f32 v66, v36, v37
    v_cvt_pk_bf16_f32 v67, v38, v39
    v_cvt_pk_bf16_f32 v68, v40, v41
    v_cvt_pk_bf16_f32 v69, v42, v43
    v_cvt_pk_bf16_f32 v70, v44, v45
    v_cvt_pk_bf16_f32 v71, v46, v47
    s_nop 1
    v_mfma_f32_32x32x16_bf16 v[80:95], v[128:131], v[64:67], v[80:95]
    v_mfma_f32_32x32x16_bf16 v[80:95], v[132:135], v[68:71], v[80:95]
    s_add_u32 s39, s39, 2560
    s_cmp_lt_u32 s39, 163840
    s_cbranch_scc1 k2_fb_main
    s_nop 15
    s_branch k2_final
k2_helper:
    s_setprio 3
    s_load_dwordx2 s[10:11], s[0:1], 32
    s_load_dwordx2 s[14:15], s[0:1], 0
    s_load_dwordx4 s[80:83], s[0:1], 72
    s_mov_b32 s32, 0x05040100
    s_mov_b32 s33, 0x07060302
    v_mov_b32 v144, 0x3f803f80
    v_mov_b32 v145, 0x3f803f80
    v_mov_b32 v146, 0x3f803f80
    v_mov_b32 v147, 0x3f803f80
    s_waitcnt lgkmcnt(0)
    s_mov_b32 s16, s12
    s_mov_b32 s17, s13
    s_mov_b32 s18, 0x1a00000
    s_mov_b32 s19, 0x00020000
    s_add_u32 s20, s12, 0x300000
    s_addc_u32 s21, s13, 0
    s_mov_b32 s22, 0x28000
    s_mov_b32 s23, 0x00020000
    s_mov_b32 s24, s4
    s_mov_b32 s25, s5
    s_mov_b32 s26, 0x1e0000
    s_mov_b32 s27, 0x00020000
    s_mov_b32 s28, s8
    s_mov_b32 s29, s9
    s_mov_b32 s30, 0x1e0000
    s_mov_b32 s31, 0x00020000
    s_mov_b32 s48, s6
    s_mov_b32 s49, s7
    s_mov_b32 s50, 0xc00
    s_mov_b32 s51, 0x00020000
    s_mov_b32 s60, s10
    s_mov_b32 s61, s11
    s_mov_b32 s62, 0xc8000
    s_mov_b32 s63, 0x00020000
    s_mov_b32 s64, s14
    s_mov_b32 s65, s15
    s_mov_b32 s66, 0x280000
    s_mov_b32 s67, 0x00020000
    v_lshrrev_b32 v4, 3, v1
    v_and_b32 v5, 7, v1
    v_mul_u32_u24 v8, 3072, v4
    v_lshl_add_u32 v8, v5, 4, v8
    v_mul_u32_u24 v9, 1280, v4
    v_lshl_add_u32 v9, v5, 4, v9
    v_and_b32 v4, 15, v1
    v_lshrrev_b32 v5, 4, v1
    v_mul_u32_u24 v14, 1280, v4
    v_lshl_add_u32 v14, v5, 4, v14
    v_bfe_u32 v4, v1, 2, 2
    v_and_b32 v5, 3, v1
    v_lshl_add_u32 v6, v3, 3, v4
    v_lshlrev_b32 v10, 7, v6
    v_bfe_u32 v6, v1, 4, 1
    v_lshl_add_u32 v10, v6, 5, v10
    v_lshl_add_u32 v10, v5, 3, v10
    v_lshrrev_b32 v6, 4, v1
    v_lshl_add_u32 v6, v6, 3, v4
    v_lshlrev_b32 v12, 7, v6
    v_lshl_add_u32 v12, v5, 3, v12
    v_add_u32 v10, 16384, v10
    v_add_u32 v12, 98304, v12
    v_mov_b32 v16, 0
    v_mov_b32 v112, 0
    v_mov_b32 v17, 0
    v_mov_b32 v113, 0
    v_mov_b32 v18, 0
    v_mov_b32 v114, 0
    v_mov_b32 v19, 0
    v_mov_b32 v115, 0
    v_mov_b32 v20, 0
    v_mov_b32 v116, 0
    v_mov_b32 v21, 0
    v_mov_b32 v117, 0
    v_mov_b32 v22, 0
    v_mov_b32 v118, 0
    v_mov_b32 v23, 0
    v_mov_b32 v119, 0
    v_mov_b32 v24, 0
    v_mov_b32 v120, 0
    v_mov_b32 v25, 0
    v_mov_b32 v121, 0
    v_mov_b32 v26, 0
    v_mov_b32 v122, 0
    v_mov_b32 v27, 0
    v_mov_b32 v123, 0
    v_mov_b32 v28, 0
    v_mov_b32 v124, 0
    v_mov_b32 v29, 0
    v_mov_b32 v125, 0
    v_mov_b32 v30, 0
    v_mov_b32 v126, 0
    v_mov_b32 v31, 0
    v_mov_b32 v127, 0
    s_barrier
    s_min_u32 s37, s2, 239
    s_mul_hi_u32 s54, s37, 0x1999999a
    s_mul_i32 s35, s54, 10
    s_sub_u32 s55, s37, s35
    s_mov_b32 s78, s54
    s_mov_b32 s79, s55
    s_mul_i32 s52, s55, 196608
    s_lshl_b32 s35, s54, 7
    s_add_u32 s52, s52, s35
    s_mul_i32 s56, s54, 2
    s_add_u32 s56, s56, 0
    s_mul_hi_u32 s57, s56, 0x55555556
    s_mul_i32 s35, s57, 3
    s_sub_u32 s39, s56, s35
    s_mul_i32 s57, s57, 40
    s_mul_i32 s35, s55, 4
    s_add_u32 s57, s57, s35
    s_mul_i32 s57, s57, 3
    s_add_u32 s57, s57, s39
    s_lshl_b32 s57, s57, 10
    s_add_u32 s68, s57, 17825792
    s_mul_i32 s56, s54, 2
    s_add_u32 s56, s56, 1
    s_mul_hi_u32 s57, s56, 0x55555556
    s_mul_i32 s35, s57, 3
    s_sub_u32 s39, s56, s35
    s_mul_i32 s57, s57, 40
    s_mul_i32 s35, s55, 4
    s_add_u32 s57, s57, s35
    s_mul_i32 s57, s57, 3
    s_add_u32 s57, s57, s39
    s_lshl_b32 s57, s57, 10
    s_add_u32 s69, s57, 17825792
    s_barrier
    s_min_u32 s37, s2, 239
    s_mul_hi_u32 s54, s37, 0xaaaaaab
    s_mul_i32 s35, s54, 24
    s_sub_u32 s55, s37, s35
    s_mul_i32 s53, s55, 81920
    s_lshl_b32 s35, s54, 7
    s_add_u32 s53, s53, s35
    s_mul_i32 s56, s54, 4
    s_add_u32 s56, s56, 0
    s_mul_hi_u32 s57, s56, 0x33333334
    s_mul_i32 s35, s57, 5
    s_sub_u32 s39, s56, s35
    s_mul_i32 s57, s57, 48
    s_mul_i32 s35, s55, 2
    s_add_u32 s57, s57, s35
    s_mul_i32 s57, s57, 5
    s_add_u32 s57, s57, s39
    s_lshl_b32 s57, s57, 10
    s_add_u32 s70, s57, 19922944
    s_mul_i32 s56, s54, 4
    s_add_u32 s56, s56, 1
    s_mul_hi_u32 s57, s56, 0x33333334
    s_mul_i32 s35, s57, 5
    s_sub_u32 s39, s56, s35
    s_mul_i32 s57, s57, 48
    s_mul_i32 s35, s55, 2
    s_add_u32 s57, s57, s35
    s_mul_i32 s57, s57, 5
    s_add_u32 s57, s57, s39
    s_lshl_b32 s57, s57, 10
    s_add_u32 s71, s57, 19922944
    s_mul_i32 s56, s54, 4
    s_add_u32 s56, s56, 2
    s_mul_hi_u32 s57, s56, 0x33333334
    s_mul_i32 s35, s57, 5
    s_sub_u32 s39, s56, s35
    s_mul_i32 s57, s57, 48
    s_mul_i32 s35, s55, 2
    s_add_u32 s57, s57, s35
    s_mul_i32 s57, s57, 5
    s_add_u32 s57, s57, s39
    s_lshl_b32 s57, s57, 10
    s_add_u32 s72, s57, 19922944
    s_mul_i32 s56, s54, 4
    s_add_u32 s56, s56, 3
    s_mul_hi_u32 s57, s56, 0x33333334
    s_mul_i32 s35, s57, 5
    s_sub_u32 s39, s56, s35
    s_mul_i32 s57, s57, 48
    s_mul_i32 s35, s55, 2
    s_add_u32 s57, s57, s35
    s_mul_i32 s57, s57, 5
    s_add_u32 s57, s57, s39
    s_lshl_b32 s57, s57, 10
    s_add_u32 s73, s57, 19922944
    s_min_u32 s37, s2, 99
    s_mul_hi_u32 s54, s37, 0x1999999a
    s_mul_i32 s35, s54, 10
    s_sub_u32 s55, s37, s35
    s_mul_i32 s58, s55, 81920
    s_lshl_b32 s35, s54, 7
    s_add_u32 s58, s58, s35
    s_mul_i32 s56, s54, 4
    s_add_u32 s56, s56, 0
    s_mul_hi_u32 s57, s56, 0x33333334
    s_mul_i32 s35, s57, 5
    s_sub_u32 s39, s56, s35
    s_mul_i32 s57, s57, 20
    s_mul_i32 s35, s55, 2
    s_add_u32 s57, s57, s35
    s_mul_i32 s57, s57, 5
    s_add_u32 s57, s57, s39
    s_lshl_b32 s57, s57, 10
    s_add_u32 s74, s57, 16777216
    s_mul_i32 s56, s54, 4
    s_add_u32 s56, s56, 1
    s_mul_hi_u32 s57, s56, 0x33333334
    s_mul_i32 s35, s57, 5
    s_sub_u32 s39, s56, s35
    s_mul_i32 s57, s57, 20
    s_mul_i32 s35, s55, 2
    s_add_u32 s57, s57, s35
    s_mul_i32 s57, s57, 5
    s_add_u32 s57, s57, s39
    s_lshl_b32 s57, s57, 10
    s_add_u32 s75, s57, 16777216
    s_mul_i32 s56, s54, 4
    s_add_u32 s56, s56, 2
    s_mul_hi_u32 s57, s56, 0x33333334
    s_mul_i32 s35, s57, 5
    s_sub_u32 s39, s56, s35
    s_mul_i32 s57, s57, 20
    s_mul_i32 s35, s55, 2
    s_add_u32 s57, s57, s35
    s_mul_i32 s57, s57, 5
    s_add_u32 s57, s57, s39
    s_lshl_b32 s57, s57, 10
    s_add_u32 s76, s57, 16777216
    s_mul_i32 s56, s54, 4
    s_add_u32 s56, s56, 3
    s_mul_hi_u32 s57, s56, 0x33333334
    s_mul_i32 s35, s57, 5
    s_sub_u32 s39, s56, s35
    s_mul_i32 s57, s57, 20
    s_mul_i32 s35, s55, 2
    s_add_u32 s57, s57, s35
    s_mul_i32 s57, s57, 5
    s_add_u32 s57, s57, s39
    s_lshl_b32 s57, s57, 10
    s_add_u32 s77, s57, 16777216
    s_mov_b32 s39, 32768
k2_kernel_hd1:
    s_mov_b32 m0, s39
    s_add_u32 s35, s39, 81920
    buffer_load_dwordx4 v11, s[20:23], s39 offen lds
    s_mov_b32 m0, s35
    s_add_u32 s39, s39, 1024
    buffer_load_dwordx4 v11, s[20:23], s35 offen lds
    s_cmp_lt_u32 s39, 57344
    s_cbranch_scc1 k2_kernel_hd1
    s_waitcnt vmcnt(8)
    s_mov_b32 s39, 57344
k2_kernel_hd2:
    s_mov_b32 m0, s39
    s_add_u32 s35, s39, 81920
    buffer_load_dwordx4 v11, s[20:23], s39 offen lds
    s_mov_b32 m0, s35
    s_add_u32 s39, s39, 1024
    buffer_load_dwordx4 v11, s[20:23], s35 offen lds
    s_cmp_lt_u32 s39, 81920
    s_cbranch_scc1 k2_kernel_hd2
    s_waitcnt vmcnt(30)
    s_lshr_b32 s54, s2, 1
    s_mul_i32 s54, s54, 20480
    s_and_b32 s35, s2, 1
    s_mul_i32 s35, s35, 640
    s_add_u32 s54, s54, s35
    buffer_load_dwordx4 v[64:67], v14, s[64:67], s54 offen offset:0
    buffer_load_dwordx4 v[68:71], v14, s[64:67], s54 offen offset:64
    buffer_load_dwordx4 v[72:75], v14, s[64:67], s54 offen offset:128
    buffer_load_dwordx4 v[76:79], v14, s[64:67], s54 offen offset:192
    buffer_load_dwordx4 v[80:83], v14, s[64:67], s54 offen offset:256
    buffer_load_dwordx4 v[84:87], v14, s[64:67], s54 offen offset:320
    buffer_load_dwordx4 v[88:91], v14, s[64:67], s54 offen offset:384
    buffer_load_dwordx4 v[92:95], v14, s[64:67], s54 offen offset:448
    buffer_load_dwordx4 v[96:99], v14, s[64:67], s54 offen offset:512
    buffer_load_dwordx4 v[100:103], v14, s[64:67], s54 offen offset:576
    v_lshlrev_b32 v4, 1, v2
    s_lshl_b32 s35, s78, 7
    buffer_load_ushort v104, v4, s[48:51], s35 offen
    buffer_load_ushort v105, v4, s[48:51], s35 offen offset:64
    s_mul_i32 s57, s2, 10240
    s_add_u32 s57, s57, 23068672
    s_waitcnt vmcnt(12)
    s_barrier
    s_mov_b32 m0, 16384
    s_add_u32 s36, s52, 0
    buffer_load_dwordx4 v8, s[24:27], s36 offen lds
    s_mov_b32 m0, 17408
    s_add_u32 s36, s52, 24576
    buffer_load_dwordx4 v8, s[24:27], s36 offen lds
    s_mov_b32 m0, 18432
    s_add_u32 s36, s52, 49152
    buffer_load_dwordx4 v8, s[24:27], s36 offen lds
    s_mov_b32 m0, 19456
    s_add_u32 s36, s52, 73728
    buffer_load_dwordx4 v8, s[24:27], s36 offen lds
    s_mov_b32 m0, 20480
    s_add_u32 s36, s52, 98304
    buffer_load_dwordx4 v8, s[24:27], s36 offen lds
    s_mov_b32 m0, 21504
    s_add_u32 s36, s52, 122880
    buffer_load_dwordx4 v8, s[24:27], s36 offen lds
    s_mov_b32 m0, 22528
    s_add_u32 s36, s52, 147456
    buffer_load_dwordx4 v8, s[24:27], s36 offen lds
    s_mov_b32 m0, 23552
    s_add_u32 s36, s52, 172032
    buffer_load_dwordx4 v8, s[24:27], s36 offen lds
    s_mov_b32 m0, 98304
    s_add_u32 s36, s53, 0
    buffer_load_dwordx4 v9, s[28:31], s36 offen lds
    s_mov_b32 m0, 99328
    s_add_u32 s36, s53, 10240
    buffer_load_dwordx4 v9, s[28:31], s36 offen lds
    s_mov_b32 m0, 100352
    s_add_u32 s36, s53, 20480
    buffer_load_dwordx4 v9, s[28:31], s36 offen lds
    s_mov_b32 m0, 101376
    s_add_u32 s36, s53, 30720
    buffer_load_dwordx4 v9, s[28:31], s36 offen lds
    s_mov_b32 m0, 102400
    s_add_u32 s36, s53, 40960
    buffer_load_dwordx4 v9, s[28:31], s36 offen lds
    s_mov_b32 m0, 103424
    s_add_u32 s36, s53, 51200
    buffer_load_dwordx4 v9, s[28:31], s36 offen lds
    s_mov_b32 m0, 104448
    s_add_u32 s36, s53, 61440
    buffer_load_dwordx4 v9, s[28:31], s36 offen lds
    s_mov_b32 m0, 105472
    s_add_u32 s36, s53, 71680
    buffer_load_dwordx4 v9, s[28:31], s36 offen lds
    s_waitcnt vmcnt(16)
    s_add_u32 s36, s57, 0
    buffer_store_dwordx4 v[64:67], v11, s[16:19], s36 offen sc1
    s_add_u32 s36, s57, 1024
    buffer_store_dwordx4 v[68:71], v11, s[16:19], s36 offen sc1
    s_add_u32 s36, s57, 2048
    buffer_store_dwordx4 v[72:75], v11, s[16:19], s36 offen sc1
    s_add_u32 s36, s57, 3072
    buffer_store_dwordx4 v[76:79], v11, s[16:19], s36 offen sc1
    s_add_u32 s36, s57, 4096
    buffer_store_dwordx4 v[80:83], v11, s[16:19], s36 offen sc1
    s_add_u32 s36, s57, 5120
    buffer_store_dwordx4 v[84:87], v11, s[16:19], s36 offen sc1
    s_add_u32 s36, s57, 6144
    buffer_store_dwordx4 v[88:91], v11, s[16:19], s36 offen sc1
    s_add_u32 s36, s57, 7168
    buffer_store_dwordx4 v[92:95], v11, s[16:19], s36 offen sc1
    s_add_u32 s36, s57, 8192
    buffer_store_dwordx4 v[96:99], v11, s[16:19], s36 offen sc1
    s_add_u32 s36, s57, 9216
    buffer_store_dwordx4 v[100:103], v11, s[16:19], s36 offen sc1
    s_waitcnt vmcnt(18)
    ds_read_b64_tr_b16 v[32:33], v10 offset:0
    ds_read_b64_tr_b16 v[34:35], v10 offset:512
    ds_read_b64_tr_b16 v[36:37], v10 offset:64
    ds_read_b64_tr_b16 v[38:39], v10 offset:576
    ds_read_b64_tr_b16 v[40:41], v10 offset:2048
    ds_read_b64_tr_b16 v[42:43], v10 offset:2560
    ds_read_b64_tr_b16 v[44:45], v10 offset:2112
    ds_read_b64_tr_b16 v[46:47], v10 offset:2624
    s_waitcnt lgkmcnt(0)
    ds_read_b64_tr_b16 v[48:49], v10 offset:4096
    ds_read_b64_tr_b16 v[50:51], v10 offset:4608
    ds_read_b64_tr_b16 v[52:53], v10 offset:4160
    ds_read_b64_tr_b16 v[54:55], v10 offset:4672
    ds_read_b64_tr_b16 v[56:57], v10 offset:6144
    ds_read_b64_tr_b16 v[58:59], v10 offset:6656
    ds_read_b64_tr_b16 v[60:61], v10 offset:6208
    ds_read_b64_tr_b16 v[62:63], v10 offset:6720
    s_waitcnt lgkmcnt(0)
    s_add_u32 s36, s68, 0
    buffer_store_dwordx4 v[32:35], v11, s[16:19], s36 offen sc1
    v_mfma_f32_32x32x16_bf16 v[16:31], v[144:147], v[32:35], v[16:31]
    s_add_u32 s36, s69, 0
    buffer_store_dwordx4 v[36:39], v11, s[16:19], s36 offen sc1
    v_mfma_f32_32x32x16_bf16 v[112:127], v[144:147], v[36:39], v[112:127]
    s_add_u32 s36, s68, 3072
    buffer_store_dwordx4 v[40:43], v11, s[16:19], s36 offen sc1
    v_mfma_f32_32x32x16_bf16 v[16:31], v[144:147], v[40:43], v[16:31]
    s_add_u32 s36, s69, 3072
    buffer_store_dwordx4 v[44:47], v11, s[16:19], s36 offen sc1
    v_mfma_f32_32x32x16_bf16 v[112:127], v[144:147], v[44:47], v[112:127]
    s_add_u32 s36, s68, 6144
    buffer_store_dwordx4 v[48:51], v11, s[16:19], s36 offen sc1
    v_mfma_f32_32x32x16_bf16 v[16:31], v[144:147], v[48:51], v[16:31]
    s_add_u32 s36, s69, 6144
    buffer_store_dwordx4 v[52:55], v11, s[16:19], s36 offen sc1
    v_mfma_f32_32x32x16_bf16 v[112:127], v[144:147], v[52:55], v[112:127]
    s_add_u32 s36, s68, 9216
    buffer_store_dwordx4 v[56:59], v11, s[16:19], s36 offen sc1
    v_mfma_f32_32x32x16_bf16 v[16:31], v[144:147], v[56:59], v[16:31]
    s_add_u32 s36, s69, 9216
    buffer_store_dwordx4 v[60:63], v11, s[16:19], s36 offen sc1
    v_mfma_f32_32x32x16_bf16 v[112:127], v[144:147], v[60:63], v[112:127]
    s_mov_b32 m0, 16384
    s_add_u32 s36, s58, 0
    buffer_load_dwordx4 v9, s[60:63], s36 offen lds
    s_mov_b32 m0, 17408
    s_add_u32 s36, s58, 10240
    buffer_load_dwordx4 v9, s[60:63], s36 offen lds
    s_mov_b32 m0, 18432
    s_add_u32 s36, s58, 20480
    buffer_load_dwordx4 v9, s[60:63], s36 offen lds
    s_mov_b32 m0, 19456
    s_add_u32 s36, s58, 30720
    buffer_load_dwordx4 v9, s[60:63], s36 offen lds
    s_mov_b32 m0, 20480
    s_add_u32 s36, s58, 40960
    buffer_load_dwordx4 v9, s[60:63], s36 offen lds
    s_mov_b32 m0, 21504
    s_add_u32 s36, s58, 51200
    buffer_load_dwordx4 v9, s[60:63], s36 offen lds
    s_mov_b32 m0, 22528
    s_add_u32 s36, s58, 61440
    buffer_load_dwordx4 v9, s[60:63], s36 offen lds
    s_mov_b32 m0, 23552
    s_add_u32 s36, s58, 71680
    buffer_load_dwordx4 v9, s[60:63], s36 offen lds
    s_waitcnt vmcnt(26)
    ds_read_b64_tr_b16 v[32:33], v12 offset:0
    ds_read_b64_tr_b16 v[34:35], v12 offset:512
    ds_read_b64_tr_b16 v[36:37], v12 offset:32
    ds_read_b64_tr_b16 v[38:39], v12 offset:544
    ds_read_b64_tr_b16 v[40:41], v12 offset:64
    ds_read_b64_tr_b16 v[42:43], v12 offset:576
    ds_read_b64_tr_b16 v[44:45], v12 offset:96
    ds_read_b64_tr_b16 v[46:47], v12 offset:608
    s_waitcnt lgkmcnt(0)
    ds_read_b64_tr_b16 v[48:49], v12 offset:4096
    ds_read_b64_tr_b16 v[50:51], v12 offset:4608
    ds_read_b64_tr_b16 v[52:53], v12 offset:4128
    ds_read_b64_tr_b16 v[54:55], v12 offset:4640
    ds_read_b64_tr_b16 v[56:57], v12 offset:4160
    ds_read_b64_tr_b16 v[58:59], v12 offset:4672
    ds_read_b64_tr_b16 v[60:61], v12 offset:4192
    ds_read_b64_tr_b16 v[62:63], v12 offset:4704
    s_waitcnt lgkmcnt(0)
    s_add_u32 s36, s70, 0
    buffer_store_dwordx4 v[32:35], v11, s[16:19], s36 offen sc1
    s_add_u32 s36, s71, 0
    buffer_store_dwordx4 v[36:39], v11, s[16:19], s36 offen sc1
    s_add_u32 s36, s72, 0
    buffer_store_dwordx4 v[40:43], v11, s[16:19], s36 offen sc1
    s_add_u32 s36, s73, 0
    buffer_store_dwordx4 v[44:47], v11, s[16:19], s36 offen sc1
    s_add_u32 s36, s70, 5120
    buffer_store_dwordx4 v[48:51], v11, s[16:19], s36 offen sc1
    s_add_u32 s36, s71, 5120
    buffer_store_dwordx4 v[52:55], v11, s[16:19], s36 offen sc1
    s_add_u32 s36, s72, 5120
    buffer_store_dwordx4 v[56:59], v11, s[16:19], s36 offen sc1
    s_add_u32 s36, s73, 5120
    buffer_store_dwordx4 v[60:63], v11, s[16:19], s36 offen sc1
    v_lshlrev_b32 v13, 4, v2
    s_lshl_b32 s54, s78, 12
    s_add_u32 s54, s54, 22020096
    s_mul_i32 s55, s79, 3
    v_and_b32 v5, 0xffff0000, v16
    v_sub_f32 v4, v16, v5
    v_and_b32 v6, 0xffff0000, v4
    v_sub_f32 v4, v4, v6
    s_add_u32 s56, s55, 0
    s_lshr_b32 s35, s56, 3
    s_lshl_b32 s35, s35, 9
    s_and_b32 s56, s56, 7
    s_lshl_b32 s56, s56, 1
    s_add_u32 s56, s56, s35
    s_add_u32 s56, s56, s54
    buffer_store_short_d16_hi v5, v13, s[16:19], s56 offen offset:0
    s_add_u32 s56, s55, 1
    s_lshr_b32 s35, s56, 3
    s_lshl_b32 s35, s35, 9
    s_and_b32 s56, s56, 7
    s_lshl_b32 s56, s56, 1
    s_add_u32 s56, s56, s35
    s_add_u32 s56, s56, s54
    buffer_store_short_d16_hi v6, v13, s[16:19], s56 offen offset:0
    s_add_u32 s56, s55, 2
    s_lshr_b32 s35, s56, 3
    s_lshl_b32 s35, s35, 9
    s_and_b32 s56, s56, 7
    s_lshl_b32 s56, s56, 1
    s_add_u32 s56, s56, s35
    s_add_u32 s56, s56, s54
    buffer_store_short_d16_hi v4, v13, s[16:19], s56 offen offset:0
    buffer_store_dword v104, v13, s[16:19], s54 offen offset:1548
    v_and_b32 v5, 0xffff0000, v112
    v_sub_f32 v4, v112, v5
    v_and_b32 v6, 0xffff0000, v4
    v_sub_f32 v4, v4, v6
    s_add_u32 s56, s55, 0
    s_lshr_b32 s35, s56, 3
    s_lshl_b32 s35, s35, 9
    s_and_b32 s56, s56, 7
    s_lshl_b32 s56, s56, 1
    s_add_u32 s56, s56, s35
    s_add_u32 s56, s56, s54
    buffer_store_short_d16_hi v5, v13, s[16:19], s56 offen offset:2048
    s_add_u32 s56, s55, 1
    s_lshr_b32 s35, s56, 3
    s_lshl_b32 s35, s35, 9
    s_and_b32 s56, s56, 7
    s_lshl_b32 s56, s56, 1
    s_add_u32 s56, s56, s35
    s_add_u32 s56, s56, s54
    buffer_store_short_d16_hi v6, v13, s[16:19], s56 offen offset:2048
    s_add_u32 s56, s55, 2
    s_lshr_b32 s35, s56, 3
    s_lshl_b32 s35, s35, 9
    s_and_b32 s56, s56, 7
    s_lshl_b32 s56, s56, 1
    s_add_u32 s56, s56, s35
    s_add_u32 s56, s56, s54
    buffer_store_short_d16_hi v4, v13, s[16:19], s56 offen offset:2048
    buffer_store_dword v105, v13, s[16:19], s54 offen offset:3596
    v_subrev_u32 v12, 81920, v12
    s_waitcnt vmcnt(16)
    ds_read_b64_tr_b16 v[32:33], v12 offset:0
    ds_read_b64_tr_b16 v[34:35], v12 offset:512
    ds_read_b64_tr_b16 v[36:37], v12 offset:32
    ds_read_b64_tr_b16 v[38:39], v12 offset:544
    ds_read_b64_tr_b16 v[40:41], v12 offset:64
    ds_read_b64_tr_b16 v[42:43], v12 offset:576
    ds_read_b64_tr_b16 v[44:45], v12 offset:96
    ds_read_b64_tr_b16 v[46:47], v12 offset:608
    s_waitcnt lgkmcnt(0)
    ds_read_b64_tr_b16 v[48:49], v12 offset:4096
    ds_read_b64_tr_b16 v[50:51], v12 offset:4608
    ds_read_b64_tr_b16 v[52:53], v12 offset:4128
    ds_read_b64_tr_b16 v[54:55], v12 offset:4640
    ds_read_b64_tr_b16 v[56:57], v12 offset:4160
    ds_read_b64_tr_b16 v[58:59], v12 offset:4672
    ds_read_b64_tr_b16 v[60:61], v12 offset:4192
    ds_read_b64_tr_b16 v[62:63], v12 offset:4704
    s_waitcnt lgkmcnt(0)
    s_add_u32 s36, s74, 0
    buffer_store_dwordx4 v[32:35], v11, s[16:19], s36 offen sc1
    s_add_u32 s36, s75, 0
    buffer_store_dwordx4 v[36:39], v11, s[16:19], s36 offen sc1
    s_add_u32 s36, s76, 0
    buffer_store_dwordx4 v[40:43], v11, s[16:19], s36 offen sc1
    s_add_u32 s36, s77, 0
    buffer_store_dwordx4 v[44:47], v11, s[16:19], s36 offen sc1
    s_add_u32 s36, s74, 5120
    buffer_store_dwordx4 v[48:51], v11, s[16:19], s36 offen sc1
    s_add_u32 s36, s75, 5120
    buffer_store_dwordx4 v[52:55], v11, s[16:19], s36 offen sc1
    s_add_u32 s36, s76, 5120
    buffer_store_dwordx4 v[56:59], v11, s[16:19], s36 offen sc1
    s_add_u32 s36, s77, 5120
    buffer_store_dwordx4 v[60:63], v11, s[16:19], s36 offen sc1
    s_mov_b32 s84, s82
    s_mov_b32 s85, s83
    s_mov_b32 s86, 0x280000
    s_mov_b32 s87, 0x00020000
    s_mov_b32 s88, s80
    s_mov_b32 s89, s81
    s_mov_b32 s90, 0x500
    s_mov_b32 s91, 0x00020000
    s_lshr_b32 s35, s2, 3
    s_lshl_b32 s35, s35, 20
    v_lshlrev_b32 v4, 14, v1
    buffer_load_dword v5, v4, s[16:19], s35 offen
    buffer_load_dword v6, v4, s[84:87], s35 offen
    buffer_load_dword v7, v4, s[88:91], s35 offen
    s_waitcnt vmcnt(0)
    s_and_b32 s54, s2, 7
    s_mul_i32 s54, s54, 327680
    s_add_u32 s14, s12, s54
    s_addc_u32 s15, s13, 0
    s_add_u32 s44, s14, 0x400000
    s_addc_u32 s45, s15, 0
    s_mov_b32 s46, 0x50000
    s_mov_b32 s47, 0x00020000
    s_lshr_b32 s35, s2, 3
    s_lshl_b32 s35, s35, 13
    v_lshlrev_b32 v4, 7, v1
    s_add_u32 s36, s35, 0
    buffer_load_dword v5, v4, s[44:47], s36 offen
    s_add_u32 s36, s35, 262144
    buffer_load_dword v5, v4, s[44:47], s36 offen
    s_and_b32 s54, s2, 7
    s_mul_i32 s54, s54, 327680
    s_add_u32 s14, s12, s54
    s_addc_u32 s15, s13, 0
    s_add_u32 s44, s14, 0x1600000
    s_addc_u32 s45, s15, 0
    s_mov_b32 s46, 0x50000
    s_mov_b32 s47, 0x00020000
    s_lshr_b32 s35, s2, 3
    s_lshl_b32 s35, s35, 13
    v_lshlrev_b32 v4, 7, v1
    s_add_u32 s36, s35, 0
    buffer_load_dword v5, v4, s[44:47], s36 offen
    s_add_u32 s36, s35, 262144
    buffer_load_dword v5, v4, s[44:47], s36 offen
    s_add_u32 s44, s12, 0x1000000
    s_addc_u32 s45, s13, 0
    s_mov_b32 s46, 0xc8000
    s_mov_b32 s47, 0x00020000
    s_lshr_b32 s35, s2, 3
    s_lshl_b32 s35, s35, 13
    v_lshlrev_b32 v4, 7, v1
    s_add_u32 s36, s35, 0
    buffer_load_dword v5, v4, s[44:47], s36 offen
    s_add_u32 s36, s35, 262144
    buffer_load_dword v5, v4, s[44:47], s36 offen
    s_add_u32 s36, s35, 524288
    buffer_load_dword v5, v4, s[44:47], s36 offen
    s_add_u32 s36, s35, 786432
    buffer_load_dword v5, v4, s[44:47], s36 offen
    s_add_u32 s44, s12, 0x1100000
    s_addc_u32 s45, s13, 0
    s_mov_b32 s46, 0x1e0000
    s_mov_b32 s47, 0x00020000
    s_lshr_b32 s35, s2, 3
    s_lshl_b32 s35, s35, 13
    v_lshlrev_b32 v4, 7, v1
    s_add_u32 s36, s35, 0
    buffer_load_dword v5, v4, s[44:47], s36 offen
    s_add_u32 s36, s35, 262144
    buffer_load_dword v5, v4, s[44:47], s36 offen
    s_add_u32 s36, s35, 524288
    buffer_load_dword v5, v4, s[44:47], s36 offen
    s_add_u32 s36, s35, 786432
    buffer_load_dword v5, v4, s[44:47], s36 offen
    s_add_u32 s36, s35, 1048576
    buffer_load_dword v5, v4, s[44:47], s36 offen
    s_add_u32 s36, s35, 1310720
    buffer_load_dword v5, v4, s[44:47], s36 offen
    s_add_u32 s36, s35, 1572864
    buffer_load_dword v5, v4, s[44:47], s36 offen
    s_add_u32 s36, s35, 1835008
    buffer_load_dword v5, v4, s[44:47], s36 offen
    s_endpgm
.globl k3_kernel
.p2align 8
.type k3_kernel,@function
k3_kernel:
    s_cmp_ge_u32 s2, 256
    s_cbranch_scc1 k3_end
    s_load_dwordx2 s[12:13], s[0:1], 96
    s_load_dwordx4 s[8:11], s[0:1], 72
    v_lshrrev_b32 v1, 6, v0
    s_nop 0
    v_readfirstlane_b32 s34, v1
    v_and_b32 v1, 63, v0
    s_and_b32 s35, s2, 7
    s_lshl_b32 s32, s35, 1
    s_bfe_u32 s35, s2, 0x10003
    s_add_u32 s32, s32, s35
    s_lshr_b32 s33, s2, 4
    s_lshl_b32 s37, s32, 1
    s_and_b32 s35, s33, 1
    s_add_u32 s37, s37, s35
    s_lshr_b32 s38, s33, 1
    v_lshlrev_b32 v4, 4, v1
    v_and_b32 v2, 15, v1
    v_lshrrev_b32 v3, 4, v1
    s_lshl_b32 s35, s37, 6
    s_lshl_b32 s36, s34, 4
    s_add_u32 s39, s35, s36
    s_mul_i32 s40, s39, 1280
    s_mul_i32 s35, s38, 2560
    s_add_u32 s55, s40, s35
    s_add_u32 s55, s55, 23068672
    s_add_u32 s40, s40, 4194304
    s_mul_i32 s42, s34, 5120
    s_mul_i32 s41, s38, 102400
    s_add_u32 s41, s41, s42
    s_add_u32 s41, s41, 16777216
    v_lshrrev_b32 v9, 1, v3
    v_and_b32 v10, 1, v3
    v_lshlrev_b32 v14, 4, v2
    v_lshl_add_u32 v14, v9, 8, v14
    v_lshl_add_u32 v14, v10, 3, v14
    s_mov_b32 s24, 0
    s_mov_b32 s25, 0
    s_mov_b32 s26, 0
    s_waitcnt lgkmcnt(0)
    s_mov_b32 s20, s12
    s_mov_b32 s21, s13
    s_mov_b32 s22, 0x1a00000
    s_mov_b32 s23, 0x00020000
    s_sub_u32 s14, s24, 5
    s_cselect_b32 s15, 5, 0
    s_add_u32 s14, s14, s15
    s_mul_i32 s14, s14, 4096
    s_add_u32 s14, s14, s40
    buffer_load_dwordx4 v[188:191], v4, s[20:23], s14 offen offset:0
    buffer_load_dwordx4 v[192:195], v4, s[20:23], s14 offen offset:1024
    buffer_load_dwordx4 v[196:199], v4, s[20:23], s14 offen offset:2048
    buffer_load_dwordx4 v[200:203], v4, s[20:23], s14 offen offset:3072
    s_sub_u32 s27, s24, 5
    s_cselect_b32 s15, 5, 0
    s_add_u32 s27, s27, s15
    s_mul_i32 s27, s27, 20480
    s_add_u32 s27, s27, s41
    s_add_u32 m0, s42, 0
    s_add_u32 s36, s27, 0
    buffer_load_dwordx4 v4, s[20:23], s36 offen lds
    s_add_u32 m0, s42, 1024
    s_add_u32 s36, s27, 1024
    buffer_load_dwordx4 v4, s[20:23], s36 offen lds
    s_add_u32 m0, s42, 2048
    s_add_u32 s36, s27, 2048
    buffer_load_dwordx4 v4, s[20:23], s36 offen lds
    s_add_u32 m0, s42, 3072
    s_add_u32 s36, s27, 3072
    buffer_load_dwordx4 v4, s[20:23], s36 offen lds
    s_add_u32 m0, s42, 4096
    s_add_u32 s36, s27, 4096
    buffer_load_dwordx4 v4, s[20:23], s36 offen lds
    buffer_load_dwordx2 v[164:165], v14, s[20:23], s55 offen offset:0
    buffer_load_dwordx2 v[166:167], v14, s[20:23], s55 offen offset:512
    buffer_load_dwordx2 v[168:169], v14, s[20:23], s55 offen offset:1024
    buffer_load_dwordx2 v[170:171], v14, s[20:23], s55 offen offset:1536
    buffer_load_dwordx2 v[172:173], v14, s[20:23], s55 offen offset:2048
    s_sub_u32 s14, s24, 4
    s_cselect_b32 s15, 5, 0
    s_add_u32 s14, s14, s15
    s_mul_i32 s14, s14, 4096
    s_add_u32 s14, s14, s40
    buffer_load_dwordx4 v[204:207], v4, s[20:23], s14 offen offset:0
    buffer_load_dwordx4 v[208:211], v4, s[20:23], s14 offen offset:1024
    buffer_load_dwordx4 v[212:215], v4, s[20:23], s14 offen offset:2048
    buffer_load_dwordx4 v[216:219], v4, s[20:23], s14 offen offset:3072
    s_sub_u32 s27, s24, 4
    s_cselect_b32 s15, 5, 0
    s_add_u32 s27, s27, s15
    s_mul_i32 s27, s27, 20480
    s_add_u32 s27, s27, s41
    s_add_u32 m0, s42, 20480
    s_add_u32 s36, s27, 0
    buffer_load_dwordx4 v4, s[20:23], s36 offen lds
    s_add_u32 m0, s42, 21504
    s_add_u32 s36, s27, 1024
    buffer_load_dwordx4 v4, s[20:23], s36 offen lds
    s_add_u32 m0, s42, 22528
    s_add_u32 s36, s27, 2048
    buffer_load_dwordx4 v4, s[20:23], s36 offen lds
    s_add_u32 m0, s42, 23552
    s_add_u32 s36, s27, 3072
    buffer_load_dwordx4 v4, s[20:23], s36 offen lds
    s_add_u32 m0, s42, 24576
    s_add_u32 s36, s27, 4096
    buffer_load_dwordx4 v4, s[20:23], s36 offen lds
    s_mov_b32 s28, s8
    s_mov_b32 s29, s9
    s_mov_b32 s30, 0x500
    s_mov_b32 s31, 0x00020000
    s_mov_b32 s44, s10
    s_mov_b32 s45, s11
    s_mov_b32 s46, 0x280000
    s_mov_b32 s47, 0x00020000
    v_and_b32 v5, 31, v1
    v_lshrrev_b32 v6, 5, v1
    v_add_u32 v18, 61440, v4
    v_add_u32 v19, 122880, v4
    v_mov_b32 v7, 0x3f803f80
    v_mov_b32 v16, 0
    v_mov_b32 v17, 0
    v_add_u32 v8, s39, v2
    v_lshrrev_b32 v11, 5, v8
    v_mul_u32_u24 v12, 40960, v11
    v_and_b32 v11, 31, v8
    v_lshl_add_u32 v12, v11, 4, v12
    v_lshl_add_u32 v12, v9, 9, v12
    v_add_u32 v13, 4096, v12
    v_lshl_add_u32 v12, v10, 10, v12
    v_cmp_eq_u32 vcc, 0, v10
    v_mov_b32 v11, 0x7ffffff0
    v_lshlrev_b32 v15, 3, v8
    v_cndmask_b32 v13, v11, v13, vcc
    v_cmp_eq_u32 vcc, 0, v3
    v_lshlrev_b32 v35, 3, v3
    s_nop 0
    v_cndmask_b32 v15, v11, v15, vcc
    s_mul_i32 s53, s38, 5120
    s_add_u32 s53, s53, 7340032
    s_mul_i32 s54, s38, 160
    s_lshl_b32 s56, s32, 8
    s_add_u32 s56, s56, 26214400
    s_lshl_b32 s35, s32, 2
    s_add_u32 s35, s35, s34
    s_mul_i32 s48, s35, 40960
    s_add_u32 s48, s48, 7340032
    s_mul_i32 s50, s34, 3072
    s_mul_i32 s49, s33, 122880
    s_add_u32 s49, s49, s50
    s_add_u32 s49, s49, 17825792
    s_mul_i32 s58, s33, 3072
    s_add_u32 s58, s58, 10485760
    s_mul_i32 s59, s33, 6144
    s_add_u32 s59, s59, 22020096
    s_mov_b32 s43, 22151168
    s_lshl_b32 s35, s35, 5
    v_add_u32 v8, s35, v5
    v_lshlrev_b32 v37, 3, v8
    v_lshl_add_u32 v37, v6, 16, v37
    v_lshrrev_b32 v11, 4, v8
    v_mul_u32_u24 v36, 49152, v11
    v_and_b32 v11, 15, v8
    v_lshl_add_u32 v36, v11, 4, v36
    v_lshl_add_u32 v36, v6, 8, v36
    s_mul_i32 s51, s39, 3072
    s_add_u32 s51, s51, 10485760
    s_mul_i32 s52, s38, 245760
    s_add_u32 s52, s52, s42
    s_add_u32 s52, s52, 19922944
    s_mul_i32 s35, s34, 2560
    s_add_u32 s35, s35, 143360
    v_mul_u32_u24 v33, 160, v2
    v_add_u32 v33, v33, v35
    v_add_u32 v33, s35, v33
    v_add_u32 v34, s35, v4
    v_add_u32 v8, 0, v1
    v_mul_u32_u24 v9, 6554, v8
    v_lshrrev_b32 v9, 16, v9
    v_mul_u32_u24 v10, 10, v9
    v_sub_u32 v10, v8, v10
    v_add_u32 v9, s39, v9
    v_mul_u32_u24 v9, 1280, v9
    v_lshl_add_u32 v30, v10, 4, v9
    v_add_u32 v8, 64, v1
    v_mul_u32_u24 v9, 6554, v8
    v_lshrrev_b32 v9, 16, v9
    v_mul_u32_u24 v10, 10, v9
    v_sub_u32 v10, v8, v10
    v_add_u32 v9, s39, v9
    v_mul_u32_u24 v9, 1280, v9
    v_lshl_add_u32 v31, v10, 4, v9
    v_add_u32 v8, 128, v1
    v_mul_u32_u24 v9, 6554, v8
    v_lshrrev_b32 v9, 16, v9
    v_mul_u32_u24 v10, 10, v9
    v_sub_u32 v10, v8, v10
    v_add_u32 v9, s39, v9
    v_mul_u32_u24 v9, 1280, v9
    v_lshl_add_u32 v32, v10, 4, v9
    v_cmp_gt_u32 vcc, 32, v1
    v_mov_b32 v8, 0x7ffffff0
    s_nop 0
    v_cndmask_b32 v32, v8, v32, vcc
    s_waitcnt vmcnt(9)
    s_barrier
    ds_read_b128 v[56:59], v4 offset:0
    ds_read_b128 v[60:63], v4 offset:1024
    ds_read_b128 v[64:67], v4 offset:2048
    ds_read_b128 v[68:71], v4 offset:3072
    ds_read_b128 v[72:75], v4 offset:4096
    ds_read_b128 v[76:79], v4 offset:5120
    ds_read_b128 v[80:83], v4 offset:6144
    ds_read_b128 v[84:87], v4 offset:7168
    s_waitcnt lgkmcnt(7)
    v_lshlrev_b32 v116, 16, v164
    v_and_b32 v117, 0xffff0000, v164
    v_lshlrev_b32 v118, 16, v165
    v_and_b32 v119, 0xffff0000, v165
    v_lshlrev_b32 v120, 16, v166
    v_and_b32 v121, 0xffff0000, v166
    v_lshlrev_b32 v122, 16, v167
    v_and_b32 v123, 0xffff0000, v167
    v_lshlrev_b32 v124, 16, v168
    v_and_b32 v125, 0xffff0000, v168
    v_lshlrev_b32 v126, 16, v169
    v_and_b32 v127, 0xffff0000, v169
    v_lshlrev_b32 v128, 16, v170
    v_and_b32 v129, 0xffff0000, v170
    v_lshlrev_b32 v130, 16, v171
    v_and_b32 v131, 0xffff0000, v171
    v_lshlrev_b32 v132, 16, v172
    v_and_b32 v133, 0xffff0000, v172
    v_lshlrev_b32 v134, 16, v173
    v_and_b32 v135, 0xffff0000, v173
    s_nop 1
    v_mfma_f32_16x16x32_bf16 v[116:119], v[56:59], v[188:191], v[116:119]
    ds_read_b128 v[88:91], v4 offset:8192
    s_sub_u32 s14, s24, 3
    s_cselect_b32 s15, 5, 0
    s_add_u32 s14, s14, s15
    s_mul_i32 s14, s14, 4096
    s_add_u32 s14, s14, s40
    buffer_load_dwordx4 v[220:223], v4, s[20:23], s14 offen offset:0
    s_waitcnt lgkmcnt(7)
    v_mfma_f32_16x16x32_bf16 v[120:123], v[60:63], v[188:191], v[120:123]
    ds_read_b128 v[56:59], v4 offset:9216
    buffer_load_dwordx4 v[224:227], v4, s[20:23], s14 offen offset:1024
    s_waitcnt lgkmcnt(7)
    v_mfma_f32_16x16x32_bf16 v[124:127], v[64:67], v[188:191], v[124:127]
    ds_read_b128 v[60:63], v4 offset:10240
    buffer_load_dwordx4 v[228:231], v4, s[20:23], s14 offen offset:2048
    s_waitcnt lgkmcnt(7)
    v_mfma_f32_16x16x32_bf16 v[128:131], v[68:71], v[188:191], v[128:131]
    ds_read_b128 v[64:67], v4 offset:11264
    buffer_load_dwordx4 v[232:235], v4, s[20:23], s14 offen offset:3072
    s_waitcnt lgkmcnt(7)
    v_mfma_f32_16x16x32_bf16 v[132:135], v[72:75], v[188:191], v[132:135]
    ds_read_b128 v[68:71], v4 offset:12288
    s_sub_u32 s27, s24, 3
    s_cselect_b32 s15, 5, 0
    s_add_u32 s27, s27, s15
    s_mul_i32 s27, s27, 20480
    s_add_u32 s27, s27, s41
    s_add_u32 m0, s42, 40960
    s_add_u32 s36, s27, 0
    buffer_load_dwordx4 v4, s[20:23], s36 offen lds
    s_waitcnt lgkmcnt(7)
    v_mfma_f32_16x16x32_bf16 v[116:119], v[76:79], v[192:195], v[116:119]
    ds_read_b128 v[72:75], v4 offset:13312
    s_add_u32 m0, s42, 41984
    s_add_u32 s36, s27, 1024
    buffer_load_dwordx4 v4, s[20:23], s36 offen lds
    s_waitcnt lgkmcnt(7)
    v_mfma_f32_16x16x32_bf16 v[120:123], v[80:83], v[192:195], v[120:123]
    ds_read_b128 v[76:79], v4 offset:14336
    s_add_u32 m0, s42, 43008
    s_add_u32 s36, s27, 2048
    buffer_load_dwordx4 v4, s[20:23], s36 offen lds
    s_waitcnt lgkmcnt(7)
    v_mfma_f32_16x16x32_bf16 v[124:127], v[84:87], v[192:195], v[124:127]
    ds_read_b128 v[80:83], v4 offset:15360
    s_add_u32 m0, s42, 44032
    s_add_u32 s36, s27, 3072
    buffer_load_dwordx4 v4, s[20:23], s36 offen lds
    s_waitcnt lgkmcnt(7)
    v_mfma_f32_16x16x32_bf16 v[128:131], v[88:91], v[192:195], v[128:131]
    ds_read_b128 v[84:87], v4 offset:16384
    s_add_u32 m0, s42, 45056
    s_add_u32 s36, s27, 4096
    buffer_load_dwordx4 v4, s[20:23], s36 offen lds
    s_waitcnt lgkmcnt(7)
    v_mfma_f32_16x16x32_bf16 v[132:135], v[56:59], v[192:195], v[132:135]
    ds_read_b128 v[88:91], v4 offset:17408
    s_waitcnt lgkmcnt(7)
    v_mfma_f32_16x16x32_bf16 v[116:119], v[60:63], v[196:199], v[116:119]
    ds_read_b128 v[56:59], v4 offset:18432
    s_waitcnt lgkmcnt(7)
    v_mfma_f32_16x16x32_bf16 v[120:123], v[64:67], v[196:199], v[120:123]
    ds_read_b128 v[60:63], v4 offset:19456
    s_waitcnt lgkmcnt(7)
    v_mfma_f32_16x16x32_bf16 v[124:127], v[68:71], v[196:199], v[124:127]
    s_waitcnt vmcnt(9)
    s_barrier
    ds_read_b128 v[64:67], v4 offset:20480
    s_waitcnt lgkmcnt(7)
    v_mfma_f32_16x16x32_bf16 v[128:131], v[72:75], v[196:199], v[128:131]
    ds_read_b128 v[68:71], v4 offset:21504
    s_waitcnt lgkmcnt(7)
    v_mfma_f32_16x16x32_bf16 v[132:135], v[76:79], v[196:199], v[132:135]
    ds_read_b128 v[72:75], v4 offset:22528
    s_waitcnt lgkmcnt(7)
    v_mfma_f32_16x16x32_bf16 v[116:119], v[80:83], v[200:203], v[116:119]
    ds_read_b128 v[76:79], v4 offset:23552
    s_waitcnt lgkmcnt(7)
    v_mfma_f32_16x16x32_bf16 v[120:123], v[84:87], v[200:203], v[120:123]
    ds_read_b128 v[80:83], v4 offset:24576
    s_waitcnt lgkmcnt(7)
    v_mfma_f32_16x16x32_bf16 v[124:127], v[88:91], v[200:203], v[124:127]
    ds_read_b128 v[84:87], v4 offset:25600
    s_waitcnt lgkmcnt(7)
    v_mfma_f32_16x16x32_bf16 v[128:131], v[56:59], v[200:203], v[128:131]
    ds_read_b128 v[88:91], v4 offset:26624
    s_waitcnt lgkmcnt(7)
    v_mfma_f32_16x16x32_bf16 v[132:135], v[60:63], v[200:203], v[132:135]
    ds_read_b128 v[56:59], v4 offset:27648
    s_waitcnt lgkmcnt(7)
    v_mfma_f32_16x16x32_bf16 v[116:119], v[64:67], v[204:207], v[116:119]
    ds_read_b128 v[60:63], v4 offset:28672
    s_sub_u32 s14, s24, 2
    s_cselect_b32 s15, 5, 0
    s_add_u32 s14, s14, s15
    s_mul_i32 s14, s14, 4096
    s_add_u32 s14, s14, s40
    buffer_load_dwordx4 v[188:191], v4, s[20:23], s14 offen offset:0
    s_waitcnt lgkmcnt(7)
    v_mfma_f32_16x16x32_bf16 v[120:123], v[68:71], v[204:207], v[120:123]
    ds_read_b128 v[64:67], v4 offset:29696
    buffer_load_dwordx4 v[192:195], v4, s[20:23], s14 offen offset:1024
    s_waitcnt lgkmcnt(7)
    v_mfma_f32_16x16x32_bf16 v[124:127], v[72:75], v[204:207], v[124:127]
    ds_read_b128 v[68:71], v4 offset:30720
    buffer_load_dwordx4 v[196:199], v4, s[20:23], s14 offen offset:2048
    s_waitcnt lgkmcnt(7)
    v_mfma_f32_16x16x32_bf16 v[128:131], v[76:79], v[204:207], v[128:131]
    ds_read_b128 v[72:75], v4 offset:31744
    buffer_load_dwordx4 v[200:203], v4, s[20:23], s14 offen offset:3072
    s_waitcnt lgkmcnt(7)
    v_mfma_f32_16x16x32_bf16 v[132:135], v[80:83], v[204:207], v[132:135]
    ds_read_b128 v[76:79], v4 offset:32768
    s_sub_u32 s27, s24, 2
    s_cselect_b32 s15, 5, 0
    s_add_u32 s27, s27, s15
    s_mul_i32 s27, s27, 20480
    s_add_u32 s27, s27, s41
    s_add_u32 m0, s42, 61440
    s_add_u32 s36, s27, 0
    buffer_load_dwordx4 v4, s[20:23], s36 offen lds
    s_waitcnt lgkmcnt(7)
    v_mfma_f32_16x16x32_bf16 v[116:119], v[84:87], v[208:211], v[116:119]
    ds_read_b128 v[80:83], v4 offset:33792
    s_add_u32 m0, s42, 62464
    s_add_u32 s36, s27, 1024
    buffer_load_dwordx4 v4, s[20:23], s36 offen lds
    s_waitcnt lgkmcnt(7)
    v_mfma_f32_16x16x32_bf16 v[120:123], v[88:91], v[208:211], v[120:123]
    ds_read_b128 v[84:87], v4 offset:34816
    s_add_u32 m0, s42, 63488
    s_add_u32 s36, s27, 2048
    buffer_load_dwordx4 v4, s[20:23], s36 offen lds
    s_waitcnt lgkmcnt(7)
    v_mfma_f32_16x16x32_bf16 v[124:127], v[56:59], v[208:211], v[124:127]
    ds_read_b128 v[88:91], v4 offset:35840
    s_add_u32 m0, s42, 64512
    s_add_u32 s36, s27, 3072
    buffer_load_dwordx4 v4, s[20:23], s36 offen lds
    s_waitcnt lgkmcnt(7)
    v_mfma_f32_16x16x32_bf16 v[128:131], v[60:63], v[208:211], v[128:131]
    ds_read_b128 v[56:59], v4 offset:36864
    s_add_u32 m0, s42, 65536
    s_add_u32 s36, s27, 4096
    buffer_load_dwordx4 v4, s[20:23], s36 offen lds
    s_waitcnt lgkmcnt(7)
    v_mfma_f32_16x16x32_bf16 v[132:135], v[64:67], v[208:211], v[132:135]
    ds_read_b128 v[60:63], v4 offset:37888
    s_waitcnt lgkmcnt(7)
    v_mfma_f32_16x16x32_bf16 v[116:119], v[68:71], v[212:215], v[116:119]
    ds_read_b128 v[64:67], v4 offset:38912
    s_waitcnt lgkmcnt(7)
    v_mfma_f32_16x16x32_bf16 v[120:123], v[72:75], v[212:215], v[120:123]
    ds_read_b128 v[68:71], v4 offset:39936
    s_waitcnt lgkmcnt(7)
    v_mfma_f32_16x16x32_bf16 v[124:127], v[76:79], v[212:215], v[124:127]
    s_waitcnt vmcnt(9)
    s_barrier
    ds_read_b128 v[72:75], v4 offset:40960
    s_waitcnt lgkmcnt(7)
    v_mfma_f32_16x16x32_bf16 v[128:131], v[80:83], v[212:215], v[128:131]
    ds_read_b128 v[76:79], v4 offset:41984
    s_waitcnt lgkmcnt(7)
    v_mfma_f32_16x16x32_bf16 v[132:135], v[84:87], v[212:215], v[132:135]
    ds_read_b128 v[80:83], v4 offset:43008
    s_waitcnt lgkmcnt(7)
    v_mfma_f32_16x16x32_bf16 v[116:119], v[88:91], v[216:219], v[116:119]
    ds_read_b128 v[84:87], v4 offset:44032
    s_waitcnt lgkmcnt(7)
    v_mfma_f32_16x16x32_bf16 v[120:123], v[56:59], v[216:219], v[120:123]
    ds_read_b128 v[88:91], v4 offset:45056
    s_waitcnt lgkmcnt(7)
    v_mfma_f32_16x16x32_bf16 v[124:127], v[60:63], v[216:219], v[124:127]
    ds_read_b128 v[56:59], v4 offset:46080
    s_waitcnt lgkmcnt(7)
    v_mfma_f32_16x16x32_bf16 v[128:131], v[64:67], v[216:219], v[128:131]
    ds_read_b128 v[60:63], v4 offset:47104
    s_waitcnt lgkmcnt(7)
    v_mfma_f32_16x16x32_bf16 v[132:135], v[68:71], v[216:219], v[132:135]
    ds_read_b128 v[64:67], v4 offset:48128
    s_waitcnt lgkmcnt(7)
    v_mfma_f32_16x16x32_bf16 v[116:119], v[72:75], v[220:223], v[116:119]
    ds_read_b128 v[68:71], v4 offset:49152
    s_sub_u32 s14, s24, 1
    s_cselect_b32 s15, 5, 0
    s_add_u32 s14, s14, s15
    s_mul_i32 s14, s14, 4096
    s_add_u32 s14, s14, s40
    buffer_load_dwordx4 v[204:207], v4, s[20:23], s14 offen offset:0
    s_waitcnt lgkmcnt(7)
    v_mfma_f32_16x16x32_bf16 v[120:123], v[76:79], v[220:223], v[120:123]
    ds_read_b128 v[72:75], v4 offset:50176
    buffer_load_dwordx4 v[208:211], v4, s[20:23], s14 offen offset:1024
    s_waitcnt lgkmcnt(7)
    v_mfma_f32_16x16x32_bf16 v[124:127], v[80:83], v[220:223], v[124:127]
    ds_read_b128 v[76:79], v4 offset:51200
    buffer_load_dwordx4 v[212:215], v4, s[20:23], s14 offen offset:2048
    s_waitcnt lgkmcnt(7)
    v_mfma_f32_16x16x32_bf16 v[128:131], v[84:87], v[220:223], v[128:131]
    ds_read_b128 v[80:83], v4 offset:52224
    buffer_load_dwordx4 v[216:219], v4, s[20:23], s14 offen offset:3072
    s_waitcnt lgkmcnt(7)
    v_mfma_f32_16x16x32_bf16 v[132:135], v[88:91], v[220:223], v[132:135]
    ds_read_b128 v[84:87], v4 offset:53248
    s_sub_u32 s27, s24, 1
    s_cselect_b32 s15, 5, 0
    s_add_u32 s27, s27, s15
    s_mul_i32 s27, s27, 20480
    s_add_u32 s27, s27, s41
    s_add_u32 m0, s42, 0
    s_add_u32 s36, s27, 0
    buffer_load_dwordx4 v4, s[20:23], s36 offen lds
    s_waitcnt lgkmcnt(7)
    v_mfma_f32_16x16x32_bf16 v[116:119], v[56:59], v[224:227], v[116:119]
    ds_read_b128 v[88:91], v4 offset:54272
    s_add_u32 m0, s42, 1024
    s_add_u32 s36, s27, 1024
    buffer_load_dwordx4 v4, s[20:23], s36 offen lds
    s_waitcnt lgkmcnt(7)
    v_mfma_f32_16x16x32_bf16 v[120:123], v[60:63], v[224:227], v[120:123]
    ds_read_b128 v[56:59], v4 offset:55296
    s_add_u32 m0, s42, 2048
    s_add_u32 s36, s27, 2048
    buffer_load_dwordx4 v4, s[20:23], s36 offen lds
    s_waitcnt lgkmcnt(7)
    v_mfma_f32_16x16x32_bf16 v[124:127], v[64:67], v[224:227], v[124:127]
    ds_read_b128 v[60:63], v4 offset:56320
    s_add_u32 m0, s42, 3072
    s_add_u32 s36, s27, 3072
    buffer_load_dwordx4 v4, s[20:23], s36 offen lds
    s_waitcnt lgkmcnt(7)
    v_mfma_f32_16x16x32_bf16 v[128:131], v[68:71], v[224:227], v[128:131]
    ds_read_b128 v[64:67], v4 offset:57344
    s_add_u32 m0, s42, 4096
    s_add_u32 s36, s27, 4096
    buffer_load_dwordx4 v4, s[20:23], s36 offen lds
    s_waitcnt lgkmcnt(7)
    v_mfma_f32_16x16x32_bf16 v[132:135], v[72:75], v[224:227], v[132:135]
    ds_read_b128 v[68:71], v4 offset:58368
    s_waitcnt lgkmcnt(7)
    v_mfma_f32_16x16x32_bf16 v[116:119], v[76:79], v[228:231], v[116:119]
    ds_read_b128 v[72:75], v4 offset:59392
    s_waitcnt lgkmcnt(7)
    v_mfma_f32_16x16x32_bf16 v[120:123], v[80:83], v[228:231], v[120:123]
    ds_read_b128 v[76:79], v4 offset:60416
    s_waitcnt lgkmcnt(7)
    v_mfma_f32_16x16x32_bf16 v[124:127], v[84:87], v[228:231], v[124:127]
    s_waitcnt vmcnt(9)
    s_barrier
    ds_read_b128 v[80:83], v18 offset:0
    s_waitcnt lgkmcnt(7)
    v_mfma_f32_16x16x32_bf16 v[128:131], v[88:91], v[228:231], v[128:131]
    ds_read_b128 v[84:87], v18 offset:1024
    s_waitcnt lgkmcnt(7)
    v_mfma_f32_16x16x32_bf16 v[132:135], v[56:59], v[228:231], v[132:135]
    ds_read_b128 v[88:91], v18 offset:2048
    s_waitcnt lgkmcnt(7)
    v_mfma_f32_16x16x32_bf16 v[116:119], v[60:63], v[232:235], v[116:119]
    ds_read_b128 v[56:59], v18 offset:3072
    s_waitcnt lgkmcnt(7)
    v_mfma_f32_16x16x32_bf16 v[120:123], v[64:67], v[232:235], v[120:123]
    ds_read_b128 v[60:63], v18 offset:4096
    s_waitcnt lgkmcnt(7)
    v_mfma_f32_16x16x32_bf16 v[124:127], v[68:71], v[232:235], v[124:127]
    ds_read_b128 v[64:67], v18 offset:5120
    s_waitcnt lgkmcnt(7)
    v_mfma_f32_16x16x32_bf16 v[128:131], v[72:75], v[232:235], v[128:131]
    ds_read_b128 v[68:71], v18 offset:6144
    s_waitcnt lgkmcnt(7)
    v_mfma_f32_16x16x32_bf16 v[132:135], v[76:79], v[232:235], v[132:135]
    ds_read_b128 v[72:75], v18 offset:7168
    s_waitcnt lgkmcnt(7)
    v_mfma_f32_16x16x32_bf16 v[116:119], v[80:83], v[188:191], v[116:119]
    ds_read_b128 v[76:79], v18 offset:8192
    s_sub_u32 s27, s25, 10
    s_cselect_b32 s15, 10, 0
    s_add_u32 s27, s27, s15
    s_mul_i32 s27, s27, 12288
    s_add_u32 s27, s27, s49
    s_add_u32 m0, s50, 81920
    s_add_u32 s36, s27, 0
    buffer_load_dwordx4 v4, s[20:23], s36 offen lds
    s_waitcnt lgkmcnt(7)
    v_mfma_f32_16x16x32_bf16 v[120:123], v[84:87], v[188:191], v[120:123]
    ds_read_b128 v[80:83], v18 offset:9216
    s_add_u32 m0, s50, 82944
    s_add_u32 s36, s27, 1024
    buffer_load_dwordx4 v4, s[20:23], s36 offen lds
    s_waitcnt lgkmcnt(7)
    v_mfma_f32_16x16x32_bf16 v[124:127], v[88:91], v[188:191], v[124:127]
    ds_read_b128 v[84:87], v18 offset:10240
    s_add_u32 m0, s50, 83968
    s_add_u32 s36, s27, 2048
    buffer_load_dwordx4 v4, s[20:23], s36 offen lds
    s_waitcnt lgkmcnt(7)
    v_mfma_f32_16x16x32_bf16 v[128:131], v[56:59], v[188:191], v[128:131]
    ds_read_b128 v[88:91], v18 offset:11264
    s_sub_u32 s27, s25, 9
    s_cselect_b32 s15, 10, 0
    s_add_u32 s27, s27, s15
    s_mul_i32 s27, s27, 12288
    s_add_u32 s27, s27, s49
    s_add_u32 m0, s50, 94208
    s_add_u32 s36, s27, 0
    buffer_load_dwordx4 v4, s[20:23], s36 offen lds
    s_waitcnt lgkmcnt(7)
    v_mfma_f32_16x16x32_bf16 v[132:135], v[60:63], v[188:191], v[132:135]
    ds_read_b128 v[56:59], v18 offset:12288
    s_add_u32 m0, s50, 95232
    s_add_u32 s36, s27, 1024
    buffer_load_dwordx4 v4, s[20:23], s36 offen lds
    s_waitcnt lgkmcnt(7)
    v_mfma_f32_16x16x32_bf16 v[116:119], v[64:67], v[192:195], v[116:119]
    ds_read_b128 v[60:63], v18 offset:13312
    s_add_u32 m0, s50, 96256
    s_add_u32 s36, s27, 2048
    buffer_load_dwordx4 v4, s[20:23], s36 offen lds
    s_waitcnt lgkmcnt(7)
    v_mfma_f32_16x16x32_bf16 v[120:123], v[68:71], v[192:195], v[120:123]
    ds_read_b128 v[64:67], v18 offset:14336
    s_sub_u32 s27, s25, 8
    s_cselect_b32 s15, 10, 0
    s_add_u32 s27, s27, s15
    s_mul_i32 s27, s27, 12288
    s_add_u32 s27, s27, s49
    s_add_u32 m0, s50, 106496
    s_add_u32 s36, s27, 0
    buffer_load_dwordx4 v4, s[20:23], s36 offen lds
    s_waitcnt lgkmcnt(7)
    v_mfma_f32_16x16x32_bf16 v[124:127], v[72:75], v[192:195], v[124:127]
    ds_read_b128 v[68:71], v18 offset:15360
    s_add_u32 m0, s50, 107520
    s_add_u32 s36, s27, 1024
    buffer_load_dwordx4 v4, s[20:23], s36 offen lds
    s_waitcnt lgkmcnt(7)
    v_mfma_f32_16x16x32_bf16 v[128:131], v[76:79], v[192:195], v[128:131]
    ds_read_b128 v[72:75], v18 offset:16384
    s_add_u32 m0, s50, 108544
    s_add_u32 s36, s27, 2048
    buffer_load_dwordx4 v4, s[20:23], s36 offen lds
    s_waitcnt lgkmcnt(7)
    v_mfma_f32_16x16x32_bf16 v[132:135], v[80:83], v[192:195], v[132:135]
    ds_read_b128 v[76:79], v18 offset:17408
    s_sub_u32 s27, s25, 7
    s_cselect_b32 s15, 10, 0
    s_add_u32 s27, s27, s15
    s_mul_i32 s27, s27, 12288
    s_add_u32 s27, s27, s49
    s_add_u32 m0, s50, 118784
    s_add_u32 s36, s27, 0
    buffer_load_dwordx4 v4, s[20:23], s36 offen lds
    s_waitcnt lgkmcnt(7)
    v_mfma_f32_16x16x32_bf16 v[116:119], v[84:87], v[196:199], v[116:119]
    ds_read_b128 v[80:83], v18 offset:18432
    s_add_u32 m0, s50, 119808
    s_add_u32 s36, s27, 1024
    buffer_load_dwordx4 v4, s[20:23], s36 offen lds
    s_waitcnt lgkmcnt(7)
    v_mfma_f32_16x16x32_bf16 v[120:123], v[88:91], v[196:199], v[120:123]
    ds_read_b128 v[84:87], v18 offset:19456
    s_add_u32 m0, s50, 120832
    s_add_u32 s36, s27, 2048
    buffer_load_dwordx4 v4, s[20:23], s36 offen lds
    s_waitcnt lgkmcnt(7)
    v_mfma_f32_16x16x32_bf16 v[124:127], v[56:59], v[196:199], v[124:127]
    s_waitcnt vmcnt(12)
    s_barrier
    ds_read_b128 v[88:91], v4 offset:0
    s_sub_u32 s27, s25, 6
    s_cselect_b32 s15, 10, 0
    s_add_u32 s27, s27, s15
    s_mul_i32 s27, s27, 12288
    s_add_u32 s27, s27, s49
    s_add_u32 m0, s50, 131072
    s_add_u32 s36, s27, 0
    buffer_load_dwordx4 v4, s[20:23], s36 offen lds
    s_waitcnt lgkmcnt(7)
    v_mfma_f32_16x16x32_bf16 v[128:131], v[60:63], v[196:199], v[128:131]
    ds_read_b128 v[56:59], v4 offset:1024
    s_add_u32 m0, s50, 132096
    s_add_u32 s36, s27, 1024
    buffer_load_dwordx4 v4, s[20:23], s36 offen lds
    s_waitcnt lgkmcnt(7)
    v_mfma_f32_16x16x32_bf16 v[132:135], v[64:67], v[196:199], v[132:135]
    ds_read_b128 v[60:63], v4 offset:2048
    s_add_u32 m0, s50, 133120
    s_add_u32 s36, s27, 2048
    buffer_load_dwordx4 v4, s[20:23], s36 offen lds
    s_waitcnt lgkmcnt(7)
    v_mfma_f32_16x16x32_bf16 v[116:119], v[68:71], v[200:203], v[116:119]
    ds_read_b128 v[64:67], v4 offset:3072
    s_sub_u32 s27, s25, 5
    s_cselect_b32 s15, 10, 0
    s_add_u32 s27, s27, s15
    s_mul_i32 s27, s27, 12288
    s_add_u32 s27, s27, s49
    s_add_u32 m0, s50, 143360
    s_add_u32 s36, s27, 0
    buffer_load_dwordx4 v4, s[20:23], s36 offen lds
    s_waitcnt lgkmcnt(7)
    v_mfma_f32_16x16x32_bf16 v[120:123], v[72:75], v[200:203], v[120:123]
    ds_read_b128 v[68:71], v4 offset:4096
    s_add_u32 m0, s50, 144384
    s_add_u32 s36, s27, 1024
    buffer_load_dwordx4 v4, s[20:23], s36 offen lds
    s_waitcnt lgkmcnt(7)
    v_mfma_f32_16x16x32_bf16 v[124:127], v[76:79], v[200:203], v[124:127]
    ds_read_b128 v[72:75], v4 offset:5120
    s_add_u32 m0, s50, 145408
    s_add_u32 s36, s27, 2048
    buffer_load_dwordx4 v4, s[20:23], s36 offen lds
    s_waitcnt lgkmcnt(7)
    v_mfma_f32_16x16x32_bf16 v[128:131], v[80:83], v[200:203], v[128:131]
    ds_read_b128 v[76:79], v4 offset:6144
    s_waitcnt lgkmcnt(7)
    v_mfma_f32_16x16x32_bf16 v[132:135], v[84:87], v[200:203], v[132:135]
    ds_read_b128 v[80:83], v4 offset:7168
    s_waitcnt lgkmcnt(7)
    v_mfma_f32_16x16x32_bf16 v[116:119], v[88:91], v[204:207], v[116:119]
    ds_read_b128 v[84:87], v4 offset:8192
    s_waitcnt lgkmcnt(7)
    v_mfma_f32_16x16x32_bf16 v[120:123], v[56:59], v[204:207], v[120:123]
    ds_read_b128 v[88:91], v4 offset:9216
    s_waitcnt lgkmcnt(7)
    v_mfma_f32_16x16x32_bf16 v[124:127], v[60:63], v[204:207], v[124:127]
    ds_read_b128 v[56:59], v4 offset:10240
    s_waitcnt lgkmcnt(7)
    v_mfma_f32_16x16x32_bf16 v[128:131], v[64:67], v[204:207], v[128:131]
    ds_read_b128 v[60:63], v4 offset:11264
    s_waitcnt lgkmcnt(7)
    v_mfma_f32_16x16x32_bf16 v[132:135], v[68:71], v[204:207], v[132:135]
    ds_read_b128 v[64:67], v4 offset:12288
    s_waitcnt lgkmcnt(7)
    v_mfma_f32_16x16x32_bf16 v[116:119], v[72:75], v[208:211], v[116:119]
    ds_read_b128 v[68:71], v4 offset:13312
    s_waitcnt lgkmcnt(7)
    v_mfma_f32_16x16x32_bf16 v[120:123], v[76:79], v[208:211], v[120:123]
    ds_read_b128 v[72:75], v4 offset:14336
    s_waitcnt lgkmcnt(7)
    v_mfma_f32_16x16x32_bf16 v[124:127], v[80:83], v[208:211], v[124:127]
    ds_read_b128 v[76:79], v4 offset:15360
    s_waitcnt lgkmcnt(7)
    v_mfma_f32_16x16x32_bf16 v[128:131], v[84:87], v[208:211], v[128:131]
    ds_read_b128 v[80:83], v4 offset:16384
    s_waitcnt lgkmcnt(7)
    v_mfma_f32_16x16x32_bf16 v[132:135], v[88:91], v[208:211], v[132:135]
    ds_read_b128 v[84:87], v4 offset:17408
    s_waitcnt lgkmcnt(7)
    v_mfma_f32_16x16x32_bf16 v[116:119], v[56:59], v[212:215], v[116:119]
    ds_read_b128 v[88:91], v4 offset:18432
    s_waitcnt lgkmcnt(7)
    v_mfma_f32_16x16x32_bf16 v[120:123], v[60:63], v[212:215], v[120:123]
    ds_read_b128 v[56:59], v4 offset:19456
    s_waitcnt lgkmcnt(7)
    v_mfma_f32_16x16x32_bf16 v[124:127], v[64:67], v[212:215], v[124:127]
    s_waitcnt lgkmcnt(6)
    v_mfma_f32_16x16x32_bf16 v[128:131], v[68:71], v[212:215], v[128:131]
    s_waitcnt lgkmcnt(5)
    v_mfma_f32_16x16x32_bf16 v[132:135], v[72:75], v[212:215], v[132:135]
    s_waitcnt lgkmcnt(4)
    v_mfma_f32_16x16x32_bf16 v[116:119], v[76:79], v[216:219], v[116:119]
    s_waitcnt lgkmcnt(3)
    v_mfma_f32_16x16x32_bf16 v[120:123], v[80:83], v[216:219], v[120:123]
    s_waitcnt lgkmcnt(2)
    v_mfma_f32_16x16x32_bf16 v[124:127], v[84:87], v[216:219], v[124:127]
    s_waitcnt lgkmcnt(1)
    v_mfma_f32_16x16x32_bf16 v[128:131], v[88:91], v[216:219], v[128:131]
    s_waitcnt lgkmcnt(0)
    v_mfma_f32_16x16x32_bf16 v[132:135], v[56:59], v[216:219], v[132:135]
    s_nop 3
    v_cvt_pk_bf16_f32 v20, v116, v117
    v_cvt_pk_bf16_f32 v21, v118, v119
    v_cvt_pk_bf16_f32 v22, v120, v121
    v_cvt_pk_bf16_f32 v23, v122, v123
    v_cvt_pk_bf16_f32 v24, v124, v125
    v_cvt_pk_bf16_f32 v25, v126, v127
    v_cvt_pk_bf16_f32 v26, v128, v129
    v_cvt_pk_bf16_f32 v27, v130, v131
    v_cvt_pk_bf16_f32 v28, v132, v133
    v_cvt_pk_bf16_f32 v29, v134, v135
    v_mov_b32 v56, v20
    v_mov_b32 v57, v21
    v_mov_b32 v58, v22
    v_mov_b32 v59, v23
    v_mov_b32 v60, v24
    v_mov_b32 v61, v25
    v_mov_b32 v62, v26
    v_mov_b32 v63, v27
    v_mov_b32 v64, v28
    v_mov_b32 v65, v29
    v_mov_b32 v66, v28
    v_mov_b32 v67, v29
    v_permlane16_swap_b32 v56, v58
    v_permlane16_swap_b32 v57, v59
    buffer_store_dwordx4 v[56:59], v12, s[20:23], s53 offen offset:0 sc1
    v_permlane16_swap_b32 v60, v62
    v_permlane16_swap_b32 v61, v63
    buffer_store_dwordx4 v[60:63], v12, s[20:23], s53 offen offset:2048 sc1
    v_permlane16_swap_b32 v64, v66
    v_permlane16_swap_b32 v65, v67
    buffer_store_dwordx4 v[64:67], v13, s[20:23], s53 offen sc1
    v_dot2_f32_bf16 v16, v20, v7, v16
    v_dot2_f32_bf16 v17, v20, v20, v17
    v_dot2_f32_bf16 v16, v21, v7, v16
    v_dot2_f32_bf16 v17, v21, v21, v17
    v_dot2_f32_bf16 v16, v22, v7, v16
    v_dot2_f32_bf16 v17, v22, v22, v17
    v_dot2_f32_bf16 v16, v23, v7, v16
    v_dot2_f32_bf16 v17, v23, v23, v17
    v_dot2_f32_bf16 v16, v24, v7, v16
    v_dot2_f32_bf16 v17, v24, v24, v17
    v_dot2_f32_bf16 v16, v25, v7, v16
    v_dot2_f32_bf16 v17, v25, v25, v17
    v_dot2_f32_bf16 v16, v26, v7, v16
    v_dot2_f32_bf16 v17, v26, v26, v17
    v_dot2_f32_bf16 v16, v27, v7, v16
    v_dot2_f32_bf16 v17, v27, v27, v17
    v_dot2_f32_bf16 v16, v28, v7, v16
    v_dot2_f32_bf16 v17, v28, v28, v17
    v_dot2_f32_bf16 v16, v29, v7, v16
    v_dot2_f32_bf16 v17, v29, v29, v17
    s_nop 2
    v_mov_b32 v8, v16
    v_mov_b32 v9, v17
    s_nop 0
    v_permlane16_swap_b32 v16, v8
    v_permlane16_swap_b32 v17, v9
    v_add_f32 v16, v16, v8
    v_add_f32 v17, v17, v9
    v_mov_b32 v8, v16
    v_mov_b32 v9, v17
    s_nop 0
    v_permlane32_swap_b32 v16, v8
    v_permlane32_swap_b32 v17, v9
    v_add_f32 v16, v16, v8
    v_add_f32 v17, v17, v9
    s_lshl_b32 s35, s38, 14
    s_add_u32 s35, s35, 22151168
    buffer_store_dwordx2 v[16:17], v15, s[20:23], s35 offen sc1
    s_waitcnt vmcnt(0)
    s_barrier
    v_mov_b32 v8, 0
    v_mov_b32 v9, 1
    s_cmp_lg_u32 s34, 0
    s_cbranch_scc1 k3_kernel_na1
    s_mov_b64 exec, 1
    buffer_atomic_add v9, v8, s[20:23], s56 offen offset:0
    s_mov_b64 exec, -1
k3_kernel_na1:
    s_sub_u32 s27, s25, 4
    s_cselect_b32 s15, 10, 0
    s_add_u32 s27, s27, s15
    s_mul_i32 s27, s27, 12288
    s_add_u32 s27, s27, s49
    s_add_u32 m0, s50, 0
    s_add_u32 s36, s27, 0
    buffer_load_dwordx4 v4, s[20:23], s36 offen lds
    s_add_u32 m0, s50, 1024
    s_add_u32 s36, s27, 1024
    buffer_load_dwordx4 v4, s[20:23], s36 offen lds
    s_add_u32 m0, s50, 2048
    s_add_u32 s36, s27, 2048
    buffer_load_dwordx4 v4, s[20:23], s36 offen lds
    s_sub_u32 s27, s25, 3
    s_cselect_b32 s15, 10, 0
    s_add_u32 s27, s27, s15
    s_mul_i32 s27, s27, 12288
    s_add_u32 s27, s27, s49
    s_add_u32 m0, s50, 12288
    s_add_u32 s36, s27, 0
    buffer_load_dwordx4 v4, s[20:23], s36 offen lds
    s_add_u32 m0, s50, 13312
    s_add_u32 s36, s27, 1024
    buffer_load_dwordx4 v4, s[20:23], s36 offen lds
    s_add_u32 m0, s50, 14336
    s_add_u32 s36, s27, 2048
    buffer_load_dwordx4 v4, s[20:23], s36 offen lds
    s_sub_u32 s27, s25, 2
    s_cselect_b32 s15, 10, 0
    s_add_u32 s27, s27, s15
    s_mul_i32 s27, s27, 12288
    s_add_u32 s27, s27, s49
    s_add_u32 m0, s50, 24576
    s_add_u32 s36, s27, 0
    buffer_load_dwordx4 v4, s[20:23], s36 offen lds
    s_add_u32 m0, s50, 25600
    s_add_u32 s36, s27, 1024
    buffer_load_dwordx4 v4, s[20:23], s36 offen lds
    s_add_u32 m0, s50, 26624
    s_add_u32 s36, s27, 2048
    buffer_load_dwordx4 v4, s[20:23], s36 offen lds
    s_sub_u32 s27, s25, 1
    s_cselect_b32 s15, 10, 0
    s_add_u32 s27, s27, s15
    s_mul_i32 s27, s27, 12288
    s_add_u32 s27, s27, s49
    s_add_u32 m0, s50, 36864
    s_add_u32 s36, s27, 0
    buffer_load_dwordx4 v4, s[20:23], s36 offen lds
    s_add_u32 m0, s50, 37888
    s_add_u32 s36, s27, 1024
    buffer_load_dwordx4 v4, s[20:23], s36 offen lds
    s_add_u32 m0, s50, 38912
    s_add_u32 s36, s27, 2048
    buffer_load_dwordx4 v4, s[20:23], s36 offen lds
    s_add_u32 s36, s59, 0
    buffer_load_dwordx4 v[164:167], v4, s[20:23], s36 offen
    s_add_u32 s36, s59, 1024
    buffer_load_dwordx4 v[168:171], v4, s[20:23], s36 offen
    s_add_u32 s36, s59, 2048
    buffer_load_dwordx4 v[172:175], v4, s[20:23], s36 offen
    s_add_u32 s36, s59, 3072
    buffer_load_dwordx4 v[176:179], v4, s[20:23], s36 offen
    s_add_u32 s36, s59, 4096
    buffer_load_dwordx4 v[180:183], v4, s[20:23], s36 offen
    s_add_u32 s36, s59, 5120
    buffer_load_dwordx4 v[184:187], v4, s[20:23], s36 offen
    s_cmp_lg_u32 s34, 0
    s_cbranch_scc1 k3_kernel_np2
    s_mov_b32 s57, 0x40000
k3_kernel_poll3:
    buffer_load_dword v9, v8, s[20:23], s56 offen offset:0 sc1
    s_waitcnt vmcnt(0)
    v_readfirstlane_b32 s35, v9
    s_sub_u32 s57, s57, 1
    s_cmp_eq_u32 s57, 0
    s_cbranch_scc1 k3_kernel_np2
    s_cmp_lt_u32 s35, 16
    s_cbranch_scc1 k3_kernel_poll3
k3_kernel_np2:
    s_waitcnt vmcnt(18)
    s_barrier
    s_sub_u32 s14, s25, 10
    s_cselect_b32 s15, 10, 0
    s_add_u32 s14, s14, s15
    s_mul_i32 s14, s14, 4096
    s_add_u32 s14, s14, s48
    buffer_load_dwordx4 v[188:191], v4, s[20:23], s14 offen offset:0 sc1
    buffer_load_dwordx4 v[192:195], v4, s[20:23], s14 offen offset:1024 sc1
    buffer_load_dwordx4 v[196:199], v4, s[20:23], s14 offen offset:2048 sc1
    buffer_load_dwordx4 v[200:203], v4, s[20:23], s14 offen offset:3072 sc1
    s_add_u32 s36, s43, 0
    buffer_load_dwordx2 v[40:41], v37, s[20:23], s36 offen sc1
    s_add_u32 s36, s43, 16384
    buffer_load_dwordx2 v[42:43], v37, s[20:23], s36 offen sc1
    s_add_u32 s36, s43, 32768
    buffer_load_dwordx2 v[44:45], v37, s[20:23], s36 offen sc1
    s_add_u32 s36, s43, 49152
    buffer_load_dwordx2 v[46:47], v37, s[20:23], s36 offen sc1
    s_sub_u32 s14, s25, 9
    s_cselect_b32 s15, 10, 0
    s_add_u32 s14, s14, s15
    s_mul_i32 s14, s14, 4096
    s_add_u32 s14, s14, s48
    buffer_load_dwordx4 v[204:207], v4, s[20:23], s14 offen offset:0 sc1
    buffer_load_dwordx4 v[208:211], v4, s[20:23], s14 offen offset:1024 sc1
    ds_read_b128 v[56:59], v18 offset:20480
    ds_read_b128 v[60:63], v18 offset:21504
    ds_read_b128 v[64:67], v18 offset:22528
    ds_read_b128 v[68:71], v18 offset:23552
    ds_read_b128 v[72:75], v18 offset:24576
    ds_read_b128 v[76:79], v18 offset:25600
    s_waitcnt lgkmcnt(5)
    s_waitcnt vmcnt(9)
    v_mfma_f32_32x32x16_bf16 v[116:131], v[56:59], v[188:191], 0
    ds_read_b128 v[80:83], v18 offset:26624
    buffer_load_dwordx4 v[212:215], v4, s[20:23], s14 offen offset:2048 sc1
    s_waitcnt lgkmcnt(5)
    v_mfma_f32_32x32x16_bf16 v[132:147], v[60:63], v[188:191], 0
    ds_read_b128 v[56:59], v18 offset:27648
    buffer_load_dwordx4 v[216:219], v4, s[20:23], s14 offen offset:3072 sc1
    s_waitcnt lgkmcnt(5)
    v_mfma_f32_32x32x16_bf16 v[148:163], v[64:67], v[188:191], 0
    ds_read_b128 v[60:63], v18 offset:28672
    s_sub_u32 s14, s25, 8
    s_cselect_b32 s15, 10, 0
    s_add_u32 s14, s14, s15
    s_mul_i32 s14, s14, 4096
    s_add_u32 s14, s14, s48
    buffer_load_dwordx4 v[220:223], v4, s[20:23], s14 offen offset:0 sc1
    s_waitcnt lgkmcnt(5)
    s_waitcnt vmcnt(11)
    v_mfma_f32_32x32x16_bf16 v[116:131], v[68:71], v[192:195], v[116:131]
    ds_read_b128 v[64:67], v18 offset:29696
    buffer_load_dwordx4 v[224:227], v4, s[20:23], s14 offen offset:1024 sc1
    s_waitcnt lgkmcnt(5)
    v_mfma_f32_32x32x16_bf16 v[132:147], v[72:75], v[192:195], v[132:147]
    ds_read_b128 v[68:71], v18 offset:30720
    buffer_load_dwordx4 v[228:231], v4, s[20:23], s14 offen offset:2048 sc1
    s_waitcnt lgkmcnt(5)
    v_mfma_f32_32x32x16_bf16 v[148:163], v[76:79], v[192:195], v[148:163]
    ds_read_b128 v[72:75], v18 offset:31744
    buffer_load_dwordx4 v[232:235], v4, s[20:23], s14 offen offset:3072 sc1
    s_waitcnt lgkmcnt(5)
    s_waitcnt vmcnt(13)
    v_mfma_f32_32x32x16_bf16 v[116:131], v[80:83], v[196:199], v[116:131]
    ds_read_b128 v[76:79], v18 offset:32768
    s_sub_u32 s14, s25, 7
    s_cselect_b32 s15, 10, 0
    s_add_u32 s14, s14, s15
    s_mul_i32 s14, s14, 4096
    s_add_u32 s14, s14, s48
    buffer_load_dwordx4 v[236:239], v4, s[20:23], s14 offen offset:0 sc1
    s_waitcnt lgkmcnt(5)
    v_mfma_f32_32x32x16_bf16 v[132:147], v[56:59], v[196:199], v[132:147]
    ds_read_b128 v[80:83], v18 offset:33792
    buffer_load_dwordx4 v[240:243], v4, s[20:23], s14 offen offset:1024 sc1
    s_sub_u32 s27, s26, 12
    s_cselect_b32 s15, 12, 0
    s_add_u32 s27, s27, s15
    s_mul_i32 s27, s27, 20480
    s_add_u32 s27, s27, s52
    s_add_u32 m0, s42, 61440
    s_add_u32 s36, s27, 0
    buffer_load_dwordx4 v4, s[20:23], s36 offen lds
    s_waitcnt lgkmcnt(5)
    v_mfma_f32_32x32x16_bf16 v[148:163], v[60:63], v[196:199], v[148:163]
    ds_read_b128 v[56:59], v18 offset:34816
    buffer_load_dwordx4 v[244:247], v4, s[20:23], s14 offen offset:2048 sc1
    s_add_u32 m0, s42, 62464
    s_add_u32 s36, s27, 1024
    buffer_load_dwordx4 v4, s[20:23], s36 offen lds
    s_waitcnt lgkmcnt(5)
    s_waitcnt vmcnt(17)
    v_mfma_f32_32x32x16_bf16 v[116:131], v[64:67], v[200:203], v[116:131]
    ds_read_b128 v[60:63], v18 offset:35840
    buffer_load_dwordx4 v[248:251], v4, s[20:23], s14 offen offset:3072 sc1
    s_waitcnt lgkmcnt(5)
    v_mfma_f32_32x32x16_bf16 v[132:147], v[68:71], v[200:203], v[132:147]
    ds_read_b128 v[64:67], v18 offset:36864
    s_sub_u32 s14, s25, 6
    s_cselect_b32 s15, 10, 0
    s_add_u32 s14, s14, s15
    s_mul_i32 s14, s14, 4096
    s_add_u32 s14, s14, s48
    buffer_load_dwordx4 v[188:191], v4, s[20:23], s14 offen offset:0 sc1
    s_add_u32 m0, s42, 63488
    s_add_u32 s36, s27, 2048
    buffer_load_dwordx4 v4, s[20:23], s36 offen lds
    s_waitcnt lgkmcnt(5)
    v_mfma_f32_32x32x16_bf16 v[148:163], v[72:75], v[200:203], v[148:163]
    ds_read_b128 v[68:71], v18 offset:37888
    buffer_load_dwordx4 v[192:195], v4, s[20:23], s14 offen offset:1024 sc1
    s_add_u32 m0, s42, 64512
    s_add_u32 s36, s27, 3072
    buffer_load_dwordx4 v4, s[20:23], s36 offen lds
    s_waitcnt lgkmcnt(5)
    s_waitcnt vmcnt(17)
    v_mfma_f32_32x32x16_bf16 v[116:131], v[76:79], v[204:207], v[116:131]
    ds_read_b128 v[72:75], v18 offset:38912
    buffer_load_dwordx4 v[196:199], v4, s[20:23], s14 offen offset:2048 sc1
    s_waitcnt lgkmcnt(5)
    v_mfma_f32_32x32x16_bf16 v[132:147], v[80:83], v[204:207], v[132:147]
    ds_read_b128 v[76:79], v18 offset:39936
    buffer_load_dwordx4 v[200:203], v4, s[20:23], s14 offen offset:3072 sc1
    s_add_u32 m0, s42, 65536
    s_add_u32 s36, s27, 4096
    buffer_load_dwordx4 v4, s[20:23], s36 offen lds
    s_waitcnt lgkmcnt(5)
    v_mfma_f32_32x32x16_bf16 v[148:163], v[56:59], v[204:207], v[148:163]
    ds_read_b128 v[80:83], v18 offset:40960
    s_waitcnt lgkmcnt(5)
    s_waitcnt vmcnt(19)
    v_mfma_f32_32x32x16_bf16 v[116:131], v[60:63], v[208:211], v[116:131]
    ds_read_b128 v[56:59], v18 offset:41984
    s_sub_u32 s14, s25, 5
    s_cselect_b32 s15, 10, 0
    s_add_u32 s14, s14, s15
    s_mul_i32 s14, s14, 4096
    s_add_u32 s14, s14, s48
    buffer_load_dwordx4 v[204:207], v4, s[20:23], s14 offen offset:0 sc1
    s_waitcnt lgkmcnt(5)
    v_mfma_f32_32x32x16_bf16 v[132:147], v[64:67], v[208:211], v[132:147]
    ds_read_b128 v[60:63], v18 offset:43008
    s_waitcnt lgkmcnt(5)
    v_mfma_f32_32x32x16_bf16 v[148:163], v[68:71], v[208:211], v[148:163]
    ds_read_b128 v[64:67], v18 offset:44032
    s_waitcnt lgkmcnt(5)
    s_waitcnt vmcnt(19)
    v_mfma_f32_32x32x16_bf16 v[116:131], v[72:75], v[212:215], v[116:131]
    ds_read_b128 v[68:71], v18 offset:45056
    buffer_load_dwordx4 v[208:211], v4, s[20:23], s14 offen offset:1024 sc1
    s_waitcnt lgkmcnt(5)
    v_mfma_f32_32x32x16_bf16 v[132:147], v[76:79], v[212:215], v[132:147]
    ds_read_b128 v[72:75], v18 offset:46080
    s_waitcnt lgkmcnt(5)
    v_mfma_f32_32x32x16_bf16 v[148:163], v[80:83], v[212:215], v[148:163]
    ds_read_b128 v[76:79], v18 offset:47104
    s_waitcnt lgkmcnt(5)
    s_waitcnt vmcnt(19)
    v_mfma_f32_32x32x16_bf16 v[116:131], v[56:59], v[216:219], v[116:131]
    ds_read_b128 v[80:83], v18 offset:48128
    buffer_load_dwordx4 v[212:215], v4, s[20:23], s14 offen offset:2048 sc1
    s_waitcnt lgkmcnt(5)
    v_mfma_f32_32x32x16_bf16 v[132:147], v[60:63], v[216:219], v[132:147]
    ds_read_b128 v[56:59], v18 offset:49152
    s_waitcnt lgkmcnt(5)
    v_mfma_f32_32x32x16_bf16 v[148:163], v[64:67], v[216:219], v[148:163]
    ds_read_b128 v[60:63], v18 offset:50176
    s_waitcnt lgkmcnt(5)
    s_waitcnt vmcnt(19)
    v_mfma_f32_32x32x16_bf16 v[116:131], v[68:71], v[220:223], v[116:131]
    ds_read_b128 v[64:67], v18 offset:51200
    buffer_load_dwordx4 v[216:219], v4, s[20:23], s14 offen offset:3072 sc1
    s_waitcnt lgkmcnt(5)
    v_mfma_f32_32x32x16_bf16 v[132:147], v[72:75], v[220:223], v[132:147]
    ds_read_b128 v[68:71], v18 offset:52224
    s_waitcnt lgkmcnt(5)
    v_mfma_f32_32x32x16_bf16 v[148:163], v[76:79], v[220:223], v[148:163]
    ds_read_b128 v[72:75], v18 offset:53248
    s_waitcnt lgkmcnt(5)
    s_waitcnt vmcnt(19)
    v_mfma_f32_32x32x16_bf16 v[116:131], v[80:83], v[224:227], v[116:131]
    ds_read_b128 v[76:79], v18 offset:54272
    s_sub_u32 s14, s25, 4
    s_cselect_b32 s15, 10, 0
    s_add_u32 s14, s14, s15
    s_mul_i32 s14, s14, 4096
    s_add_u32 s14, s14, s48
    buffer_load_dwordx4 v[220:223], v4, s[20:23], s14 offen offset:0 sc1
    s_waitcnt lgkmcnt(5)
    v_mfma_f32_32x32x16_bf16 v[132:147], v[56:59], v[224:227], v[132:147]
    ds_read_b128 v[80:83], v18 offset:55296
    s_waitcnt lgkmcnt(5)
    v_mfma_f32_32x32x16_bf16 v[148:163], v[60:63], v[224:227], v[148:163]
    ds_read_b128 v[56:59], v18 offset:56320
    s_waitcnt lgkmcnt(5)
    s_waitcnt vmcnt(19)
    v_mfma_f32_32x32x16_bf16 v[116:131], v[64:67], v[228:231], v[116:131]
    ds_read_b128 v[60:63], v18 offset:57344
    buffer_load_dwordx4 v[224:227], v4, s[20:23], s14 offen offset:1024 sc1
    v_add_f32 v16, v40, v42
    v_add_f32 v17, v41, v43
    s_waitcnt lgkmcnt(5)
    v_mfma_f32_32x32x16_bf16 v[132:147], v[68:71], v[228:231], v[132:147]
    ds_read_b128 v[64:67], v18 offset:58368
    v_add_f32 v44, v44, v46
    v_add_f32 v45, v45, v47
    s_waitcnt lgkmcnt(5)
    v_mfma_f32_32x32x16_bf16 v[148:163], v[72:75], v[228:231], v[148:163]
    ds_read_b128 v[68:71], v18 offset:59392
    v_add_f32 v16, v16, v44
    v_add_f32 v17, v17, v45
    s_waitcnt lgkmcnt(5)
    s_waitcnt vmcnt(19)
    v_mfma_f32_32x32x16_bf16 v[116:131], v[76:79], v[232:235], v[116:131]
    ds_read_b128 v[72:75], v18 offset:60416
    buffer_load_dwordx4 v[228:231], v4, s[20:23], s14 offen offset:2048 sc1
    v_mov_b32 v8, v16
    s_nop 1
    s_waitcnt lgkmcnt(5)
    v_mfma_f32_32x32x16_bf16 v[132:147], v[80:83], v[232:235], v[132:147]
    ds_read_b128 v[76:79], v19 offset:0
    v_permlane32_swap_b32 v16, v8
    s_nop 1
    s_waitcnt lgkmcnt(5)
    v_mfma_f32_32x32x16_bf16 v[148:163], v[56:59], v[232:235], v[148:163]
    ds_read_b128 v[80:83], v19 offset:1024
    v_add_f32 v16, v16, v8
    v_mov_b32 v8, v17
    s_waitcnt lgkmcnt(5)
    s_waitcnt vmcnt(19)
    v_mfma_f32_32x32x16_bf16 v[116:131], v[60:63], v[236:239], v[116:131]
    ds_read_b128 v[56:59], v19 offset:2048
    buffer_load_dwordx4 v[232:235], v4, s[20:23], s14 offen offset:3072 sc1
    s_nop 1
    v_permlane32_swap_b32 v17, v8
    s_waitcnt lgkmcnt(5)
    v_mfma_f32_32x32x16_bf16 v[132:147], v[64:67], v[236:239], v[132:147]
    ds_read_b128 v[60:63], v19 offset:3072
    s_nop 1
    v_add_f32 v17, v17, v8
    s_waitcnt lgkmcnt(5)
    v_mfma_f32_32x32x16_bf16 v[148:163], v[68:71], v[236:239], v[148:163]
    ds_read_b128 v[64:67], v19 offset:4096
    v_mul_f32 v8, 0x3acccccd, v16
    v_mul_f32 v9, 0x3acccccd, v17
    s_waitcnt lgkmcnt(5)
    s_waitcnt vmcnt(19)
    v_mfma_f32_32x32x16_bf16 v[116:131], v[72:75], v[240:243], v[116:131]
    ds_read_b128 v[68:71], v19 offset:5120
    s_sub_u32 s14, s25, 3
    s_cselect_b32 s15, 10, 0
    s_add_u32 s14, s14, s15
    s_mul_i32 s14, s14, 4096
    s_add_u32 s14, s14, s48
    buffer_load_dwordx4 v[236:239], v4, s[20:23], s14 offen offset:0 sc1
    v_fma_f32 v9, -v8, v8, v9
    v_max_f32 v9, 0, v9
    s_waitcnt lgkmcnt(5)
    v_mfma_f32_32x32x16_bf16 v[132:147], v[76:79], v[240:243], v[132:147]
    ds_read_b128 v[72:75], v19 offset:6144
    v_cvt_pk_bf16_f32 v38, v8, v8
    v_lshlrev_b32 v38, 16, v38
    s_waitcnt lgkmcnt(5)
    v_mfma_f32_32x32x16_bf16 v[148:163], v[80:83], v[240:243], v[148:163]
    ds_read_b128 v[76:79], v19 offset:7168
    v_cvt_pk_bf16_f32 v9, v9, v9
    v_lshlrev_b32 v9, 16, v9
    s_waitcnt lgkmcnt(5)
    s_waitcnt vmcnt(18)
    v_mfma_f32_32x32x16_bf16 v[116:131], v[56:59], v[244:247], v[116:131]
    ds_read_b128 v[80:83], v19 offset:8192
    buffer_load_dwordx4 v[240:243], v4, s[20:23], s14 offen offset:1024 sc1
    v_add_f32 v9, 0x3727c5ac, v9
    v_cvt_pk_bf16_f32 v9, v9, v9
    s_waitcnt lgkmcnt(5)
    v_mfma_f32_32x32x16_bf16 v[132:147], v[60:63], v[244:247], v[132:147]
    ds_read_b128 v[56:59], v19 offset:9216
    v_lshlrev_b32 v9, 16, v9
    v_sqrt_f32 v9, v9
    s_waitcnt lgkmcnt(5)
    v_mfma_f32_32x32x16_bf16 v[148:163], v[64:67], v[244:247], v[148:163]
    ds_read_b128 v[60:63], v19 offset:10240
    s_nop 0
    v_cvt_pk_bf16_f32 v9, v9, v9
    s_waitcnt lgkmcnt(5)
    s_waitcnt vmcnt(17)
    v_mfma_f32_32x32x16_bf16 v[116:131], v[68:71], v[248:251], v[116:131]
    ds_read_b128 v[64:67], v19 offset:11264
    buffer_load_dwordx4 v[244:247], v4, s[20:23], s14 offen offset:2048 sc1
    v_lshlrev_b32 v9, 16, v9
    v_rcp_f32 v39, v9
    s_waitcnt lgkmcnt(5)
    v_mfma_f32_32x32x16_bf16 v[132:147], v[72:75], v[248:251], v[132:147]
    ds_read_b128 v[68:71], v19 offset:12288
    s_nop 0
    v_xor_b32 v8, 0x80000000, v38
    s_waitcnt lgkmcnt(5)
    v_mfma_f32_32x32x16_bf16 v[148:163], v[76:79], v[248:251], v[148:163]
    ds_read_b128 v[72:75], v19 offset:13312
    v_lshrrev_b32 v48, 16, v8
    v_or_b32 v48, v48, v8
    s_waitcnt lgkmcnt(5)
    s_waitcnt vmcnt(17)
    v_mfma_f32_32x32x16_bf16 v[116:131], v[80:83], v[188:191], v[116:131]
    ds_read_b128 v[76:79], v19 offset:14336
    buffer_load_dwordx4 v[248:251], v4, s[20:23], s14 offen offset:3072 sc1
    v_cmp_eq_u32 vcc, 0, v6
    v_mov_b32 v49, v48
    s_waitcnt lgkmcnt(5)
    v_mfma_f32_32x32x16_bf16 v[132:147], v[56:59], v[188:191], v[132:147]
    ds_read_b128 v[80:83], v19 offset:15360
    v_mov_b32 v50, v48
    v_mov_b32 v51, v48
    s_waitcnt lgkmcnt(5)
    v_mfma_f32_32x32x16_bf16 v[148:163], v[60:63], v[188:191], v[148:163]
    ds_read_b128 v[56:59], v19 offset:16384
    v_mov_b32 v52, v48
    v_mov_b32 v53, v48
    s_waitcnt lgkmcnt(5)
    s_waitcnt vmcnt(16)
    v_mfma_f32_32x32x16_bf16 v[116:131], v[64:67], v[192:195], v[116:131]
    ds_read_b128 v[60:63], v19 offset:17408
    s_sub_u32 s14, s25, 2
    s_cselect_b32 s15, 10, 0
    s_add_u32 s14, s14, s15
    s_mul_i32 s14, s14, 4096
    s_add_u32 s14, s14, s48
    buffer_load_dwordx4 v[188:191], v4, s[20:23], s14 offen offset:0 sc1
    v_mov_b32 v54, v48
    v_lshrrev_b32 v8, 16, v9
    s_waitcnt lgkmcnt(5)
    v_mfma_f32_32x32x16_bf16 v[132:147], v[68:71], v[192:195], v[132:147]
    ds_read_b128 v[64:67], v19 offset:18432
    v_cndmask_b32 v55, v8, v48, vcc
    v_mul_f32 v38, v39, v39
    s_waitcnt lgkmcnt(5)
    v_mfma_f32_32x32x16_bf16 v[148:163], v[72:75], v[192:195], v[148:163]
    ds_read_b128 v[68:71], v19 offset:19456
    v_mov_b32 v39, v38
    s_waitcnt lgkmcnt(5)
    s_waitcnt vmcnt(15)
    v_mfma_f32_32x32x16_bf16 v[116:131], v[76:79], v[196:199], v[116:131]
    ds_read_b128 v[72:75], v19 offset:20480
    buffer_load_dwordx4 v[192:195], v4, s[20:23], s14 offen offset:1024 sc1
    s_waitcnt lgkmcnt(5)
    v_mfma_f32_32x32x16_bf16 v[132:147], v[80:83], v[196:199], v[132:147]
    ds_read_b128 v[76:79], v19 offset:21504
    s_waitcnt lgkmcnt(5)
    v_mfma_f32_32x32x16_bf16 v[148:163], v[56:59], v[196:199], v[148:163]
    ds_read_b128 v[80:83], v19 offset:22528
    s_waitcnt lgkmcnt(5)
    s_waitcnt vmcnt(15)
    v_mfma_f32_32x32x16_bf16 v[116:131], v[60:63], v[200:203], v[116:131]
    ds_read_b128 v[56:59], v19 offset:23552
    buffer_load_dwordx4 v[196:199], v4, s[20:23], s14 offen offset:2048 sc1
    s_waitcnt lgkmcnt(5)
    v_mfma_f32_32x32x16_bf16 v[132:147], v[64:67], v[200:203], v[132:147]
    ds_read_b128 v[60:63], v19 offset:24576
    s_waitcnt lgkmcnt(5)
    v_mfma_f32_32x32x16_bf16 v[148:163], v[68:71], v[200:203], v[148:163]
    ds_read_b128 v[64:67], v19 offset:25600
    s_waitcnt lgkmcnt(5)
    s_waitcnt vmcnt(14)
    v_mfma_f32_32x32x16_bf16 v[116:131], v[72:75], v[204:207], v[116:131]
    ds_read_b128 v[68:71], v19 offset:26624
    buffer_load_dwordx4 v[200:203], v4, s[20:23], s14 offen offset:3072 sc1
    s_waitcnt lgkmcnt(5)
    v_mfma_f32_32x32x16_bf16 v[132:147], v[76:79], v[204:207], v[132:147]
    ds_read_b128 v[72:75], v19 offset:27648
    s_waitcnt lgkmcnt(5)
    v_mfma_f32_32x32x16_bf16 v[148:163], v[80:83], v[204:207], v[148:163]
    ds_read_b128 v[76:79], v19 offset:28672
    s_waitcnt lgkmcnt(5)
    s_waitcnt vmcnt(14)
    v_mfma_f32_32x32x16_bf16 v[116:131], v[56:59], v[208:211], v[116:131]
    ds_read_b128 v[80:83], v19 offset:29696
    s_sub_u32 s14, s25, 1
    s_cselect_b32 s15, 10, 0
    s_add_u32 s14, s14, s15
    s_mul_i32 s14, s14, 4096
    s_add_u32 s14, s14, s48
    buffer_load_dwordx4 v[204:207], v4, s[20:23], s14 offen offset:0 sc1
    s_waitcnt lgkmcnt(5)
    v_mfma_f32_32x32x16_bf16 v[132:147], v[60:63], v[208:211], v[132:147]
    ds_read_b128 v[56:59], v19 offset:30720
    s_waitcnt lgkmcnt(5)
    v_mfma_f32_32x32x16_bf16 v[148:163], v[64:67], v[208:211], v[148:163]
    ds_read_b128 v[60:63], v19 offset:31744
    s_waitcnt lgkmcnt(5)
    s_waitcnt vmcnt(14)
    v_mfma_f32_32x32x16_bf16 v[116:131], v[68:71], v[212:215], v[116:131]
    s_waitcnt vmcnt(14)
    s_barrier
    ds_read_b128 v[64:67], v4 offset:0
    buffer_load_dwordx4 v[208:211], v4, s[20:23], s14 offen offset:1024 sc1
    s_waitcnt lgkmcnt(5)
    v_mfma_f32_32x32x16_bf16 v[132:147], v[72:75], v[212:215], v[132:147]
    ds_read_b128 v[68:71], v4 offset:1024
    s_waitcnt lgkmcnt(5)
    v_mfma_f32_32x32x16_bf16 v[148:163], v[76:79], v[212:215], v[148:163]
    ds_read_b128 v[72:75], v4 offset:2048
    s_waitcnt lgkmcnt(5)
    s_waitcnt vmcnt(14)
    v_mfma_f32_32x32x16_bf16 v[116:131], v[80:83], v[216:219], v[116:131]
    ds_read_b128 v[76:79], v4 offset:3072
    buffer_load_dwordx4 v[212:215], v4, s[20:23], s14 offen offset:2048 sc1
    s_waitcnt lgkmcnt(5)
    v_mfma_f32_32x32x16_bf16 v[132:147], v[56:59], v[216:219], v[132:147]
    ds_read_b128 v[80:83], v4 offset:4096
    s_waitcnt lgkmcnt(5)
    v_mfma_f32_32x32x16_bf16 v[148:163], v[60:63], v[216:219], v[148:163]
    ds_read_b128 v[56:59], v4 offset:5120
    s_waitcnt lgkmcnt(5)
    s_waitcnt vmcnt(14)
    v_mfma_f32_32x32x16_bf16 v[116:131], v[64:67], v[220:223], v[116:131]
    ds_read_b128 v[60:63], v4 offset:6144
    buffer_load_dwordx4 v[216:219], v4, s[20:23], s14 offen offset:3072 sc1
    s_waitcnt lgkmcnt(5)
    v_mfma_f32_32x32x16_bf16 v[132:147], v[68:71], v[220:223], v[132:147]
    ds_read_b128 v[64:67], v4 offset:7168
    s_barrier
    s_sub_u32 s27, s26, 11
    s_cselect_b32 s15, 12, 0
    s_add_u32 s27, s27, s15
    s_mul_i32 s27, s27, 20480
    s_add_u32 s27, s27, s52
    s_add_u32 m0, s42, 81920
    s_add_u32 s36, s27, 0
    buffer_load_dwordx4 v4, s[20:23], s36 offen lds
    s_waitcnt lgkmcnt(5)
    v_mfma_f32_32x32x16_bf16 v[148:163], v[72:75], v[220:223], v[148:163]
    ds_read_b128 v[68:71], v4 offset:8192
    s_add_u32 m0, s42, 82944
    s_add_u32 s36, s27, 1024
    buffer_load_dwordx4 v4, s[20:23], s36 offen lds
    s_waitcnt lgkmcnt(5)
    s_waitcnt vmcnt(16)
    v_mfma_f32_32x32x16_bf16 v[116:131], v[76:79], v[224:227], v[116:131]
    ds_read_b128 v[72:75], v4 offset:9216
    s_waitcnt lgkmcnt(5)
    v_mfma_f32_32x32x16_bf16 v[132:147], v[80:83], v[224:227], v[132:147]
    ds_read_b128 v[76:79], v4 offset:10240
    s_add_u32 m0, s42, 83968
    s_add_u32 s36, s27, 2048
    buffer_load_dwordx4 v4, s[20:23], s36 offen lds
    s_waitcnt lgkmcnt(5)
    v_mfma_f32_32x32x16_bf16 v[148:163], v[56:59], v[224:227], v[148:163]
    ds_read_b128 v[80:83], v4 offset:11264
    s_add_u32 m0, s42, 84992
    s_add_u32 s36, s27, 3072
    buffer_load_dwordx4 v4, s[20:23], s36 offen lds
    s_waitcnt lgkmcnt(5)
    s_waitcnt vmcnt(17)
    v_mfma_f32_32x32x16_bf16 v[116:131], v[60:63], v[228:231], v[116:131]
    ds_read_b128 v[56:59], v4 offset:12288
    s_waitcnt lgkmcnt(5)
    v_mfma_f32_32x32x16_bf16 v[132:147], v[64:67], v[228:231], v[132:147]
    ds_read_b128 v[60:63], v4 offset:13312
    s_add_u32 m0, s42, 86016
    s_add_u32 s36, s27, 4096
    buffer_load_dwordx4 v4, s[20:23], s36 offen lds
    s_waitcnt lgkmcnt(5)
    v_mfma_f32_32x32x16_bf16 v[148:163], v[68:71], v[228:231], v[148:163]
    ds_read_b128 v[64:67], v4 offset:14336
    s_sub_u32 s27, s26, 10
    s_cselect_b32 s15, 12, 0
    s_add_u32 s27, s27, s15
    s_mul_i32 s27, s27, 20480
    s_add_u32 s27, s27, s52
    s_add_u32 m0, s42, 102400
    s_add_u32 s36, s27, 0
    buffer_load_dwordx4 v4, s[20:23], s36 offen lds
    s_waitcnt lgkmcnt(5)
    s_waitcnt vmcnt(18)
    v_mfma_f32_32x32x16_bf16 v[116:131], v[72:75], v[232:235], v[116:131]
    ds_read_b128 v[68:71], v4 offset:15360
    s_waitcnt lgkmcnt(5)
    v_mfma_f32_32x32x16_bf16 v[132:147], v[76:79], v[232:235], v[132:147]
    ds_read_b128 v[72:75], v4 offset:16384
    s_add_u32 m0, s42, 103424
    s_add_u32 s36, s27, 1024
    buffer_load_dwordx4 v4, s[20:23], s36 offen lds
    s_waitcnt lgkmcnt(5)
    v_mfma_f32_32x32x16_bf16 v[148:163], v[80:83], v[232:235], v[148:163]
    ds_read_b128 v[76:79], v4 offset:17408
    s_add_u32 m0, s42, 104448
    s_add_u32 s36, s27, 2048
    buffer_load_dwordx4 v4, s[20:23], s36 offen lds
    s_waitcnt lgkmcnt(5)
    s_waitcnt vmcnt(19)
    v_mfma_f32_32x32x16_bf16 v[116:131], v[56:59], v[236:239], v[116:131]
    ds_read_b128 v[80:83], v4 offset:18432
    s_waitcnt lgkmcnt(5)
    v_mfma_f32_32x32x16_bf16 v[132:147], v[60:63], v[236:239], v[132:147]
    ds_read_b128 v[56:59], v4 offset:19456
    s_add_u32 m0, s42, 105472
    s_add_u32 s36, s27, 3072
    buffer_load_dwordx4 v4, s[20:23], s36 offen lds
    s_waitcnt lgkmcnt(5)
    v_mfma_f32_32x32x16_bf16 v[148:163], v[64:67], v[236:239], v[148:163]
    ds_read_b128 v[60:63], v4 offset:20480
    s_add_u32 m0, s42, 106496
    s_add_u32 s36, s27, 4096
    buffer_load_dwordx4 v4, s[20:23], s36 offen lds
    s_waitcnt lgkmcnt(5)
    s_waitcnt vmcnt(20)
    v_mfma_f32_32x32x16_bf16 v[116:131], v[68:71], v[240:243], v[116:131]
    ds_read_b128 v[64:67], v4 offset:21504
    s_waitcnt lgkmcnt(5)
    v_mfma_f32_32x32x16_bf16 v[132:147], v[72:75], v[240:243], v[132:147]
    ds_read_b128 v[68:71], v4 offset:22528
    s_sub_u32 s27, s26, 9
    s_cselect_b32 s15, 12, 0
    s_add_u32 s27, s27, s15
    s_mul_i32 s27, s27, 20480
    s_add_u32 s27, s27, s52
    s_add_u32 m0, s42, 122880
    s_add_u32 s36, s27, 0
    buffer_load_dwordx4 v4, s[20:23], s36 offen lds
    s_waitcnt lgkmcnt(5)
    v_mfma_f32_32x32x16_bf16 v[148:163], v[76:79], v[240:243], v[148:163]
    ds_read_b128 v[72:75], v4 offset:23552
    s_add_u32 m0, s42, 123904
    s_add_u32 s36, s27, 1024
    buffer_load_dwordx4 v4, s[20:23], s36 offen lds
    s_waitcnt lgkmcnt(5)
    s_waitcnt vmcnt(21)
    v_mfma_f32_32x32x16_bf16 v[116:131], v[80:83], v[244:247], v[116:131]
    ds_read_b128 v[76:79], v4 offset:24576
    s_waitcnt lgkmcnt(5)
    v_mfma_f32_32x32x16_bf16 v[132:147], v[56:59], v[244:247], v[132:147]
    ds_read_b128 v[80:83], v4 offset:25600
    s_add_u32 m0, s42, 124928
    s_add_u32 s36, s27, 2048
    buffer_load_dwordx4 v4, s[20:23], s36 offen lds
    s_waitcnt lgkmcnt(5)
    v_mfma_f32_32x32x16_bf16 v[148:163], v[60:63], v[244:247], v[148:163]
    ds_read_b128 v[56:59], v4 offset:26624
    s_add_u32 m0, s42, 125952
    s_add_u32 s36, s27, 3072
    buffer_load_dwordx4 v4, s[20:23], s36 offen lds
    s_waitcnt lgkmcnt(5)
    s_waitcnt vmcnt(22)
    v_mfma_f32_32x32x16_bf16 v[116:131], v[64:67], v[248:251], v[116:131]
    ds_read_b128 v[60:63], v4 offset:27648
    s_waitcnt lgkmcnt(5)
    v_mfma_f32_32x32x16_bf16 v[132:147], v[68:71], v[248:251], v[132:147]
    ds_read_b128 v[64:67], v4 offset:28672
    s_add_u32 m0, s42, 126976
    s_add_u32 s36, s27, 4096
    buffer_load_dwordx4 v4, s[20:23], s36 offen lds
    s_waitcnt lgkmcnt(5)
    v_mfma_f32_32x32x16_bf16 v[148:163], v[72:75], v[248:251], v[148:163]
    ds_read_b128 v[68:71], v4 offset:29696
    s_waitcnt lgkmcnt(5)
    s_waitcnt vmcnt(22)
    v_mfma_f32_32x32x16_bf16 v[116:131], v[76:79], v[188:191], v[116:131]
    ds_read_b128 v[72:75], v4 offset:30720
    s_waitcnt lgkmcnt(5)
    v_mfma_f32_32x32x16_bf16 v[132:147], v[80:83], v[188:191], v[132:147]
    ds_read_b128 v[76:79], v4 offset:31744
    s_waitcnt lgkmcnt(5)
    v_mfma_f32_32x32x16_bf16 v[148:163], v[56:59], v[188:191], v[148:163]
    ds_read_b128 v[80:83], v4 offset:32768
    s_waitcnt lgkmcnt(5)
    s_waitcnt vmcnt(21)
    v_mfma_f32_32x32x16_bf16 v[116:131], v[60:63], v[192:195], v[116:131]
    ds_read_b128 v[56:59], v4 offset:33792
    s_waitcnt lgkmcnt(5)
    v_mfma_f32_32x32x16_bf16 v[132:147], v[64:67], v[192:195], v[132:147]
    ds_read_b128 v[60:63], v4 offset:34816
    s_waitcnt lgkmcnt(5)
    v_mfma_f32_32x32x16_bf16 v[148:163], v[68:71], v[192:195], v[148:163]
    ds_read_b128 v[64:67], v4 offset:35840
    s_waitcnt lgkmcnt(5)
    s_waitcnt vmcnt(20)
    v_mfma_f32_32x32x16_bf16 v[116:131], v[72:75], v[196:199], v[116:131]
    ds_read_b128 v[68:71], v4 offset:36864
    s_waitcnt lgkmcnt(5)
    v_mfma_f32_32x32x16_bf16 v[132:147], v[76:79], v[196:199], v[132:147]
    ds_read_b128 v[72:75], v4 offset:37888
    s_waitcnt lgkmcnt(5)
    v_mfma_f32_32x32x16_bf16 v[148:163], v[80:83], v[196:199], v[148:163]
    ds_read_b128 v[76:79], v4 offset:38912
    s_waitcnt lgkmcnt(5)
    s_waitcnt vmcnt(19)
    v_mfma_f32_32x32x16_bf16 v[116:131], v[56:59], v[200:203], v[116:131]
    ds_read_b128 v[80:83], v4 offset:39936
    s_waitcnt lgkmcnt(5)
    v_mfma_f32_32x32x16_bf16 v[132:147], v[60:63], v[200:203], v[132:147]
    ds_read_b128 v[56:59], v4 offset:40960
    s_waitcnt lgkmcnt(5)
    v_mfma_f32_32x32x16_bf16 v[148:163], v[64:67], v[200:203], v[148:163]
    ds_read_b128 v[60:63], v4 offset:41984
    s_waitcnt lgkmcnt(5)
    s_waitcnt vmcnt(18)
    v_mfma_f32_32x32x16_bf16 v[116:131], v[68:71], v[204:207], v[116:131]
    ds_read_b128 v[64:67], v4 offset:43008
    s_waitcnt lgkmcnt(5)
    v_mfma_f32_32x32x16_bf16 v[132:147], v[72:75], v[204:207], v[132:147]
    ds_read_b128 v[68:71], v4 offset:44032
    s_waitcnt lgkmcnt(5)
    v_mfma_f32_32x32x16_bf16 v[148:163], v[76:79], v[204:207], v[148:163]
    ds_read_b128 v[72:75], v4 offset:45056
    s_waitcnt lgkmcnt(5)
    s_waitcnt vmcnt(17)
    v_mfma_f32_32x32x16_bf16 v[116:131], v[80:83], v[208:211], v[116:131]
    ds_read_b128 v[76:79], v4 offset:46080
    s_waitcnt lgkmcnt(5)
    v_mfma_f32_32x32x16_bf16 v[132:147], v[56:59], v[208:211], v[132:147]
    ds_read_b128 v[80:83], v4 offset:47104
    s_waitcnt lgkmcnt(5)
    v_mfma_f32_32x32x16_bf16 v[148:163], v[60:63], v[208:211], v[148:163]
    ds_read_b128 v[56:59], v4 offset:48128
    s_waitcnt lgkmcnt(5)
    s_waitcnt vmcnt(16)
    v_mfma_f32_32x32x16_bf16 v[116:131], v[64:67], v[212:215], v[116:131]
    s_waitcnt lgkmcnt(4)
    v_mfma_f32_32x32x16_bf16 v[132:147], v[68:71], v[212:215], v[132:147]
    s_waitcnt lgkmcnt(3)
    v_mfma_f32_32x32x16_bf16 v[148:163], v[72:75], v[212:215], v[148:163]
    s_waitcnt lgkmcnt(2)
    s_waitcnt vmcnt(15)
    v_mfma_f32_32x32x16_bf16 v[116:131], v[76:79], v[216:219], v[116:131]
    s_waitcnt lgkmcnt(1)
    v_mfma_f32_32x32x16_bf16 v[132:147], v[80:83], v[216:219], v[132:147]
    s_waitcnt lgkmcnt(0)
    v_mfma_f32_32x32x16_bf16 v[148:163], v[56:59], v[216:219], v[148:163]
    v_mfma_f32_32x32x16_bf16 v[116:131], v[164:167], v[48:51], v[116:131]
    v_mfma_f32_32x32x16_bf16 v[116:131], v[168:171], v[52:55], v[116:131]
    v_mfma_f32_32x32x16_bf16 v[132:147], v[172:175], v[48:51], v[132:147]
    v_mfma_f32_32x32x16_bf16 v[132:147], v[176:179], v[52:55], v[132:147]
    v_mfma_f32_32x32x16_bf16 v[148:163], v[180:183], v[48:51], v[148:163]
    v_mfma_f32_32x32x16_bf16 v[148:163], v[184:187], v[52:55], v[148:163]
    s_nop 7
    v_max_f32 v188, 0, v116
    v_max_f32 v189, 0, v117
    v_max_f32 v190, 0, v118
    v_max_f32 v191, 0, v119
    v_pk_mul_f32 v[116:117], v[116:117], v[38:39]
    v_pk_mul_f32 v[118:119], v[118:119], v[38:39]
    v_pk_mul_f32 v[116:117], v[116:117], v[188:189]
    v_pk_mul_f32 v[118:119], v[118:119], v[190:191]
    v_cvt_pk_bf16_f32 v220, v116, v117
    v_cvt_pk_bf16_f32 v221, v118, v119
    v_max_f32 v192, 0, v120
    v_max_f32 v193, 0, v121
    v_max_f32 v194, 0, v122
    v_max_f32 v195, 0, v123
    v_pk_mul_f32 v[120:121], v[120:121], v[38:39]
    v_pk_mul_f32 v[122:123], v[122:123], v[38:39]
    v_pk_mul_f32 v[120:121], v[120:121], v[192:193]
    v_pk_mul_f32 v[122:123], v[122:123], v[194:195]
    v_cvt_pk_bf16_f32 v222, v120, v121
    v_cvt_pk_bf16_f32 v223, v122, v123
    s_nop 1
    v_permlane32_swap_b32 v220, v222
    v_permlane32_swap_b32 v221, v223
    buffer_store_dwordx4 v[220:223], v36, s[20:23], s58 offen offset:0 sc1
    v_max_f32 v188, 0, v124
    v_max_f32 v189, 0, v125
    v_max_f32 v190, 0, v126
    v_max_f32 v191, 0, v127
    v_pk_mul_f32 v[124:125], v[124:125], v[38:39]
    v_pk_mul_f32 v[126:127], v[126:127], v[38:39]
    v_pk_mul_f32 v[124:125], v[124:125], v[188:189]
    v_pk_mul_f32 v[126:127], v[126:127], v[190:191]
    v_cvt_pk_bf16_f32 v224, v124, v125
    v_cvt_pk_bf16_f32 v225, v126, v127
    v_max_f32 v192, 0, v128
    v_max_f32 v193, 0, v129
    v_max_f32 v194, 0, v130
    v_max_f32 v195, 0, v131
    v_pk_mul_f32 v[128:129], v[128:129], v[38:39]
    v_pk_mul_f32 v[130:131], v[130:131], v[38:39]
    v_pk_mul_f32 v[128:129], v[128:129], v[192:193]
    v_pk_mul_f32 v[130:131], v[130:131], v[194:195]
    v_cvt_pk_bf16_f32 v226, v128, v129
    v_cvt_pk_bf16_f32 v227, v130, v131
    s_nop 1
    v_permlane32_swap_b32 v224, v226
    v_permlane32_swap_b32 v225, v227
    buffer_store_dwordx4 v[224:227], v36, s[20:23], s58 offen offset:512 sc1
    v_max_f32 v188, 0, v132
    v_max_f32 v189, 0, v133
    v_max_f32 v190, 0, v134
    v_max_f32 v191, 0, v135
    v_pk_mul_f32 v[132:133], v[132:133], v[38:39]
    v_pk_mul_f32 v[134:135], v[134:135], v[38:39]
    v_pk_mul_f32 v[132:133], v[132:133], v[188:189]
    v_pk_mul_f32 v[134:135], v[134:135], v[190:191]
    v_cvt_pk_bf16_f32 v228, v132, v133
    v_cvt_pk_bf16_f32 v229, v134, v135
    v_max_f32 v192, 0, v136
    v_max_f32 v193, 0, v137
    v_max_f32 v194, 0, v138
    v_max_f32 v195, 0, v139
    v_pk_mul_f32 v[136:137], v[136:137], v[38:39]
    v_pk_mul_f32 v[138:139], v[138:139], v[38:39]
    v_pk_mul_f32 v[136:137], v[136:137], v[192:193]
    v_pk_mul_f32 v[138:139], v[138:139], v[194:195]
    v_cvt_pk_bf16_f32 v230, v136, v137
    v_cvt_pk_bf16_f32 v231, v138, v139
    s_nop 1
    v_permlane32_swap_b32 v228, v230
    v_permlane32_swap_b32 v229, v231
    buffer_store_dwordx4 v[228:231], v36, s[20:23], s58 offen offset:1024 sc1
    v_max_f32 v188, 0, v140
    v_max_f32 v189, 0, v141
    v_max_f32 v190, 0, v142
    v_max_f32 v191, 0, v143
    v_pk_mul_f32 v[140:141], v[140:141], v[38:39]
    v_pk_mul_f32 v[142:143], v[142:143], v[38:39]
    v_pk_mul_f32 v[140:141], v[140:141], v[188:189]
    v_pk_mul_f32 v[142:143], v[142:143], v[190:191]
    v_cvt_pk_bf16_f32 v232, v140, v141
    v_cvt_pk_bf16_f32 v233, v142, v143
    v_max_f32 v192, 0, v144
    v_max_f32 v193, 0, v145
    v_max_f32 v194, 0, v146
    v_max_f32 v195, 0, v147
    v_pk_mul_f32 v[144:145], v[144:145], v[38:39]
    v_pk_mul_f32 v[146:147], v[146:147], v[38:39]
    v_pk_mul_f32 v[144:145], v[144:145], v[192:193]
    v_pk_mul_f32 v[146:147], v[146:147], v[194:195]
    v_cvt_pk_bf16_f32 v234, v144, v145
    v_cvt_pk_bf16_f32 v235, v146, v147
    s_nop 1
    v_permlane32_swap_b32 v232, v234
    v_permlane32_swap_b32 v233, v235
    buffer_store_dwordx4 v[232:235], v36, s[20:23], s58 offen offset:1536 sc1
    v_max_f32 v188, 0, v148
    v_max_f32 v189, 0, v149
    v_max_f32 v190, 0, v150
    v_max_f32 v191, 0, v151
    v_pk_mul_f32 v[148:149], v[148:149], v[38:39]
    v_pk_mul_f32 v[150:151], v[150:151], v[38:39]
    v_pk_mul_f32 v[148:149], v[148:149], v[188:189]
    v_pk_mul_f32 v[150:151], v[150:151], v[190:191]
    v_cvt_pk_bf16_f32 v236, v148, v149
    v_cvt_pk_bf16_f32 v237, v150, v151
    v_max_f32 v192, 0, v152
    v_max_f32 v193, 0, v153
    v_max_f32 v194, 0, v154
    v_max_f32 v195, 0, v155
    v_pk_mul_f32 v[152:153], v[152:153], v[38:39]
    v_pk_mul_f32 v[154:155], v[154:155], v[38:39]
    v_pk_mul_f32 v[152:153], v[152:153], v[192:193]
    v_pk_mul_f32 v[154:155], v[154:155], v[194:195]
    v_cvt_pk_bf16_f32 v238, v152, v153
    v_cvt_pk_bf16_f32 v239, v154, v155
    s_nop 1
    v_permlane32_swap_b32 v236, v238
    v_permlane32_swap_b32 v237, v239
    buffer_store_dwordx4 v[236:239], v36, s[20:23], s58 offen offset:2048 sc1
    v_max_f32 v188, 0, v156
    v_max_f32 v189, 0, v157
    v_max_f32 v190, 0, v158
    v_max_f32 v191, 0, v159
    v_pk_mul_f32 v[156:157], v[156:157], v[38:39]
    v_pk_mul_f32 v[158:159], v[158:159], v[38:39]
    v_pk_mul_f32 v[156:157], v[156:157], v[188:189]
    v_pk_mul_f32 v[158:159], v[158:159], v[190:191]
    v_cvt_pk_bf16_f32 v240, v156, v157
    v_cvt_pk_bf16_f32 v241, v158, v159
    v_max_f32 v192, 0, v160
    v_max_f32 v193, 0, v161
    v_max_f32 v194, 0, v162
    v_max_f32 v195, 0, v163
    v_pk_mul_f32 v[160:161], v[160:161], v[38:39]
    v_pk_mul_f32 v[162:163], v[162:163], v[38:39]
    v_pk_mul_f32 v[160:161], v[160:161], v[192:193]
    v_pk_mul_f32 v[162:163], v[162:163], v[194:195]
    v_cvt_pk_bf16_f32 v242, v160, v161
    v_cvt_pk_bf16_f32 v243, v162, v163
    s_nop 1
    v_permlane32_swap_b32 v240, v242
    v_permlane32_swap_b32 v241, v243
    buffer_store_dwordx4 v[240:243], v36, s[20:23], s58 offen offset:2560 sc1
    s_waitcnt vmcnt(0)
    s_barrier
    v_mov_b32 v8, 0
    v_mov_b32 v9, 1
    s_cmp_lg_u32 s34, 0
    s_cbranch_scc1 k3_kernel_na4
    s_mov_b64 exec, 1
    buffer_atomic_add v9, v8, s[20:23], s56 offen offset:128
    s_mov_b64 exec, -1
k3_kernel_na4:
    buffer_load_dwordx2 v[174:175], v35, s[28:31], s54 offen offset:0
    buffer_load_dwordx2 v[176:177], v35, s[28:31], s54 offen offset:32
    buffer_load_dwordx2 v[178:179], v35, s[28:31], s54 offen offset:64
    buffer_load_dwordx2 v[180:181], v35, s[28:31], s54 offen offset:96
    buffer_load_dwordx2 v[182:183], v35, s[28:31], s54 offen offset:128
    s_sub_u32 s27, s26, 8
    s_cselect_b32 s15, 12, 0
    s_add_u32 s27, s27, s15
    s_mul_i32 s27, s27, 20480
    s_add_u32 s27, s27, s52
    s_add_u32 m0, s42, 0
    s_add_u32 s36, s27, 0
    buffer_load_dwordx4 v4, s[20:23], s36 offen lds
    s_add_u32 m0, s42, 1024
    s_add_u32 s36, s27, 1024
    buffer_load_dwordx4 v4, s[20:23], s36 offen lds
    s_add_u32 m0, s42, 2048
    s_add_u32 s36, s27, 2048
    buffer_load_dwordx4 v4, s[20:23], s36 offen lds
    s_add_u32 m0, s42, 3072
    s_add_u32 s36, s27, 3072
    buffer_load_dwordx4 v4, s[20:23], s36 offen lds
    s_add_u32 m0, s42, 4096
    s_add_u32 s36, s27, 4096
    buffer_load_dwordx4 v4, s[20:23], s36 offen lds
    s_sub_u32 s27, s26, 7
    s_cselect_b32 s15, 12, 0
    s_add_u32 s27, s27, s15
    s_mul_i32 s27, s27, 20480
    s_add_u32 s27, s27, s52
    s_add_u32 m0, s42, 20480
    s_add_u32 s36, s27, 0
    buffer_load_dwordx4 v4, s[20:23], s36 offen lds
    s_add_u32 m0, s42, 21504
    s_add_u32 s36, s27, 1024
    buffer_load_dwordx4 v4, s[20:23], s36 offen lds
    s_add_u32 m0, s42, 22528
    s_add_u32 s36, s27, 2048
    buffer_load_dwordx4 v4, s[20:23], s36 offen lds
    s_add_u32 m0, s42, 23552
    s_add_u32 s36, s27, 3072
    buffer_load_dwordx4 v4, s[20:23], s36 offen lds
    s_add_u32 m0, s42, 24576
    s_add_u32 s36, s27, 4096
    buffer_load_dwordx4 v4, s[20:23], s36 offen lds
    s_sub_u32 s27, s26, 6
    s_cselect_b32 s15, 12, 0
    s_add_u32 s27, s27, s15
    s_mul_i32 s27, s27, 20480
    s_add_u32 s27, s27, s52
    s_add_u32 m0, s42, 40960
    s_add_u32 s36, s27, 0
    buffer_load_dwordx4 v4, s[20:23], s36 offen lds
    s_add_u32 m0, s42, 41984
    s_add_u32 s36, s27, 1024
    buffer_load_dwordx4 v4, s[20:23], s36 offen lds
    s_add_u32 m0, s42, 43008
    s_add_u32 s36, s27, 2048
    buffer_load_dwordx4 v4, s[20:23], s36 offen lds
    s_add_u32 m0, s42, 44032
    s_add_u32 s36, s27, 3072
    buffer_load_dwordx4 v4, s[20:23], s36 offen lds
    s_add_u32 m0, s42, 45056
    s_add_u32 s36, s27, 4096
    buffer_load_dwordx4 v4, s[20:23], s36 offen lds
    s_cmp_lg_u32 s34, 0
    s_cbranch_scc1 k3_kernel_np5
    s_mov_b32 s57, 0x40000
k3_kernel_poll6:
    buffer_load_dword v9, v8, s[20:23], s56 offen offset:128 sc1
    s_waitcnt vmcnt(0)
    v_readfirstlane_b32 s35, v9
    s_sub_u32 s57, s57, 1
    s_cmp_eq_u32 s57, 0
    s_cbranch_scc1 k3_kernel_np5
    s_cmp_lt_u32 s35, 16
    s_cbranch_scc1 k3_kernel_poll6
k3_kernel_np5:
    s_barrier
    s_sub_u32 s14, s26, 12
    s_cselect_b32 s15, 12, 0
    s_add_u32 s14, s14, s15
    s_mul_i32 s14, s14, 4096
    s_add_u32 s14, s14, s51
    buffer_load_dwordx4 v[188:191], v4, s[20:23], s14 offen offset:0 sc1
    buffer_load_dwordx4 v[192:195], v4, s[20:23], s14 offen offset:1024 sc1
    buffer_load_dwordx4 v[196:199], v4, s[20:23], s14 offen offset:2048 sc1
    buffer_load_dwordx4 v[200:203], v4, s[20:23], s14 offen offset:3072 sc1
    s_sub_u32 s14, s26, 11
    s_cselect_b32 s15, 12, 0
    s_add_u32 s14, s14, s15
    s_mul_i32 s14, s14, 4096
    s_add_u32 s14, s14, s51
    buffer_load_dwordx4 v[204:207], v4, s[20:23], s14 offen offset:0 sc1
    buffer_load_dwordx4 v[208:211], v4, s[20:23], s14 offen offset:1024 sc1
    buffer_load_dwordx4 v[212:215], v4, s[20:23], s14 offen offset:2048 sc1
    buffer_load_dwordx4 v[216:219], v4, s[20:23], s14 offen offset:3072 sc1
    s_sub_u32 s14, s26, 10
    s_cselect_b32 s15, 12, 0
    s_add_u32 s14, s14, s15
    s_mul_i32 s14, s14, 4096
    s_add_u32 s14, s14, s51
    buffer_load_dwordx4 v[220:223], v4, s[20:23], s14 offen offset:0 sc1
    buffer_load_dwordx4 v[224:227], v4, s[20:23], s14 offen offset:1024 sc1
    buffer_load_dwordx4 v[228:231], v4, s[20:23], s14 offen offset:2048 sc1
    buffer_load_dwordx4 v[232:235], v4, s[20:23], s14 offen offset:3072 sc1
    s_waitcnt vmcnt(8)
    s_barrier
    ds_read_b128 v[56:59], v18 offset:0
    ds_read_b128 v[60:63], v18 offset:1024
    ds_read_b128 v[64:67], v18 offset:2048
    ds_read_b128 v[68:71], v18 offset:3072
    ds_read_b128 v[72:75], v18 offset:4096
    ds_read_b128 v[76:79], v18 offset:5120
    ds_read_b128 v[80:83], v18 offset:6144
    ds_read_b128 v[84:87], v18 offset:7168
    s_waitcnt lgkmcnt(7)
    v_lshlrev_b32 v116, 16, v20
    v_and_b32 v117, 0xffff0000, v20
    v_lshlrev_b32 v118, 16, v21
    v_and_b32 v119, 0xffff0000, v21
    v_lshlrev_b32 v8, 16, v174
    v_and_b32 v9, 0xffff0000, v174
    v_lshlrev_b32 v10, 16, v175
    v_and_b32 v11, 0xffff0000, v175
    v_add_f32 v116, v116, v8
    v_add_f32 v117, v117, v9
    v_add_f32 v118, v118, v10
    v_add_f32 v119, v119, v11
    v_lshlrev_b32 v120, 16, v22
    v_and_b32 v121, 0xffff0000, v22
    v_lshlrev_b32 v122, 16, v23
    v_and_b32 v123, 0xffff0000, v23
    v_lshlrev_b32 v8, 16, v176
    v_and_b32 v9, 0xffff0000, v176
    v_lshlrev_b32 v10, 16, v177
    v_and_b32 v11, 0xffff0000, v177
    v_add_f32 v120, v120, v8
    v_add_f32 v121, v121, v9
    v_add_f32 v122, v122, v10
    v_add_f32 v123, v123, v11
    v_lshlrev_b32 v124, 16, v24
    v_and_b32 v125, 0xffff0000, v24
    v_lshlrev_b32 v126, 16, v25
    v_and_b32 v127, 0xffff0000, v25
    v_lshlrev_b32 v8, 16, v178
    v_and_b32 v9, 0xffff0000, v178
    v_lshlrev_b32 v10, 16, v179
    v_and_b32 v11, 0xffff0000, v179
    v_add_f32 v124, v124, v8
    v_add_f32 v125, v125, v9
    v_add_f32 v126, v126, v10
    v_add_f32 v127, v127, v11
    v_lshlrev_b32 v128, 16, v26
    v_and_b32 v129, 0xffff0000, v26
    v_lshlrev_b32 v130, 16, v27
    v_and_b32 v131, 0xffff0000, v27
    v_lshlrev_b32 v8, 16, v180
    v_and_b32 v9, 0xffff0000, v180
    v_lshlrev_b32 v10, 16, v181
    v_and_b32 v11, 0xffff0000, v181
    v_add_f32 v128, v128, v8
    v_add_f32 v129, v129, v9
    v_add_f32 v130, v130, v10
    v_add_f32 v131, v131, v11
    v_lshlrev_b32 v132, 16, v28
    v_and_b32 v133, 0xffff0000, v28
    v_lshlrev_b32 v134, 16, v29
    v_and_b32 v135, 0xffff0000, v29
    v_lshlrev_b32 v8, 16, v182
    v_and_b32 v9, 0xffff0000, v182
    v_lshlrev_b32 v10, 16, v183
    v_and_b32 v11, 0xffff0000, v183
    v_add_f32 v132, v132, v8
    v_add_f32 v133, v133, v9
    v_add_f32 v134, v134, v10
    v_add_f32 v135, v135, v11
    s_nop 1
    v_mfma_f32_16x16x32_bf16 v[116:119], v[56:59], v[188:191], v[116:119]
    ds_read_b128 v[88:91], v18 offset:8192
    s_sub_u32 s14, s26, 9
    s_cselect_b32 s15, 12, 0
    s_add_u32 s14, s14, s15
    s_mul_i32 s14, s14, 4096
    s_add_u32 s14, s14, s51
    buffer_load_dwordx4 v[236:239], v4, s[20:23], s14 offen offset:0 sc1
    s_waitcnt lgkmcnt(7)
    v_mfma_f32_16x16x32_bf16 v[120:123], v[60:63], v[188:191], v[120:123]
    ds_read_b128 v[56:59], v18 offset:9216
    buffer_load_dwordx4 v[240:243], v4, s[20:23], s14 offen offset:1024 sc1
    s_waitcnt lgkmcnt(7)
    v_mfma_f32_16x16x32_bf16 v[124:127], v[64:67], v[188:191], v[124:127]
    ds_read_b128 v[60:63], v18 offset:10240
    buffer_load_dwordx4 v[244:247], v4, s[20:23], s14 offen offset:2048 sc1
    s_waitcnt lgkmcnt(7)
    v_mfma_f32_16x16x32_bf16 v[128:131], v[68:71], v[188:191], v[128:131]
    ds_read_b128 v[64:67], v18 offset:11264
    buffer_load_dwordx4 v[248:251], v4, s[20:23], s14 offen offset:3072 sc1
    s_waitcnt lgkmcnt(7)
    v_mfma_f32_16x16x32_bf16 v[132:135], v[72:75], v[188:191], v[132:135]
    ds_read_b128 v[68:71], v18 offset:12288
    s_waitcnt lgkmcnt(7)
    v_mfma_f32_16x16x32_bf16 v[116:119], v[76:79], v[192:195], v[116:119]
    ds_read_b128 v[72:75], v18 offset:13312
    s_waitcnt lgkmcnt(7)
    v_mfma_f32_16x16x32_bf16 v[120:123], v[80:83], v[192:195], v[120:123]
    ds_read_b128 v[76:79], v18 offset:14336
    s_waitcnt lgkmcnt(7)
    v_mfma_f32_16x16x32_bf16 v[124:127], v[84:87], v[192:195], v[124:127]
    ds_read_b128 v[80:83], v18 offset:15360
    s_waitcnt lgkmcnt(7)
    v_mfma_f32_16x16x32_bf16 v[128:131], v[88:91], v[192:195], v[128:131]
    ds_read_b128 v[84:87], v18 offset:16384
    s_waitcnt lgkmcnt(7)
    v_mfma_f32_16x16x32_bf16 v[132:135], v[56:59], v[192:195], v[132:135]
    ds_read_b128 v[88:91], v18 offset:17408
    s_waitcnt lgkmcnt(7)
    v_mfma_f32_16x16x32_bf16 v[116:119], v[60:63], v[196:199], v[116:119]
    ds_read_b128 v[56:59], v18 offset:18432
    s_waitcnt lgkmcnt(7)
    v_mfma_f32_16x16x32_bf16 v[120:123], v[64:67], v[196:199], v[120:123]
    ds_read_b128 v[60:63], v18 offset:19456
    s_waitcnt lgkmcnt(7)
    v_mfma_f32_16x16x32_bf16 v[124:127], v[68:71], v[196:199], v[124:127]
    s_waitcnt vmcnt(8)
    s_barrier
    ds_read_b128 v[64:67], v18 offset:20480
    s_waitcnt lgkmcnt(7)
    v_mfma_f32_16x16x32_bf16 v[128:131], v[72:75], v[196:199], v[128:131]
    ds_read_b128 v[68:71], v18 offset:21504
    s_waitcnt lgkmcnt(7)
    v_mfma_f32_16x16x32_bf16 v[132:135], v[76:79], v[196:199], v[132:135]
    ds_read_b128 v[72:75], v18 offset:22528
    s_waitcnt lgkmcnt(7)
    v_mfma_f32_16x16x32_bf16 v[116:119], v[80:83], v[200:203], v[116:119]
    ds_read_b128 v[76:79], v18 offset:23552
    s_waitcnt lgkmcnt(7)
    v_mfma_f32_16x16x32_bf16 v[120:123], v[84:87], v[200:203], v[120:123]
    ds_read_b128 v[80:83], v18 offset:24576
    s_waitcnt lgkmcnt(7)
    v_mfma_f32_16x16x32_bf16 v[124:127], v[88:91], v[200:203], v[124:127]
    ds_read_b128 v[84:87], v18 offset:25600
    s_waitcnt lgkmcnt(7)
    v_mfma_f32_16x16x32_bf16 v[128:131], v[56:59], v[200:203], v[128:131]
    ds_read_b128 v[88:91], v18 offset:26624
    s_waitcnt lgkmcnt(7)
    v_mfma_f32_16x16x32_bf16 v[132:135], v[60:63], v[200:203], v[132:135]
    ds_read_b128 v[56:59], v18 offset:27648
    s_waitcnt lgkmcnt(7)
    v_mfma_f32_16x16x32_bf16 v[116:119], v[64:67], v[204:207], v[116:119]
    ds_read_b128 v[60:63], v18 offset:28672
    s_sub_u32 s14, s26, 8
    s_cselect_b32 s15, 12, 0
    s_add_u32 s14, s14, s15
    s_mul_i32 s14, s14, 4096
    s_add_u32 s14, s14, s51
    buffer_load_dwordx4 v[188:191], v4, s[20:23], s14 offen offset:0 sc1
    s_waitcnt lgkmcnt(7)
    v_mfma_f32_16x16x32_bf16 v[120:123], v[68:71], v[204:207], v[120:123]
    ds_read_b128 v[64:67], v18 offset:29696
    buffer_load_dwordx4 v[192:195], v4, s[20:23], s14 offen offset:1024 sc1
    s_waitcnt lgkmcnt(7)
    v_mfma_f32_16x16x32_bf16 v[124:127], v[72:75], v[204:207], v[124:127]
    ds_read_b128 v[68:71], v18 offset:30720
    buffer_load_dwordx4 v[196:199], v4, s[20:23], s14 offen offset:2048 sc1
    s_waitcnt lgkmcnt(7)
    v_mfma_f32_16x16x32_bf16 v[128:131], v[76:79], v[204:207], v[128:131]
    ds_read_b128 v[72:75], v18 offset:31744
    buffer_load_dwordx4 v[200:203], v4, s[20:23], s14 offen offset:3072 sc1
    s_waitcnt lgkmcnt(7)
    v_mfma_f32_16x16x32_bf16 v[132:135], v[80:83], v[204:207], v[132:135]
    ds_read_b128 v[76:79], v18 offset:32768
    s_waitcnt lgkmcnt(7)
    v_mfma_f32_16x16x32_bf16 v[116:119], v[84:87], v[208:211], v[116:119]
    ds_read_b128 v[80:83], v18 offset:33792
    s_waitcnt lgkmcnt(7)
    v_mfma_f32_16x16x32_bf16 v[120:123], v[88:91], v[208:211], v[120:123]
    ds_read_b128 v[84:87], v18 offset:34816
    s_waitcnt lgkmcnt(7)
    v_mfma_f32_16x16x32_bf16 v[124:127], v[56:59], v[208:211], v[124:127]
    ds_read_b128 v[88:91], v18 offset:35840
    s_waitcnt lgkmcnt(7)
    v_mfma_f32_16x16x32_bf16 v[128:131], v[60:63], v[208:211], v[128:131]
    ds_read_b128 v[56:59], v18 offset:36864
    s_waitcnt lgkmcnt(7)
    v_mfma_f32_16x16x32_bf16 v[132:135], v[64:67], v[208:211], v[132:135]
    ds_read_b128 v[60:63], v18 offset:37888
    s_waitcnt lgkmcnt(7)
    v_mfma_f32_16x16x32_bf16 v[116:119], v[68:71], v[212:215], v[116:119]
    ds_read_b128 v[64:67], v18 offset:38912
    s_waitcnt lgkmcnt(7)
    v_mfma_f32_16x16x32_bf16 v[120:123], v[72:75], v[212:215], v[120:123]
    ds_read_b128 v[68:71], v18 offset:39936
    s_waitcnt lgkmcnt(7)
    v_mfma_f32_16x16x32_bf16 v[124:127], v[76:79], v[212:215], v[124:127]
    s_waitcnt vmcnt(8)
    s_barrier
    ds_read_b128 v[72:75], v18 offset:40960
    s_waitcnt lgkmcnt(7)
    v_mfma_f32_16x16x32_bf16 v[128:131], v[80:83], v[212:215], v[128:131]
    ds_read_b128 v[76:79], v18 offset:41984
    s_waitcnt lgkmcnt(7)
    v_mfma_f32_16x16x32_bf16 v[132:135], v[84:87], v[212:215], v[132:135]
    ds_read_b128 v[80:83], v18 offset:43008
    s_waitcnt lgkmcnt(7)
    v_mfma_f32_16x16x32_bf16 v[116:119], v[88:91], v[216:219], v[116:119]
    ds_read_b128 v[84:87], v18 offset:44032
    s_waitcnt lgkmcnt(7)
    v_mfma_f32_16x16x32_bf16 v[120:123], v[56:59], v[216:219], v[120:123]
    ds_read_b128 v[88:91], v18 offset:45056
    s_waitcnt lgkmcnt(7)
    v_mfma_f32_16x16x32_bf16 v[124:127], v[60:63], v[216:219], v[124:127]
    ds_read_b128 v[56:59], v18 offset:46080
    s_waitcnt lgkmcnt(7)
    v_mfma_f32_16x16x32_bf16 v[128:131], v[64:67], v[216:219], v[128:131]
    ds_read_b128 v[60:63], v18 offset:47104
    s_waitcnt lgkmcnt(7)
    v_mfma_f32_16x16x32_bf16 v[132:135], v[68:71], v[216:219], v[132:135]
    ds_read_b128 v[64:67], v18 offset:48128
    s_waitcnt lgkmcnt(7)
    v_mfma_f32_16x16x32_bf16 v[116:119], v[72:75], v[220:223], v[116:119]
    ds_read_b128 v[68:71], v18 offset:49152
    s_sub_u32 s14, s26, 7
    s_cselect_b32 s15, 12, 0
    s_add_u32 s14, s14, s15
    s_mul_i32 s14, s14, 4096
    s_add_u32 s14, s14, s51
    buffer_load_dwordx4 v[204:207], v4, s[20:23], s14 offen offset:0 sc1
    s_waitcnt lgkmcnt(7)
    v_mfma_f32_16x16x32_bf16 v[120:123], v[76:79], v[220:223], v[120:123]
    ds_read_b128 v[72:75], v18 offset:50176
    buffer_load_dwordx4 v[208:211], v4, s[20:23], s14 offen offset:1024 sc1
    s_waitcnt lgkmcnt(7)
    v_mfma_f32_16x16x32_bf16 v[124:127], v[80:83], v[220:223], v[124:127]
    ds_read_b128 v[76:79], v18 offset:51200
    buffer_load_dwordx4 v[212:215], v4, s[20:23], s14 offen offset:2048 sc1
    s_waitcnt lgkmcnt(7)
    v_mfma_f32_16x16x32_bf16 v[128:131], v[84:87], v[220:223], v[128:131]
    ds_read_b128 v[80:83], v18 offset:52224
    buffer_load_dwordx4 v[216:219], v4, s[20:23], s14 offen offset:3072 sc1
    s_waitcnt lgkmcnt(7)
    v_mfma_f32_16x16x32_bf16 v[132:135], v[88:91], v[220:223], v[132:135]
    ds_read_b128 v[84:87], v18 offset:53248
    s_sub_u32 s27, s26, 5
    s_cselect_b32 s15, 12, 0
    s_add_u32 s27, s27, s15
    s_mul_i32 s27, s27, 20480
    s_add_u32 s27, s27, s52
    s_add_u32 m0, s42, 61440
    s_add_u32 s36, s27, 0
    buffer_load_dwordx4 v4, s[20:23], s36 offen lds
    s_waitcnt lgkmcnt(7)
    v_mfma_f32_16x16x32_bf16 v[116:119], v[56:59], v[224:227], v[116:119]
    ds_read_b128 v[88:91], v18 offset:54272
    s_add_u32 m0, s42, 62464
    s_add_u32 s36, s27, 1024
    buffer_load_dwordx4 v4, s[20:23], s36 offen lds
    s_waitcnt lgkmcnt(7)
    v_mfma_f32_16x16x32_bf16 v[120:123], v[60:63], v[224:227], v[120:123]
    ds_read_b128 v[56:59], v18 offset:55296
    s_add_u32 m0, s42, 63488
    s_add_u32 s36, s27, 2048
    buffer_load_dwordx4 v4, s[20:23], s36 offen lds
    s_waitcnt lgkmcnt(7)
    v_mfma_f32_16x16x32_bf16 v[124:127], v[64:67], v[224:227], v[124:127]
    ds_read_b128 v[60:63], v18 offset:56320
    s_add_u32 m0, s42, 64512
    s_add_u32 s36, s27, 3072
    buffer_load_dwordx4 v4, s[20:23], s36 offen lds
    s_waitcnt lgkmcnt(7)
    v_mfma_f32_16x16x32_bf16 v[128:131], v[68:71], v[224:227], v[128:131]
    ds_read_b128 v[64:67], v18 offset:57344
    s_add_u32 m0, s42, 65536
    s_add_u32 s36, s27, 4096
    buffer_load_dwordx4 v4, s[20:23], s36 offen lds
    s_waitcnt lgkmcnt(7)
    v_mfma_f32_16x16x32_bf16 v[132:135], v[72:75], v[224:227], v[132:135]
    ds_read_b128 v[68:71], v18 offset:58368
    s_waitcnt lgkmcnt(7)
    v_mfma_f32_16x16x32_bf16 v[116:119], v[76:79], v[228:231], v[116:119]
    ds_read_b128 v[72:75], v18 offset:59392
    s_waitcnt lgkmcnt(7)
    v_mfma_f32_16x16x32_bf16 v[120:123], v[80:83], v[228:231], v[120:123]
    ds_read_b128 v[76:79], v18 offset:60416
    s_waitcnt lgkmcnt(7)
    v_mfma_f32_16x16x32_bf16 v[124:127], v[84:87], v[228:231], v[124:127]
    s_waitcnt vmcnt(13)
    s_barrier
    ds_read_b128 v[80:83], v19 offset:0
    s_waitcnt lgkmcnt(7)
    v_mfma_f32_16x16x32_bf16 v[128:131], v[88:91], v[228:231], v[128:131]
    ds_read_b128 v[84:87], v19 offset:1024
    s_waitcnt lgkmcnt(7)
    v_mfma_f32_16x16x32_bf16 v[132:135], v[56:59], v[228:231], v[132:135]
    ds_read_b128 v[88:91], v19 offset:2048
    s_waitcnt lgkmcnt(7)
    v_mfma_f32_16x16x32_bf16 v[116:119], v[60:63], v[232:235], v[116:119]
    ds_read_b128 v[56:59], v19 offset:3072
    s_waitcnt lgkmcnt(7)
    v_mfma_f32_16x16x32_bf16 v[120:123], v[64:67], v[232:235], v[120:123]
    ds_read_b128 v[60:63], v19 offset:4096
    s_waitcnt lgkmcnt(7)
    v_mfma_f32_16x16x32_bf16 v[124:127], v[68:71], v[232:235], v[124:127]
    ds_read_b128 v[64:67], v19 offset:5120
    s_waitcnt lgkmcnt(7)
    v_mfma_f32_16x16x32_bf16 v[128:131], v[72:75], v[232:235], v[128:131]
    ds_read_b128 v[68:71], v19 offset:6144
    s_waitcnt lgkmcnt(7)
    v_mfma_f32_16x16x32_bf16 v[132:135], v[76:79], v[232:235], v[132:135]
    ds_read_b128 v[72:75], v19 offset:7168
    s_waitcnt lgkmcnt(7)
    v_mfma_f32_16x16x32_bf16 v[116:119], v[80:83], v[236:239], v[116:119]
    ds_read_b128 v[76:79], v19 offset:8192
    s_sub_u32 s14, s26, 6
    s_cselect_b32 s15, 12, 0
    s_add_u32 s14, s14, s15
    s_mul_i32 s14, s14, 4096
    s_add_u32 s14, s14, s51
    buffer_load_dwordx4 v[220:223], v4, s[20:23], s14 offen offset:0 sc1
    s_waitcnt lgkmcnt(7)
    v_mfma_f32_16x16x32_bf16 v[120:123], v[84:87], v[236:239], v[120:123]
    ds_read_b128 v[80:83], v19 offset:9216
    buffer_load_dwordx4 v[224:227], v4, s[20:23], s14 offen offset:1024 sc1
    s_waitcnt lgkmcnt(7)
    v_mfma_f32_16x16x32_bf16 v[124:127], v[88:91], v[236:239], v[124:127]
    ds_read_b128 v[84:87], v19 offset:10240
    buffer_load_dwordx4 v[228:231], v4, s[20:23], s14 offen offset:2048 sc1
    s_waitcnt lgkmcnt(7)
    v_mfma_f32_16x16x32_bf16 v[128:131], v[56:59], v[236:239], v[128:131]
    ds_read_b128 v[88:91], v19 offset:11264
    buffer_load_dwordx4 v[232:235], v4, s[20:23], s14 offen offset:3072 sc1
    s_waitcnt lgkmcnt(7)
    v_mfma_f32_16x16x32_bf16 v[132:135], v[60:63], v[236:239], v[132:135]
    ds_read_b128 v[56:59], v19 offset:12288
    s_sub_u32 s27, s26, 4
    s_cselect_b32 s15, 12, 0
    s_add_u32 s27, s27, s15
    s_mul_i32 s27, s27, 20480
    s_add_u32 s27, s27, s52
    s_add_u32 m0, s42, 81920
    s_add_u32 s36, s27, 0
    buffer_load_dwordx4 v4, s[20:23], s36 offen lds
    s_waitcnt lgkmcnt(7)
    v_mfma_f32_16x16x32_bf16 v[116:119], v[64:67], v[240:243], v[116:119]
    ds_read_b128 v[60:63], v19 offset:13312
    s_add_u32 m0, s42, 82944
    s_add_u32 s36, s27, 1024
    buffer_load_dwordx4 v4, s[20:23], s36 offen lds
    s_waitcnt lgkmcnt(7)
    v_mfma_f32_16x16x32_bf16 v[120:123], v[68:71], v[240:243], v[120:123]
    ds_read_b128 v[64:67], v19 offset:14336
    s_add_u32 m0, s42, 83968
    s_add_u32 s36, s27, 2048
    buffer_load_dwordx4 v4, s[20:23], s36 offen lds
    s_waitcnt lgkmcnt(7)
    v_mfma_f32_16x16x32_bf16 v[124:127], v[72:75], v[240:243], v[124:127]
    ds_read_b128 v[68:71], v19 offset:15360
    s_add_u32 m0, s42, 84992
    s_add_u32 s36, s27, 3072
    buffer_load_dwordx4 v4, s[20:23], s36 offen lds
    s_waitcnt lgkmcnt(7)
    v_mfma_f32_16x16x32_bf16 v[128:131], v[76:79], v[240:243], v[128:131]
    ds_read_b128 v[72:75], v19 offset:16384
    s_add_u32 m0, s42, 86016
    s_add_u32 s36, s27, 4096
    buffer_load_dwordx4 v4, s[20:23], s36 offen lds
    s_waitcnt lgkmcnt(7)
    v_mfma_f32_16x16x32_bf16 v[132:135], v[80:83], v[240:243], v[132:135]
    ds_read_b128 v[76:79], v19 offset:17408
    s_waitcnt lgkmcnt(7)
    v_mfma_f32_16x16x32_bf16 v[116:119], v[84:87], v[244:247], v[116:119]
    ds_read_b128 v[80:83], v19 offset:18432
    s_waitcnt lgkmcnt(7)
    v_mfma_f32_16x16x32_bf16 v[120:123], v[88:91], v[244:247], v[120:123]
    ds_read_b128 v[84:87], v19 offset:19456
    s_waitcnt lgkmcnt(7)
    v_mfma_f32_16x16x32_bf16 v[124:127], v[56:59], v[244:247], v[124:127]
    s_waitcnt vmcnt(18)
    s_barrier
    ds_read_b128 v[88:91], v4 offset:0
    s_waitcnt lgkmcnt(7)
    v_mfma_f32_16x16x32_bf16 v[128:131], v[60:63], v[244:247], v[128:131]
    ds_read_b128 v[56:59], v4 offset:1024
    s_waitcnt lgkmcnt(7)
    v_mfma_f32_16x16x32_bf16 v[132:135], v[64:67], v[244:247], v[132:135]
    ds_read_b128 v[60:63], v4 offset:2048
    s_waitcnt lgkmcnt(7)
    v_mfma_f32_16x16x32_bf16 v[116:119], v[68:71], v[248:251], v[116:119]
    ds_read_b128 v[64:67], v4 offset:3072
    s_waitcnt lgkmcnt(7)
    v_mfma_f32_16x16x32_bf16 v[120:123], v[72:75], v[248:251], v[120:123]
    ds_read_b128 v[68:71], v4 offset:4096
    s_waitcnt lgkmcnt(7)
    v_mfma_f32_16x16x32_bf16 v[124:127], v[76:79], v[248:251], v[124:127]
    ds_read_b128 v[72:75], v4 offset:5120
    s_waitcnt lgkmcnt(7)
    v_mfma_f32_16x16x32_bf16 v[128:131], v[80:83], v[248:251], v[128:131]
    ds_read_b128 v[76:79], v4 offset:6144
    s_waitcnt lgkmcnt(7)
    v_mfma_f32_16x16x32_bf16 v[132:135], v[84:87], v[248:251], v[132:135]
    ds_read_b128 v[80:83], v4 offset:7168
    s_waitcnt lgkmcnt(7)
    v_mfma_f32_16x16x32_bf16 v[116:119], v[88:91], v[188:191], v[116:119]
    ds_read_b128 v[84:87], v4 offset:8192
    s_sub_u32 s14, s26, 5
    s_cselect_b32 s15, 12, 0
    s_add_u32 s14, s14, s15
    s_mul_i32 s14, s14, 4096
    s_add_u32 s14, s14, s51
    buffer_load_dwordx4 v[236:239], v4, s[20:23], s14 offen offset:0 sc1
    s_waitcnt lgkmcnt(7)
    v_mfma_f32_16x16x32_bf16 v[120:123], v[56:59], v[188:191], v[120:123]
    ds_read_b128 v[88:91], v4 offset:9216
    buffer_load_dwordx4 v[240:243], v4, s[20:23], s14 offen offset:1024 sc1
    s_waitcnt lgkmcnt(7)
    v_mfma_f32_16x16x32_bf16 v[124:127], v[60:63], v[188:191], v[124:127]
    ds_read_b128 v[56:59], v4 offset:10240
    buffer_load_dwordx4 v[244:247], v4, s[20:23], s14 offen offset:2048 sc1
    s_waitcnt lgkmcnt(7)
    v_mfma_f32_16x16x32_bf16 v[128:131], v[64:67], v[188:191], v[128:131]
    ds_read_b128 v[60:63], v4 offset:11264
    buffer_load_dwordx4 v[248:251], v4, s[20:23], s14 offen offset:3072 sc1
    s_waitcnt lgkmcnt(7)
    v_mfma_f32_16x16x32_bf16 v[132:135], v[68:71], v[188:191], v[132:135]
    ds_read_b128 v[64:67], v4 offset:12288
    s_sub_u32 s27, s26, 3
    s_cselect_b32 s15, 12, 0
    s_add_u32 s27, s27, s15
    s_mul_i32 s27, s27, 20480
    s_add_u32 s27, s27, s52
    s_add_u32 m0, s42, 102400
    s_add_u32 s36, s27, 0
    buffer_load_dwordx4 v4, s[20:23], s36 offen lds
    s_waitcnt lgkmcnt(7)
    v_mfma_f32_16x16x32_bf16 v[116:119], v[72:75], v[192:195], v[116:119]
    ds_read_b128 v[68:71], v4 offset:13312
    s_add_u32 m0, s42, 103424
    s_add_u32 s36, s27, 1024
    buffer_load_dwordx4 v4, s[20:23], s36 offen lds
    s_waitcnt lgkmcnt(7)
    v_mfma_f32_16x16x32_bf16 v[120:123], v[76:79], v[192:195], v[120:123]
    ds_read_b128 v[72:75], v4 offset:14336
    s_add_u32 m0, s42, 104448
    s_add_u32 s36, s27, 2048
    buffer_load_dwordx4 v4, s[20:23], s36 offen lds
    s_waitcnt lgkmcnt(7)
    v_mfma_f32_16x16x32_bf16 v[124:127], v[80:83], v[192:195], v[124:127]
    ds_read_b128 v[76:79], v4 offset:15360
    s_add_u32 m0, s42, 105472
    s_add_u32 s36, s27, 3072
    buffer_load_dwordx4 v4, s[20:23], s36 offen lds
    s_waitcnt lgkmcnt(7)
    v_mfma_f32_16x16x32_bf16 v[128:131], v[84:87], v[192:195], v[128:131]
    ds_read_b128 v[80:83], v4 offset:16384
    s_add_u32 m0, s42, 106496
    s_add_u32 s36, s27, 4096
    buffer_load_dwordx4 v4, s[20:23], s36 offen lds
    s_waitcnt lgkmcnt(7)
    v_mfma_f32_16x16x32_bf16 v[132:135], v[88:91], v[192:195], v[132:135]
    ds_read_b128 v[84:87], v4 offset:17408
    s_waitcnt lgkmcnt(7)
    v_mfma_f32_16x16x32_bf16 v[116:119], v[56:59], v[196:199], v[116:119]
    ds_read_b128 v[88:91], v4 offset:18432
    s_waitcnt lgkmcnt(7)
    v_mfma_f32_16x16x32_bf16 v[120:123], v[60:63], v[196:199], v[120:123]
    ds_read_b128 v[56:59], v4 offset:19456
    s_waitcnt lgkmcnt(7)
    v_mfma_f32_16x16x32_bf16 v[124:127], v[64:67], v[196:199], v[124:127]
    s_waitcnt vmcnt(23)
    s_barrier
    ds_read_b128 v[60:63], v4 offset:20480
    s_waitcnt lgkmcnt(7)
    v_mfma_f32_16x16x32_bf16 v[128:131], v[68:71], v[196:199], v[128:131]
    ds_read_b128 v[64:67], v4 offset:21504
    s_waitcnt lgkmcnt(7)
    v_mfma_f32_16x16x32_bf16 v[132:135], v[72:75], v[196:199], v[132:135]
    ds_read_b128 v[68:71], v4 offset:22528
    s_waitcnt lgkmcnt(7)
    v_mfma_f32_16x16x32_bf16 v[116:119], v[76:79], v[200:203], v[116:119]
    ds_read_b128 v[72:75], v4 offset:23552
    s_waitcnt lgkmcnt(7)
    v_mfma_f32_16x16x32_bf16 v[120:123], v[80:83], v[200:203], v[120:123]
    ds_read_b128 v[76:79], v4 offset:24576
    s_waitcnt lgkmcnt(7)
    v_mfma_f32_16x16x32_bf16 v[124:127], v[84:87], v[200:203], v[124:127]
    ds_read_b128 v[80:83], v4 offset:25600
    s_waitcnt lgkmcnt(7)
    v_mfma_f32_16x16x32_bf16 v[128:131], v[88:91], v[200:203], v[128:131]
    ds_read_b128 v[84:87], v4 offset:26624
    s_waitcnt lgkmcnt(7)
    v_mfma_f32_16x16x32_bf16 v[132:135], v[56:59], v[200:203], v[132:135]
    ds_read_b128 v[88:91], v4 offset:27648
    s_waitcnt lgkmcnt(7)
    v_mfma_f32_16x16x32_bf16 v[116:119], v[60:63], v[204:207], v[116:119]
    ds_read_b128 v[56:59], v4 offset:28672
    s_sub_u32 s14, s26, 4
    s_cselect_b32 s15, 12, 0
    s_add_u32 s14, s14, s15
    s_mul_i32 s14, s14, 4096
    s_add_u32 s14, s14, s51
    buffer_load_dwordx4 v[188:191], v4, s[20:23], s14 offen offset:0 sc1
    s_waitcnt lgkmcnt(7)
    v_mfma_f32_16x16x32_bf16 v[120:123], v[64:67], v[204:207], v[120:123]
    ds_read_b128 v[60:63], v4 offset:29696
    buffer_load_dwordx4 v[192:195], v4, s[20:23], s14 offen offset:1024 sc1
    s_waitcnt lgkmcnt(7)
    v_mfma_f32_16x16x32_bf16 v[124:127], v[68:71], v[204:207], v[124:127]
    ds_read_b128 v[64:67], v4 offset:30720
    buffer_load_dwordx4 v[196:199], v4, s[20:23], s14 offen offset:2048 sc1
    s_waitcnt lgkmcnt(7)
    v_mfma_f32_16x16x32_bf16 v[128:131], v[72:75], v[204:207], v[128:131]
    ds_read_b128 v[68:71], v4 offset:31744
    buffer_load_dwordx4 v[200:203], v4, s[20:23], s14 offen offset:3072 sc1
    s_waitcnt lgkmcnt(7)
    v_mfma_f32_16x16x32_bf16 v[132:135], v[76:79], v[204:207], v[132:135]
    ds_read_b128 v[72:75], v4 offset:32768
    s_sub_u32 s27, s26, 2
    s_cselect_b32 s15, 12, 0
    s_add_u32 s27, s27, s15
    s_mul_i32 s27, s27, 20480
    s_add_u32 s27, s27, s52
    s_add_u32 m0, s42, 122880
    s_add_u32 s36, s27, 0
    buffer_load_dwordx4 v4, s[20:23], s36 offen lds
    s_waitcnt lgkmcnt(7)
    v_mfma_f32_16x16x32_bf16 v[116:119], v[80:83], v[208:211], v[116:119]
    ds_read_b128 v[76:79], v4 offset:33792
    s_add_u32 m0, s42, 123904
    s_add_u32 s36, s27, 1024
    buffer_load_dwordx4 v4, s[20:23], s36 offen lds
    s_waitcnt lgkmcnt(7)
    v_mfma_f32_16x16x32_bf16 v[120:123], v[84:87], v[208:211], v[120:123]
    ds_read_b128 v[80:83], v4 offset:34816
    s_add_u32 m0, s42, 124928
    s_add_u32 s36, s27, 2048
    buffer_load_dwordx4 v4, s[20:23], s36 offen lds
    s_waitcnt lgkmcnt(7)
    v_mfma_f32_16x16x32_bf16 v[124:127], v[88:91], v[208:211], v[124:127]
    ds_read_b128 v[84:87], v4 offset:35840
    s_add_u32 m0, s42, 125952
    s_add_u32 s36, s27, 3072
    buffer_load_dwordx4 v4, s[20:23], s36 offen lds
    s_waitcnt lgkmcnt(7)
    v_mfma_f32_16x16x32_bf16 v[128:131], v[56:59], v[208:211], v[128:131]
    ds_read_b128 v[88:91], v4 offset:36864
    s_add_u32 m0, s42, 126976
    s_add_u32 s36, s27, 4096
    buffer_load_dwordx4 v4, s[20:23], s36 offen lds
    s_waitcnt lgkmcnt(7)
    v_mfma_f32_16x16x32_bf16 v[132:135], v[60:63], v[208:211], v[132:135]
    ds_read_b128 v[56:59], v4 offset:37888
    s_waitcnt lgkmcnt(7)
    v_mfma_f32_16x16x32_bf16 v[116:119], v[64:67], v[212:215], v[116:119]
    ds_read_b128 v[60:63], v4 offset:38912
    s_waitcnt lgkmcnt(7)
    v_mfma_f32_16x16x32_bf16 v[120:123], v[68:71], v[212:215], v[120:123]
    ds_read_b128 v[64:67], v4 offset:39936
    s_waitcnt lgkmcnt(7)
    v_mfma_f32_16x16x32_bf16 v[124:127], v[72:75], v[212:215], v[124:127]
    s_waitcnt vmcnt(23)
    s_barrier
    ds_read_b128 v[68:71], v4 offset:40960
    s_waitcnt lgkmcnt(7)
    v_mfma_f32_16x16x32_bf16 v[128:131], v[76:79], v[212:215], v[128:131]
    ds_read_b128 v[72:75], v4 offset:41984
    s_waitcnt lgkmcnt(7)
    v_mfma_f32_16x16x32_bf16 v[132:135], v[80:83], v[212:215], v[132:135]
    ds_read_b128 v[76:79], v4 offset:43008
    s_waitcnt lgkmcnt(7)
    v_mfma_f32_16x16x32_bf16 v[116:119], v[84:87], v[216:219], v[116:119]
    ds_read_b128 v[80:83], v4 offset:44032
    s_waitcnt lgkmcnt(7)
    v_mfma_f32_16x16x32_bf16 v[120:123], v[88:91], v[216:219], v[120:123]
    ds_read_b128 v[84:87], v4 offset:45056
    s_waitcnt lgkmcnt(7)
    v_mfma_f32_16x16x32_bf16 v[124:127], v[56:59], v[216:219], v[124:127]
    ds_read_b128 v[88:91], v4 offset:46080
    s_waitcnt lgkmcnt(7)
    v_mfma_f32_16x16x32_bf16 v[128:131], v[60:63], v[216:219], v[128:131]
    ds_read_b128 v[56:59], v4 offset:47104
    s_waitcnt lgkmcnt(7)
    v_mfma_f32_16x16x32_bf16 v[132:135], v[64:67], v[216:219], v[132:135]
    ds_read_b128 v[60:63], v4 offset:48128
    s_waitcnt lgkmcnt(7)
    v_mfma_f32_16x16x32_bf16 v[116:119], v[68:71], v[220:223], v[116:119]
    ds_read_b128 v[64:67], v4 offset:49152
    s_sub_u32 s14, s26, 3
    s_cselect_b32 s15, 12, 0
    s_add_u32 s14, s14, s15
    s_mul_i32 s14, s14, 4096
    s_add_u32 s14, s14, s51
    buffer_load_dwordx4 v[204:207], v4, s[20:23], s14 offen offset:0 sc1
    s_waitcnt lgkmcnt(7)
    v_mfma_f32_16x16x32_bf16 v[120:123], v[72:75], v[220:223], v[120:123]
    ds_read_b128 v[68:71], v4 offset:50176
    buffer_load_dwordx4 v[208:211], v4, s[20:23], s14 offen offset:1024 sc1
    s_waitcnt lgkmcnt(7)
    v_mfma_f32_16x16x32_bf16 v[124:127], v[76:79], v[220:223], v[124:127]
    ds_read_b128 v[72:75], v4 offset:51200
    buffer_load_dwordx4 v[212:215], v4, s[20:23], s14 offen offset:2048 sc1
    s_waitcnt lgkmcnt(7)
    v_mfma_f32_16x16x32_bf16 v[128:131], v[80:83], v[220:223], v[128:131]
    ds_read_b128 v[76:79], v4 offset:52224
    buffer_load_dwordx4 v[216:219], v4, s[20:23], s14 offen offset:3072 sc1
    s_waitcnt lgkmcnt(7)
    v_mfma_f32_16x16x32_bf16 v[132:135], v[84:87], v[220:223], v[132:135]
    ds_read_b128 v[80:83], v4 offset:53248
    s_sub_u32 s27, s26, 1
    s_cselect_b32 s15, 12, 0
    s_add_u32 s27, s27, s15
    s_mul_i32 s27, s27, 20480
    s_add_u32 s27, s27, s52
    s_add_u32 m0, s42, 0
    s_add_u32 s36, s27, 0
    buffer_load_dwordx4 v4, s[20:23], s36 offen lds
    s_waitcnt lgkmcnt(7)
    v_mfma_f32_16x16x32_bf16 v[116:119], v[88:91], v[224:227], v[116:119]
    ds_read_b128 v[84:87], v4 offset:54272
    s_add_u32 m0, s42, 1024
    s_add_u32 s36, s27, 1024
    buffer_load_dwordx4 v4, s[20:23], s36 offen lds
    s_waitcnt lgkmcnt(7)
    v_mfma_f32_16x16x32_bf16 v[120:123], v[56:59], v[224:227], v[120:123]
    ds_read_b128 v[88:91], v4 offset:55296
    s_add_u32 m0, s42, 2048
    s_add_u32 s36, s27, 2048
    buffer_load_dwordx4 v4, s[20:23], s36 offen lds
    s_waitcnt lgkmcnt(7)
    v_mfma_f32_16x16x32_bf16 v[124:127], v[60:63], v[224:227], v[124:127]
    ds_read_b128 v[56:59], v4 offset:56320
    s_add_u32 m0, s42, 3072
    s_add_u32 s36, s27, 3072
    buffer_load_dwordx4 v4, s[20:23], s36 offen lds
    s_waitcnt lgkmcnt(7)
    v_mfma_f32_16x16x32_bf16 v[128:131], v[64:67], v[224:227], v[128:131]
    ds_read_b128 v[60:63], v4 offset:57344
    s_add_u32 m0, s42, 4096
    s_add_u32 s36, s27, 4096
    buffer_load_dwordx4 v4, s[20:23], s36 offen lds
    s_waitcnt lgkmcnt(7)
    v_mfma_f32_16x16x32_bf16 v[132:135], v[68:71], v[224:227], v[132:135]
    ds_read_b128 v[64:67], v4 offset:58368
    s_waitcnt lgkmcnt(7)
    v_mfma_f32_16x16x32_bf16 v[116:119], v[72:75], v[228:231], v[116:119]
    ds_read_b128 v[68:71], v4 offset:59392
    s_waitcnt lgkmcnt(7)
    v_mfma_f32_16x16x32_bf16 v[120:123], v[76:79], v[228:231], v[120:123]
    ds_read_b128 v[72:75], v4 offset:60416
    s_waitcnt lgkmcnt(7)
    v_mfma_f32_16x16x32_bf16 v[124:127], v[80:83], v[228:231], v[124:127]
    s_waitcnt vmcnt(23)
    s_barrier
    ds_read_b128 v[76:79], v18 offset:0
    s_waitcnt lgkmcnt(7)
    v_mfma_f32_16x16x32_bf16 v[128:131], v[84:87], v[228:231], v[128:131]
    ds_read_b128 v[80:83], v18 offset:1024
    s_waitcnt lgkmcnt(7)
    v_mfma_f32_16x16x32_bf16 v[132:135], v[88:91], v[228:231], v[132:135]
    ds_read_b128 v[84:87], v18 offset:2048
    s_waitcnt lgkmcnt(7)
    v_mfma_f32_16x16x32_bf16 v[116:119], v[56:59], v[232:235], v[116:119]
    ds_read_b128 v[88:91], v18 offset:3072
    s_waitcnt lgkmcnt(7)
    v_mfma_f32_16x16x32_bf16 v[120:123], v[60:63], v[232:235], v[120:123]
    ds_read_b128 v[56:59], v18 offset:4096
    s_waitcnt lgkmcnt(7)
    v_mfma_f32_16x16x32_bf16 v[124:127], v[64:67], v[232:235], v[124:127]
    ds_read_b128 v[60:63], v18 offset:5120
    s_waitcnt lgkmcnt(7)
    v_mfma_f32_16x16x32_bf16 v[128:131], v[68:71], v[232:235], v[128:131]
    ds_read_b128 v[64:67], v18 offset:6144
    s_waitcnt lgkmcnt(7)
    v_mfma_f32_16x16x32_bf16 v[132:135], v[72:75], v[232:235], v[132:135]
    ds_read_b128 v[68:71], v18 offset:7168
    s_waitcnt lgkmcnt(7)
    v_mfma_f32_16x16x32_bf16 v[116:119], v[76:79], v[236:239], v[116:119]
    ds_read_b128 v[72:75], v18 offset:8192
    s_sub_u32 s14, s26, 2
    s_cselect_b32 s15, 12, 0
    s_add_u32 s14, s14, s15
    s_mul_i32 s14, s14, 4096
    s_add_u32 s14, s14, s51
    buffer_load_dwordx4 v[220:223], v4, s[20:23], s14 offen offset:0 sc1
    s_waitcnt lgkmcnt(7)
    v_mfma_f32_16x16x32_bf16 v[120:123], v[80:83], v[236:239], v[120:123]
    ds_read_b128 v[76:79], v18 offset:9216
    buffer_load_dwordx4 v[224:227], v4, s[20:23], s14 offen offset:1024 sc1
    s_waitcnt lgkmcnt(7)
    v_mfma_f32_16x16x32_bf16 v[124:127], v[84:87], v[236:239], v[124:127]
    ds_read_b128 v[80:83], v18 offset:10240
    buffer_load_dwordx4 v[228:231], v4, s[20:23], s14 offen offset:2048 sc1
    s_waitcnt lgkmcnt(7)
    v_mfma_f32_16x16x32_bf16 v[128:131], v[88:91], v[236:239], v[128:131]
    ds_read_b128 v[84:87], v18 offset:11264
    buffer_load_dwordx4 v[232:235], v4, s[20:23], s14 offen offset:3072 sc1
    s_waitcnt lgkmcnt(7)
    v_mfma_f32_16x16x32_bf16 v[132:135], v[56:59], v[236:239], v[132:135]
    ds_read_b128 v[88:91], v18 offset:12288
    s_waitcnt lgkmcnt(7)
    v_mfma_f32_16x16x32_bf16 v[116:119], v[60:63], v[240:243], v[116:119]
    ds_read_b128 v[56:59], v18 offset:13312
    s_waitcnt lgkmcnt(7)
    v_mfma_f32_16x16x32_bf16 v[120:123], v[64:67], v[240:243], v[120:123]
    ds_read_b128 v[60:63], v18 offset:14336
    s_waitcnt lgkmcnt(7)
    v_mfma_f32_16x16x32_bf16 v[124:127], v[68:71], v[240:243], v[124:127]
    ds_read_b128 v[64:67], v18 offset:15360
    s_waitcnt lgkmcnt(7)
    v_mfma_f32_16x16x32_bf16 v[128:131], v[72:75], v[240:243], v[128:131]
    ds_read_b128 v[68:71], v18 offset:16384
    s_waitcnt lgkmcnt(7)
    v_mfma_f32_16x16x32_bf16 v[132:135], v[76:79], v[240:243], v[132:135]
    ds_read_b128 v[72:75], v18 offset:17408
    s_waitcnt lgkmcnt(7)
    v_mfma_f32_16x16x32_bf16 v[116:119], v[80:83], v[244:247], v[116:119]
    ds_read_b128 v[76:79], v18 offset:18432
    s_waitcnt lgkmcnt(7)
    v_mfma_f32_16x16x32_bf16 v[120:123], v[84:87], v[244:247], v[120:123]
    ds_read_b128 v[80:83], v18 offset:19456
    s_waitcnt lgkmcnt(7)
    v_mfma_f32_16x16x32_bf16 v[124:127], v[88:91], v[244:247], v[124:127]
    s_waitcnt vmcnt(18)
    s_barrier
    ds_read_b128 v[84:87], v18 offset:20480
    s_waitcnt lgkmcnt(7)
    v_mfma_f32_16x16x32_bf16 v[128:131], v[56:59], v[244:247], v[128:131]
    ds_read_b128 v[88:91], v18 offset:21504
    s_waitcnt lgkmcnt(7)
    v_mfma_f32_16x16x32_bf16 v[132:135], v[60:63], v[244:247], v[132:135]
    ds_read_b128 v[56:59], v18 offset:22528
    s_waitcnt lgkmcnt(7)
    v_mfma_f32_16x16x32_bf16 v[116:119], v[64:67], v[248:251], v[116:119]
    ds_read_b128 v[60:63], v18 offset:23552
    s_waitcnt lgkmcnt(7)
    v_mfma_f32_16x16x32_bf16 v[120:123], v[68:71], v[248:251], v[120:123]
    ds_read_b128 v[64:67], v18 offset:24576
    s_waitcnt lgkmcnt(7)
    v_mfma_f32_16x16x32_bf16 v[124:127], v[72:75], v[248:251], v[124:127]
    ds_read_b128 v[68:71], v18 offset:25600
    s_waitcnt lgkmcnt(7)
    v_mfma_f32_16x16x32_bf16 v[128:131], v[76:79], v[248:251], v[128:131]
    ds_read_b128 v[72:75], v18 offset:26624
    s_waitcnt lgkmcnt(7)
    v_mfma_f32_16x16x32_bf16 v[132:135], v[80:83], v[248:251], v[132:135]
    ds_read_b128 v[76:79], v18 offset:27648
    s_waitcnt lgkmcnt(7)
    v_mfma_f32_16x16x32_bf16 v[116:119], v[84:87], v[188:191], v[116:119]
    ds_read_b128 v[80:83], v18 offset:28672
    s_sub_u32 s14, s26, 1
    s_cselect_b32 s15, 12, 0
    s_add_u32 s14, s14, s15
    s_mul_i32 s14, s14, 4096
    s_add_u32 s14, s14, s51
    buffer_load_dwordx4 v[236:239], v4, s[20:23], s14 offen offset:0 sc1
    s_waitcnt lgkmcnt(7)
    v_mfma_f32_16x16x32_bf16 v[120:123], v[88:91], v[188:191], v[120:123]
    ds_read_b128 v[84:87], v18 offset:29696
    buffer_load_dwordx4 v[240:243], v4, s[20:23], s14 offen offset:1024 sc1
    s_waitcnt lgkmcnt(7)
    v_mfma_f32_16x16x32_bf16 v[124:127], v[56:59], v[188:191], v[124:127]
    ds_read_b128 v[88:91], v18 offset:30720
    buffer_load_dwordx4 v[244:247], v4, s[20:23], s14 offen offset:2048 sc1
    s_waitcnt lgkmcnt(7)
    v_mfma_f32_16x16x32_bf16 v[128:131], v[60:63], v[188:191], v[128:131]
    ds_read_b128 v[56:59], v18 offset:31744
    buffer_load_dwordx4 v[248:251], v4, s[20:23], s14 offen offset:3072 sc1
    s_waitcnt lgkmcnt(7)
    v_mfma_f32_16x16x32_bf16 v[132:135], v[64:67], v[188:191], v[132:135]
    ds_read_b128 v[60:63], v18 offset:32768
    s_waitcnt lgkmcnt(7)
    v_mfma_f32_16x16x32_bf16 v[116:119], v[68:71], v[192:195], v[116:119]
    ds_read_b128 v[64:67], v18 offset:33792
    s_waitcnt lgkmcnt(7)
    v_mfma_f32_16x16x32_bf16 v[120:123], v[72:75], v[192:195], v[120:123]
    ds_read_b128 v[68:71], v18 offset:34816
    s_waitcnt lgkmcnt(7)
    v_mfma_f32_16x16x32_bf16 v[124:127], v[76:79], v[192:195], v[124:127]
    ds_read_b128 v[72:75], v18 offset:35840
    s_waitcnt lgkmcnt(7)
    v_mfma_f32_16x16x32_bf16 v[128:131], v[80:83], v[192:195], v[128:131]
    ds_read_b128 v[76:79], v18 offset:36864
    s_waitcnt lgkmcnt(7)
    v_mfma_f32_16x16x32_bf16 v[132:135], v[84:87], v[192:195], v[132:135]
    ds_read_b128 v[80:83], v18 offset:37888
    s_waitcnt lgkmcnt(7)
    v_mfma_f32_16x16x32_bf16 v[116:119], v[88:91], v[196:199], v[116:119]
    ds_read_b128 v[84:87], v18 offset:38912
    s_waitcnt lgkmcnt(7)
    v_mfma_f32_16x16x32_bf16 v[120:123], v[56:59], v[196:199], v[120:123]
    ds_read_b128 v[88:91], v18 offset:39936
    s_waitcnt lgkmcnt(7)
    v_mfma_f32_16x16x32_bf16 v[124:127], v[60:63], v[196:199], v[124:127]
    s_waitcnt vmcnt(13)
    s_barrier
    ds_read_b128 v[56:59], v18 offset:40960
    s_waitcnt lgkmcnt(7)
    v_mfma_f32_16x16x32_bf16 v[128:131], v[64:67], v[196:199], v[128:131]
    ds_read_b128 v[60:63], v18 offset:41984
    s_waitcnt lgkmcnt(7)
    v_mfma_f32_16x16x32_bf16 v[132:135], v[68:71], v[196:199], v[132:135]
    ds_read_b128 v[64:67], v18 offset:43008
    s_waitcnt lgkmcnt(7)
    v_mfma_f32_16x16x32_bf16 v[116:119], v[72:75], v[200:203], v[116:119]
    ds_read_b128 v[68:71], v18 offset:44032
    s_waitcnt lgkmcnt(7)
    v_mfma_f32_16x16x32_bf16 v[120:123], v[76:79], v[200:203], v[120:123]
    ds_read_b128 v[72:75], v18 offset:45056
    s_waitcnt lgkmcnt(7)
    v_mfma_f32_16x16x32_bf16 v[124:127], v[80:83], v[200:203], v[124:127]
    ds_read_b128 v[76:79], v18 offset:46080
    s_waitcnt lgkmcnt(7)
    v_mfma_f32_16x16x32_bf16 v[128:131], v[84:87], v[200:203], v[128:131]
    ds_read_b128 v[80:83], v18 offset:47104
    s_waitcnt lgkmcnt(7)
    v_mfma_f32_16x16x32_bf16 v[132:135], v[88:91], v[200:203], v[132:135]
    ds_read_b128 v[84:87], v18 offset:48128
    s_waitcnt lgkmcnt(7)
    v_mfma_f32_16x16x32_bf16 v[116:119], v[56:59], v[204:207], v[116:119]
    ds_read_b128 v[88:91], v18 offset:49152
    s_waitcnt lgkmcnt(7)
    v_mfma_f32_16x16x32_bf16 v[120:123], v[60:63], v[204:207], v[120:123]
    ds_read_b128 v[56:59], v18 offset:50176
    s_waitcnt lgkmcnt(7)
    v_mfma_f32_16x16x32_bf16 v[124:127], v[64:67], v[204:207], v[124:127]
    ds_read_b128 v[60:63], v18 offset:51200
    s_waitcnt lgkmcnt(7)
    v_mfma_f32_16x16x32_bf16 v[128:131], v[68:71], v[204:207], v[128:131]
    ds_read_b128 v[64:67], v18 offset:52224
    s_waitcnt lgkmcnt(7)
    v_mfma_f32_16x16x32_bf16 v[132:135], v[72:75], v[204:207], v[132:135]
    ds_read_b128 v[68:71], v18 offset:53248
    s_waitcnt lgkmcnt(7)
    v_mfma_f32_16x16x32_bf16 v[116:119], v[76:79], v[208:211], v[116:119]
    ds_read_b128 v[72:75], v18 offset:54272
    s_waitcnt lgkmcnt(7)
    v_mfma_f32_16x16x32_bf16 v[120:123], v[80:83], v[208:211], v[120:123]
    ds_read_b128 v[76:79], v18 offset:55296
    s_waitcnt lgkmcnt(7)
    v_mfma_f32_16x16x32_bf16 v[124:127], v[84:87], v[208:211], v[124:127]
    ds_read_b128 v[80:83], v18 offset:56320
    s_waitcnt lgkmcnt(7)
    v_mfma_f32_16x16x32_bf16 v[128:131], v[88:91], v[208:211], v[128:131]
    ds_read_b128 v[84:87], v18 offset:57344
    s_waitcnt lgkmcnt(7)
    v_mfma_f32_16x16x32_bf16 v[132:135], v[56:59], v[208:211], v[132:135]
    ds_read_b128 v[88:91], v18 offset:58368
    s_waitcnt lgkmcnt(7)
    v_mfma_f32_16x16x32_bf16 v[116:119], v[60:63], v[212:215], v[116:119]
    ds_read_b128 v[56:59], v18 offset:59392
    s_waitcnt lgkmcnt(7)
    v_mfma_f32_16x16x32_bf16 v[120:123], v[64:67], v[212:215], v[120:123]
    ds_read_b128 v[60:63], v18 offset:60416
    s_waitcnt lgkmcnt(7)
    v_mfma_f32_16x16x32_bf16 v[124:127], v[68:71], v[212:215], v[124:127]
    s_waitcnt vmcnt(4)
    s_barrier
    ds_read_b128 v[64:67], v19 offset:0
    s_waitcnt lgkmcnt(7)
    v_mfma_f32_16x16x32_bf16 v[128:131], v[72:75], v[212:215], v[128:131]
    ds_read_b128 v[68:71], v19 offset:1024
    s_waitcnt lgkmcnt(7)
    v_mfma_f32_16x16x32_bf16 v[132:135], v[76:79], v[212:215], v[132:135]
    ds_read_b128 v[72:75], v19 offset:2048
    s_waitcnt lgkmcnt(7)
    v_mfma_f32_16x16x32_bf16 v[116:119], v[80:83], v[216:219], v[116:119]
    ds_read_b128 v[76:79], v19 offset:3072
    s_waitcnt lgkmcnt(7)
    v_mfma_f32_16x16x32_bf16 v[120:123], v[84:87], v[216:219], v[120:123]
    ds_read_b128 v[80:83], v19 offset:4096
    s_waitcnt lgkmcnt(7)
    v_mfma_f32_16x16x32_bf16 v[124:127], v[88:91], v[216:219], v[124:127]
    ds_read_b128 v[84:87], v19 offset:5120
    s_waitcnt lgkmcnt(7)
    v_mfma_f32_16x16x32_bf16 v[128:131], v[56:59], v[216:219], v[128:131]
    ds_read_b128 v[88:91], v19 offset:6144
    s_waitcnt lgkmcnt(7)
    v_mfma_f32_16x16x32_bf16 v[132:135], v[60:63], v[216:219], v[132:135]
    ds_read_b128 v[56:59], v19 offset:7168
    s_waitcnt lgkmcnt(7)
    v_mfma_f32_16x16x32_bf16 v[116:119], v[64:67], v[220:223], v[116:119]
    ds_read_b128 v[60:63], v19 offset:8192
    s_waitcnt lgkmcnt(7)
    v_mfma_f32_16x16x32_bf16 v[120:123], v[68:71], v[220:223], v[120:123]
    ds_read_b128 v[64:67], v19 offset:9216
    s_waitcnt lgkmcnt(7)
    v_mfma_f32_16x16x32_bf16 v[124:127], v[72:75], v[220:223], v[124:127]
    ds_read_b128 v[68:71], v19 offset:10240
    s_waitcnt lgkmcnt(7)
    v_mfma_f32_16x16x32_bf16 v[128:131], v[76:79], v[220:223], v[128:131]
    ds_read_b128 v[72:75], v19 offset:11264
    s_waitcnt lgkmcnt(7)
    v_mfma_f32_16x16x32_bf16 v[132:135], v[80:83], v[220:223], v[132:135]
    ds_read_b128 v[76:79], v19 offset:12288
    s_waitcnt lgkmcnt(7)
    v_mfma_f32_16x16x32_bf16 v[116:119], v[84:87], v[224:227], v[116:119]
    ds_read_b128 v[80:83], v19 offset:13312
    s_waitcnt lgkmcnt(7)
    v_mfma_f32_16x16x32_bf16 v[120:123], v[88:91], v[224:227], v[120:123]
    ds_read_b128 v[84:87], v19 offset:14336
    s_waitcnt lgkmcnt(7)
    v_mfma_f32_16x16x32_bf16 v[124:127], v[56:59], v[224:227], v[124:127]
    ds_read_b128 v[88:91], v19 offset:15360
    s_waitcnt lgkmcnt(7)
    v_mfma_f32_16x16x32_bf16 v[128:131], v[60:63], v[224:227], v[128:131]
    ds_read_b128 v[56:59], v19 offset:16384
    s_waitcnt lgkmcnt(7)
    v_mfma_f32_16x16x32_bf16 v[132:135], v[64:67], v[224:227], v[132:135]
    ds_read_b128 v[60:63], v19 offset:17408
    s_waitcnt lgkmcnt(7)
    v_mfma_f32_16x16x32_bf16 v[116:119], v[68:71], v[228:231], v[116:119]
    ds_read_b128 v[64:67], v19 offset:18432
    s_waitcnt lgkmcnt(7)
    v_mfma_f32_16x16x32_bf16 v[120:123], v[72:75], v[228:231], v[120:123]
    ds_read_b128 v[68:71], v19 offset:19456
    s_waitcnt lgkmcnt(7)
    v_mfma_f32_16x16x32_bf16 v[124:127], v[76:79], v[228:231], v[124:127]
    s_waitcnt vmcnt(0)
    s_barrier
    ds_read_b128 v[72:75], v4 offset:0
    s_waitcnt lgkmcnt(7)
    v_mfma_f32_16x16x32_bf16 v[128:131], v[80:83], v[228:231], v[128:131]
    ds_read_b128 v[76:79], v4 offset:1024
    s_waitcnt lgkmcnt(7)
    v_mfma_f32_16x16x32_bf16 v[132:135], v[84:87], v[228:231], v[132:135]
    ds_read_b128 v[80:83], v4 offset:2048
    s_waitcnt lgkmcnt(7)
    v_mfma_f32_16x16x32_bf16 v[116:119], v[88:91], v[232:235], v[116:119]
    ds_read_b128 v[84:87], v4 offset:3072
    s_waitcnt lgkmcnt(7)
    v_mfma_f32_16x16x32_bf16 v[120:123], v[56:59], v[232:235], v[120:123]
    ds_read_b128 v[88:91], v4 offset:4096
    s_waitcnt lgkmcnt(7)
    v_mfma_f32_16x16x32_bf16 v[124:127], v[60:63], v[232:235], v[124:127]
    ds_read_b128 v[56:59], v4 offset:5120
    s_waitcnt lgkmcnt(7)
    v_mfma_f32_16x16x32_bf16 v[128:131], v[64:67], v[232:235], v[128:131]
    ds_read_b128 v[60:63], v4 offset:6144
    s_waitcnt lgkmcnt(7)
    v_mfma_f32_16x16x32_bf16 v[132:135], v[68:71], v[232:235], v[132:135]
    ds_read_b128 v[64:67], v4 offset:7168
    s_waitcnt lgkmcnt(7)
    v_mfma_f32_16x16x32_bf16 v[116:119], v[72:75], v[236:239], v[116:119]
    ds_read_b128 v[68:71], v4 offset:8192
    s_waitcnt lgkmcnt(7)
    v_mfma_f32_16x16x32_bf16 v[120:123], v[76:79], v[236:239], v[120:123]
    ds_read_b128 v[72:75], v4 offset:9216
    s_waitcnt lgkmcnt(7)
    v_mfma_f32_16x16x32_bf16 v[124:127], v[80:83], v[236:239], v[124:127]
    ds_read_b128 v[76:79], v4 offset:10240
    s_waitcnt lgkmcnt(7)
    v_mfma_f32_16x16x32_bf16 v[128:131], v[84:87], v[236:239], v[128:131]
    ds_read_b128 v[80:83], v4 offset:11264
    s_waitcnt lgkmcnt(7)
    v_mfma_f32_16x16x32_bf16 v[132:135], v[88:91], v[236:239], v[132:135]
    ds_read_b128 v[84:87], v4 offset:12288
    s_waitcnt lgkmcnt(7)
    v_mfma_f32_16x16x32_bf16 v[116:119], v[56:59], v[240:243], v[116:119]
    ds_read_b128 v[88:91], v4 offset:13312
    s_waitcnt lgkmcnt(7)
    v_mfma_f32_16x16x32_bf16 v[120:123], v[60:63], v[240:243], v[120:123]
    ds_read_b128 v[56:59], v4 offset:14336
    s_waitcnt lgkmcnt(7)
    v_mfma_f32_16x16x32_bf16 v[124:127], v[64:67], v[240:243], v[124:127]
    ds_read_b128 v[60:63], v4 offset:15360
    s_waitcnt lgkmcnt(7)
    v_mfma_f32_16x16x32_bf16 v[128:131], v[68:71], v[240:243], v[128:131]
    ds_read_b128 v[64:67], v4 offset:16384
    s_waitcnt lgkmcnt(7)
    v_mfma_f32_16x16x32_bf16 v[132:135], v[72:75], v[240:243], v[132:135]
    ds_read_b128 v[68:71], v4 offset:17408
    s_waitcnt lgkmcnt(7)
    v_mfma_f32_16x16x32_bf16 v[116:119], v[76:79], v[244:247], v[116:119]
    ds_read_b128 v[72:75], v4 offset:18432
    s_waitcnt lgkmcnt(7)
    v_mfma_f32_16x16x32_bf16 v[120:123], v[80:83], v[244:247], v[120:123]
    ds_read_b128 v[76:79], v4 offset:19456
    s_waitcnt lgkmcnt(7)
    v_mfma_f32_16x16x32_bf16 v[124:127], v[84:87], v[244:247], v[124:127]
    s_waitcnt lgkmcnt(6)
    v_mfma_f32_16x16x32_bf16 v[128:131], v[88:91], v[244:247], v[128:131]
    s_waitcnt lgkmcnt(5)
    v_mfma_f32_16x16x32_bf16 v[132:135], v[56:59], v[244:247], v[132:135]
    s_waitcnt lgkmcnt(4)
    v_mfma_f32_16x16x32_bf16 v[116:119], v[60:63], v[248:251], v[116:119]
    s_waitcnt lgkmcnt(3)
    v_mfma_f32_16x16x32_bf16 v[120:123], v[64:67], v[248:251], v[120:123]
    s_waitcnt lgkmcnt(2)
    v_mfma_f32_16x16x32_bf16 v[124:127], v[68:71], v[248:251], v[124:127]
    s_waitcnt lgkmcnt(1)
    v_mfma_f32_16x16x32_bf16 v[128:131], v[72:75], v[248:251], v[128:131]
    s_waitcnt lgkmcnt(0)
    v_mfma_f32_16x16x32_bf16 v[132:135], v[76:79], v[248:251], v[132:135]
    s_nop 3
    v_cvt_pk_bf16_f32 v56, v116, v117
    v_cvt_pk_bf16_f32 v57, v118, v119
    ds_write_b64 v33, v[56:57] offset:0
    v_cvt_pk_bf16_f32 v58, v120, v121
    v_cvt_pk_bf16_f32 v59, v122, v123
    ds_write_b64 v33, v[58:59] offset:32
    v_cvt_pk_bf16_f32 v60, v124, v125
    v_cvt_pk_bf16_f32 v61, v126, v127
    ds_write_b64 v33, v[60:61] offset:64
    v_cvt_pk_bf16_f32 v62, v128, v129
    v_cvt_pk_bf16_f32 v63, v130, v131
    ds_write_b64 v33, v[62:63] offset:96
    v_cvt_pk_bf16_f32 v64, v132, v133
    v_cvt_pk_bf16_f32 v65, v134, v135
    ds_write_b64 v33, v[64:65] offset:128
    s_waitcnt lgkmcnt(0)
    ds_read_b128 v[68:71], v34 offset:0
    ds_read_b128 v[72:75], v34 offset:1024
    ds_read_b128 v[76:79], v34 offset:2048
    s_waitcnt lgkmcnt(2)
    buffer_store_dwordx4 v[68:71], v30, s[44:47], s54 offen
    s_waitcnt lgkmcnt(1)
    buffer_store_dwordx4 v[72:75], v31, s[44:47], s54 offen
    s_waitcnt lgkmcnt(0)
    buffer_store_dwordx4 v[76:79], v32, s[44:47], s54 offen
k3_end:
    s_endpgm
text_end:
.section .rodata,"a"
.p2align 6
.amdhsa_kernel k1_kernel
  .amdhsa_next_free_vgpr 248
  .amdhsa_next_free_sgpr 102
  .amdhsa_accum_offset 248
  .amdhsa_group_segment_fixed_size 0
  .amdhsa_kernarg_size 104
  .amdhsa_user_sgpr_count 2
  .amdhsa_user_sgpr_kernarg_segment_ptr 1
  .amdhsa_system_sgpr_workgroup_id_x 1
.end_amdhsa_kernel
.p2align 6
.amdhsa_kernel k2_kernel
  .amdhsa_next_free_vgpr 152
  .amdhsa_next_free_sgpr 102
  .amdhsa_accum_offset 152
  .amdhsa_group_segment_fixed_size 0
  .amdhsa_kernarg_size 104
  .amdhsa_user_sgpr_count 2
  .amdhsa_user_sgpr_kernarg_segment_ptr 1
  .amdhsa_system_sgpr_workgroup_id_x 1
.end_amdhsa_kernel
.p2align 6
.amdhsa_kernel k3_kernel
  .amdhsa_next_free_vgpr 252
  .amdhsa_next_free_sgpr 102
  .amdhsa_accum_offset 252
  .amdhsa_group_segment_fixed_size 0
  .amdhsa_kernarg_size 104
  .amdhsa_user_sgpr_count 2
  .amdhsa_user_sgpr_kernarg_segment_ptr 1
  .amdhsa_system_sgpr_workgroup_id_x 1
.end_amdhsa_kernel
```
